```python
import torch

def _softmax(x, axis=-1):
    return torch.softmax(x, dim=axis)
def _gelu(x):
    return torch.nn.functional.gelu(x, approximate="tanh")
def _silu(x):
    return torch.nn.functional.silu(x)
def _sigmoid(x):
    return torch.sigmoid(x)
def _layernorm(x, axis=-1, eps=1e-5):
    m = x.mean(dim=axis, keepdim=True)
    v = x.var(dim=axis, keepdim=True, unbiased=False)
    return (x - m) / torch.sqrt(v + eps)
def _scatter_add(tgt, idx, src, axis=0):
    return tgt.clone().index_add_(axis, idx, src)
def _segment_sum(src, seg, n):
    out = torch.zeros((n,) + src.shape[1:], dtype=src.dtype)
    return out.index_add_(0, seg, src)
def _pad(x, pw):
    flat = tuple(v for pair in reversed(pw) for v in pair)
    return torch.nn.functional.pad(x, flat)

kernel_name = 'recurrent_scan__sliding_block_cached__glu_gated_reglu__prompt'

def setup_inputs():

    _w = (lambda a: (lambda t: t.to(torch.bfloat16) if t.is_floating_point() else t)(torch.as_tensor(a)))
    def _A_setup():
        B, Sq, D = 1, 2048, 512
        Hq, Hkv, Sk, Dh = 32, 8, 2048, 128
        assert Hq % Hkv == 0, (Hq, Hkv)
        return {
            "x": _w((lambda *s: torch.randn(*s, dtype=torch.bfloat16) * 0.05)(B, Sq, D)),
            "k_cache": _w((lambda *s: torch.randn(*s, dtype=torch.bfloat16) * 1.6)(B, Hkv, Sk, Dh)),
            "v_cache": _w((lambda *s: torch.randn(*s, dtype=torch.bfloat16) * 1.6)(B, Hkv, Sk, Dh)),
            "wq": _w((lambda *s: torch.randn(*s, dtype=torch.bfloat16) * 1.6)(D, Hq * Dh) * (D ** -0.5)),
            "wo": _w((lambda *s: torch.randn(*s, dtype=torch.bfloat16) * 1.6)(Hq * Dh, D) * ((Hq * Dh) ** -0.5)),
        }
    _A_in = _A_setup()

    def _B_setup():
        B, S, D, F = 1, 2048, 512, 1792
        return {
            "x": _w((lambda *s: torch.randn(*s, dtype=torch.bfloat16) * 0.05)(B, S, D)),
            "W_gate": _w((lambda *s: torch.randn(*s, dtype=torch.bfloat16) * 0.2)(D, F) * (2.0 / D) ** 0.5),
            "W_up": _w((lambda *s: torch.randn(*s, dtype=torch.bfloat16) * 0.2)(D, F) * (2.0 / D) ** 0.5),
            "W_down": _w((lambda *s: torch.randn(*s, dtype=torch.bfloat16) * 0.2)(F, D) * (1.0 / F) ** 0.5),
        }
    _B_in = _B_setup()

    return {
        "A_x": _A_in["x"],
        "A_k_cache": _A_in["k_cache"],
        "A_v_cache": _A_in["v_cache"],
        "A_wq": _A_in["wq"],
        "A_wo": _A_in["wo"],
        "B_x": _B_in["x"],
        "B_W_gate": _B_in["W_gate"],
        "B_W_up": _B_in["W_up"],
        "B_W_down": _B_in["W_down"],
    }

def reference(A_x, A_k_cache, A_v_cache, A_wq, A_wo, B_x, B_W_gate, B_W_up, B_W_down):
    def _A_ref(x, k_cache, v_cache, wq, wo):
        B, Sq, D = x.shape
        Hq, Dh = 32, 128
        Hkv, Sk = k_cache.shape[1], k_cache.shape[2]
        W = min(4096, max(256, Sk // 4))
        rep = Hq // Hkv
        q = (lambda x, *d: x.permute(*d))((x @ wq).reshape(B, Sq, Hq, Dh), 0, 2, 1, 3)
        k = (lambda x, n, axis: torch.repeat_interleave(x, n, dim=axis))(k_cache[:, :, Sk - W:, :], rep, axis=1)
        v = (lambda x, n, axis: torch.repeat_interleave(x, n, dim=axis))(v_cache[:, :, Sk - W:, :], rep, axis=1)
        scores = torch.einsum("bhqd,bhkd->bhqk", q, k) * (Dh ** -0.5)
        p = _softmax(scores, axis=-1)
        o = torch.einsum("bhqk,bhkd->bhqd", p, v)
        return (lambda x, *d: x.permute(*d))(o, 0, 2, 1, 3).reshape(B, Sq, Hq * Dh) @ wo

    def _B_ref(x, W_gate, W_up, W_down):
        gate = torch.einsum("bsd,df->bsf", x, W_gate)
        up = torch.einsum("bsd,df->bsf", x, W_up)
        gate = gate * (lambda x, dt: x.to(dt))(gate > 0, gate.dtype)
        h = gate * up
        return torch.einsum("bsf,fd->bsd", h, W_down)

    x = A_x
    xn = _layernorm(x, axis=-1)
    s = _A_ref(xn, A_k_cache, A_v_cache, A_wq, A_wo)
    g = _silu(_B_ref(xn, B_W_gate, B_W_up, B_W_down))
    return x + s * g
```

```asm
; @launch grid=(256,1,1) block=(256,1,1) lds=163840
.amdgcn_target "amdgcn-amd-amdhsa--gfx950"
.text
.globl recurrent_scan__sliding_block_cached__glu_gated_reglu__prompt_kernel
.p2align 8
.type recurrent_scan__sliding_block_cached__glu_gated_reglu__prompt_kernel,@function
recurrent_scan__sliding_block_cached__glu_gated_reglu__prompt_kernel:
s_cmp_ge_u32 s2, 0x100
s_cbranch_scc1 L_end
s_load_dwordx16 s[72:87], s[0:1], 0
s_load_dwordx8 s[88:95], s[0:1], 64
v_lshrrev_b32 v233, 6, v0
v_and_b32 v232, 63, v0
v_readfirstlane_b32 s5, v233
s_and_b32 s3, s2, 7
s_lshr_b32 s4, s2, 3
s_mov_b32 s101, s4
s_lshl_b32 s62, s4, 6
s_lshl_b32 s63, s5, 4
s_add_u32 s62, s62, s63
s_lshl_b32 s62, s62, 10
v_lshrrev_b32 v233, 2, v232
v_lshlrev_b32 v233, 10, v233
v_and_b32 v234, 3, v232
v_lshlrev_b32 v234, 4, v234
v_add3_u32 v233, v233, v234, s62
s_lshl_b32 s62, s4, 12
s_lshl_b32 s63, s3, 7
s_add_u32 s62, s62, s63
s_add_u32 s62, s62, 0x3000000
s_cmp_eq_u32 s5, 0
s_cselect_b32 s7, s62, 0x7ff00000
v_mov_b32 v237, 0x7ff00000
v_cmp_eq_u32 vcc, 0, v232
v_mov_b32 v239, s7
s_nop 0
v_cndmask_b32 v237, v237, v239, vcc
v_mov_b32 v238, 0
s_waitcnt lgkmcnt(0)
s_mov_b32 s8, s72
s_mov_b32 s9, s73
s_mov_b32 s10, 0x200000
s_mov_b32 s11, 0x20000
v_mov_b32 v231, v233
buffer_load_dwordx4 v[0:3], v231, s[8:11], 0 offen
buffer_load_dwordx4 v[4:7], v231, s[8:11], 0 offen offset:64
buffer_load_dwordx4 v[8:11], v231, s[8:11], 0 offen offset:128
buffer_load_dwordx4 v[12:15], v231, s[8:11], 0 offen offset:192
buffer_load_dwordx4 v[16:19], v231, s[8:11], 0 offen offset:256
buffer_load_dwordx4 v[20:23], v231, s[8:11], 0 offen offset:320
s_mov_b32 s20, s84
s_mov_b32 s21, s85
s_mov_b32 s22, 0x1c0000
s_mov_b32 s23, 0x20000
s_mov_b32 s24, s86
s_mov_b32 s25, s87
s_mov_b32 s26, 0x1c0000
s_mov_b32 s27, 0x20000
s_lshl_b32 s48, s5, 14
s_add_u32 s48, s48, 0x17000
v_lshrrev_b32 v234, 3, v232
v_lshrrev_b32 v236, 4, v232
v_and_b32 v236, 1, v236
v_bfe_u32 v235, v232, 2, 1
v_xor_b32 v235, v235, v236
v_lshlrev_b32 v235, 6, v235
v_and_b32 v236, 3, v232
v_lshlrev_b32 v236, 4, v236
v_add_u32 v235, v235, v236
s_mul_i32 s62, s3, 0x1c0
s_and_b32 s63, s3, 1
s_lshl_b32 s6, s5, 7
s_add_u32 s6, s62, s6
s_lshl_b32 s7, s63, 6
s_add_u32 s6, s6, s7
s_cmp_eq_u32 s5, 3
s_cselect_b32 s7, s63, 0
s_mul_i32 s7, s7, 0x200
s_sub_u32 s6, s6, s7
v_bfe_u32 v229, v232, 1, 2
v_bfe_u32 v230, v232, 4, 1
v_xor_b32 v229, v229, v230
v_lshlrev_b32 v229, 5, v229
v_and_b32 v230, 1, v232
v_lshlrev_b32 v230, 4, v230
v_add_u32 v229, v229, v230
v_xor_b32 v230, 64, v229
v_mul_u32_u24 v240, 0xe00, v234
v_add3_u32 v241, v240, v230, s6
v_add_u32 v241, 0x6c00, v241
v_add3_u32 v240, v240, v229, s6
s_mul_i32 s96, s5, 0x1800
s_mov_b32 s32, s74
s_mov_b32 s33, s75
s_mov_b32 s34, 0x400000
s_mov_b32 s35, 0x20000
s_mov_b32 s36, s76
s_mov_b32 s37, s77
s_mov_b32 s38, 0x400000
s_mov_b32 s39, 0x20000
s_mov_b32 s12, s78
s_mov_b32 s13, s79
s_mov_b32 s14, 0x400000
s_mov_b32 s15, 0x20000
s_mov_b32 s16, s80
s_mov_b32 s17, s81
s_mov_b32 s18, 0x400000
s_mov_b32 s19, 0x20000
s_mov_b32 s28, s88
s_mov_b32 s29, s89
s_mov_b32 s30, 0x1c0000
s_mov_b32 s31, 0x20000
s_mov_b32 s64, s90
s_mov_b32 s65, s91
s_mov_b32 s66, 0x200000
s_mov_b32 s67, 0x20000
s_mov_b32 s68, s92
s_mov_b32 s69, s93
s_mov_b32 s70, 0x100
s_mov_b32 s71, 0x20000
s_and_b32 s63, s3, 1
s_lshl_b32 s6, s5, 1
s_add_u32 s6, s6, s63
s_lshl_b32 s7, s6, 12
s_add_u32 s62, s7, 0x1000
s_cmp_eq_u32 s6, 6
s_cselect_b32 s62, 0x27000, s62
s_cmp_eq_u32 s6, 7
s_cselect_b32 s7, 0x27000, s7
s_cselect_b32 s62, 0, s62
v_lshlrev_b32 v248, 4, v232
v_add_u32 v252, s7, v248
v_add_u32 v253, s62, v248
s_mul_i32 s54, s3, 0x38000
s_mul_i32 s55, s3, 0x80000
s_lshl_b32 s62, s4, 19
s_lshl_b32 s63, s3, 16
s_add_u32 s62, s62, s63
s_lshl_b32 s63, s5, 14
s_add_u32 s56, s62, s63
s_add_u32 s57, s56, 0x1000000
s_mov_b32 s58, 0x3e0293ee
s_mov_b32 s59, 0x5f800000
s_mov_b32 s60, 0
s_mov_b32 s61, 0x3f803f80
s_mul_i32 s52, s5, 0x880
s_add_u32 s52, s52, 0x7000
s_lshl_b32 s53, s5, 11
s_add_u32 s53, s53, 0xd600
s_lshl_b32 s62, s3, 10
s_lshl_b32 s63, s5, 8
s_add_u32 s62, s62, s63
v_lshlrev_b32 v242, 13, v234
v_add3_u32 v243, v242, v230, s62
v_add_u32 v243, 0xfc00, v243
v_add3_u32 v242, v242, v229, s62
v_lshlrev_b32 v244, 10, v234
v_add3_u32 v244, v244, v235, s63
v_add_u32 v245, 0x1c00, v244
v_lshrrev_b32 v233, 5, v232
v_lshlrev_b32 v233, 3, v233
v_bfe_u32 v234, v232, 2, 2
v_add_u32 v233, v233, v234
v_lshlrev_b32 v233, 7, v233
v_bfe_u32 v236, v232, 4, 1
v_lshlrev_b32 v236, 5, v236
v_add_u32 v233, v233, v236
v_and_b32 v235, 1, v232
v_lshlrev_b32 v235, 4, v235
v_bfe_u32 v236, v232, 1, 1
v_lshlrev_b32 v236, 3, v236
v_add3_u32 v233, v233, v235, v236
v_lshrrev_b32 v234, 1, v234
v_lshlrev_b32 v234, 6, v234
v_add3_u32 v246, v233, v234, s48
v_xor_b32 v234, 64, v234
v_add3_u32 v247, v233, v234, s48
s_sub_u32 s62, s96, s48
v_lshrrev_b32 v233, 5, v232
v_lshlrev_b32 v233, 11, v233
v_bfe_u32 v234, v232, 4, 1
v_lshlrev_b32 v235, 10, v234
v_add_u32 v233, v233, v235
v_bfe_u32 v235, v232, 2, 2
v_lshlrev_b32 v235, 7, v235
v_add_u32 v233, v233, v235
v_and_b32 v235, 3, v232
v_lshlrev_b32 v235, 3, v235
v_add3_u32 v233, v233, v235, s48
v_lshlrev_b32 v234, 1, v234
v_bfe_u32 v235, v232, 3, 1
v_add_u32 v234, v234, v235
v_lshlrev_b32 v234, 5, v234
v_xor_b32 v235, 0, v234
v_add_u32 v249, v233, v235
v_add_u32 v192, s62, v249
v_xor_b32 v235, 32, v234
v_add_u32 v251, v233, v235
v_add_u32 v193, s62, v251
v_xor_b32 v235, 64, v234
v_add_u32 v254, v233, v235
v_add_u32 v194, s62, v254
v_xor_b32 v235, 0x60, v234
v_add_u32 v255, v233, v235
v_add_u32 v195, s62, v255
v_lshrrev_b32 v233, 4, v232
v_lshlrev_b32 v233, 1, v233
v_xor_b32 v234, v232, v233
v_lshlrev_b32 v234, 4, v234
v_add_u32 v250, 0x7000, v234
buffer_load_dwordx4 v[24:27], v231, s[8:11], 0 offen offset:384
buffer_load_dwordx4 v[28:31], v231, s[8:11], 0 offen offset:448
buffer_load_dwordx4 v[32:35], v231, s[8:11], 0 offen offset:512
buffer_load_dwordx4 v[36:39], v231, s[8:11], 0 offen offset:576
buffer_load_dwordx4 v[40:43], v231, s[8:11], 0 offen offset:640
buffer_load_dwordx4 v[44:47], v231, s[8:11], 0 offen offset:704
buffer_load_dwordx4 v[48:51], v231, s[8:11], 0 offen offset:768
buffer_load_dwordx4 v[52:55], v231, s[8:11], 0 offen offset:832
buffer_load_dwordx4 v[56:59], v231, s[8:11], 0 offen offset:896
buffer_load_dwordx4 v[60:63], v231, s[8:11], 0 offen offset:960
s_lshr_b32 s62, s2, 3
s_lshl_b32 s62, s62, 2
s_add_u32 s62, s62, s5
s_lshl_b32 s62, s62, 10
v_and_b32 v180, 7, v232
v_lshlrev_b32 v180, 7, v180
v_add_u32 v180, s62, v180
L_pc:
s_getpc_b64 s[44:45]
s_mov_b32 s46, L_code_end-L_pc-4
s_mov_b32 s47, 0x20000
buffer_load_dword v181, v180, s[44:47], 0 offen
s_mov_b32 s40, s94
s_mov_b32 s41, s95
s_mov_b32 s42, 0x10000000
s_mov_b32 s43, 0x20000
buffer_store_dword v238, v237, s[40:43], 0 offen sc1
buffer_store_dword v238, v237, s[40:43], 0 offen offset:1024 sc1
buffer_store_dword v238, v237, s[40:43], 0 offen offset:2048 sc1
s_add_u32 m0, s48, 0
s_mov_b32 s49, 0
buffer_load_dwordx4 v240, s[20:23], s49 offen lds
buffer_load_dwordx4 v241, s[20:23], s49 offen offset:1024 lds
s_add_u32 m0, s48, 0x800
s_mov_b32 s49, 0xe000
buffer_load_dwordx4 v240, s[20:23], s49 offen lds
buffer_load_dwordx4 v241, s[20:23], s49 offen offset:1024 lds
s_add_u32 m0, s48, 0x1000
s_mov_b32 s49, 0x1c000
buffer_load_dwordx4 v240, s[20:23], s49 offen lds
buffer_load_dwordx4 v241, s[20:23], s49 offen offset:1024 lds
s_add_u32 m0, s48, 0x1800
s_mov_b32 s49, 0x2a000
buffer_load_dwordx4 v240, s[20:23], s49 offen lds
buffer_load_dwordx4 v241, s[20:23], s49 offen offset:1024 lds
s_add_u32 m0, s48, 0x2000
s_mov_b32 s49, 0x38000
buffer_load_dwordx4 v240, s[20:23], s49 offen lds
buffer_load_dwordx4 v241, s[20:23], s49 offen offset:1024 lds
s_add_u32 m0, s48, 0x2800
s_mov_b32 s49, 0x46000
buffer_load_dwordx4 v240, s[20:23], s49 offen lds
buffer_load_dwordx4 v241, s[20:23], s49 offen offset:1024 lds
s_waitcnt vmcnt(31)
v_dot2_f32_bf16 v65, v0, s61, 0
v_dot2_f32_bf16 v67, v0, v0, 0
v_dot2_f32_bf16 v66, v1, s61, 0
v_dot2_f32_bf16 v69, v1, v1, 0
v_dot2_f32_bf16 v65, v2, s61, v65
v_dot2_f32_bf16 v67, v2, v2, v67
v_dot2_f32_bf16 v66, v3, s61, v66
v_dot2_f32_bf16 v69, v3, v3, v69
s_waitcnt vmcnt(30)
v_dot2_f32_bf16 v65, v4, s61, v65
v_dot2_f32_bf16 v67, v4, v4, v67
v_dot2_f32_bf16 v66, v5, s61, v66
v_dot2_f32_bf16 v69, v5, v5, v69
v_dot2_f32_bf16 v65, v6, s61, v65
v_dot2_f32_bf16 v67, v6, v6, v67
v_dot2_f32_bf16 v66, v7, s61, v66
v_dot2_f32_bf16 v69, v7, v7, v69
s_waitcnt vmcnt(29)
v_dot2_f32_bf16 v65, v8, s61, v65
v_dot2_f32_bf16 v67, v8, v8, v67
v_dot2_f32_bf16 v66, v9, s61, v66
v_dot2_f32_bf16 v69, v9, v9, v69
v_dot2_f32_bf16 v65, v10, s61, v65
v_dot2_f32_bf16 v67, v10, v10, v67
v_dot2_f32_bf16 v66, v11, s61, v66
v_dot2_f32_bf16 v69, v11, v11, v69
s_waitcnt vmcnt(28)
v_dot2_f32_bf16 v65, v12, s61, v65
v_dot2_f32_bf16 v67, v12, v12, v67
v_dot2_f32_bf16 v66, v13, s61, v66
v_dot2_f32_bf16 v69, v13, v13, v69
v_dot2_f32_bf16 v65, v14, s61, v65
v_dot2_f32_bf16 v67, v14, v14, v67
v_dot2_f32_bf16 v66, v15, s61, v66
v_dot2_f32_bf16 v69, v15, v15, v69
s_waitcnt vmcnt(27)
v_dot2_f32_bf16 v65, v16, s61, v65
v_dot2_f32_bf16 v67, v16, v16, v67
v_dot2_f32_bf16 v66, v17, s61, v66
v_dot2_f32_bf16 v69, v17, v17, v69
v_dot2_f32_bf16 v65, v18, s61, v65
v_dot2_f32_bf16 v67, v18, v18, v67
v_dot2_f32_bf16 v66, v19, s61, v66
v_dot2_f32_bf16 v69, v19, v19, v69
s_waitcnt vmcnt(26)
v_dot2_f32_bf16 v65, v20, s61, v65
v_dot2_f32_bf16 v67, v20, v20, v67
v_dot2_f32_bf16 v66, v21, s61, v66
v_dot2_f32_bf16 v69, v21, v21, v69
v_dot2_f32_bf16 v65, v22, s61, v65
v_dot2_f32_bf16 v67, v22, v22, v67
v_dot2_f32_bf16 v66, v23, s61, v66
v_dot2_f32_bf16 v69, v23, v23, v69
s_waitcnt vmcnt(25)
v_dot2_f32_bf16 v65, v24, s61, v65
v_dot2_f32_bf16 v67, v24, v24, v67
v_dot2_f32_bf16 v66, v25, s61, v66
v_dot2_f32_bf16 v69, v25, v25, v69
v_dot2_f32_bf16 v65, v26, s61, v65
v_dot2_f32_bf16 v67, v26, v26, v67
v_dot2_f32_bf16 v66, v27, s61, v66
v_dot2_f32_bf16 v69, v27, v27, v69
s_waitcnt vmcnt(24)
v_dot2_f32_bf16 v65, v28, s61, v65
v_dot2_f32_bf16 v67, v28, v28, v67
v_dot2_f32_bf16 v66, v29, s61, v66
v_dot2_f32_bf16 v69, v29, v29, v69
v_dot2_f32_bf16 v65, v30, s61, v65
v_dot2_f32_bf16 v67, v30, v30, v67
v_dot2_f32_bf16 v66, v31, s61, v66
v_dot2_f32_bf16 v69, v31, v31, v69
s_waitcnt vmcnt(23)
v_dot2_f32_bf16 v65, v32, s61, v65
v_dot2_f32_bf16 v67, v32, v32, v67
v_dot2_f32_bf16 v66, v33, s61, v66
v_dot2_f32_bf16 v69, v33, v33, v69
v_dot2_f32_bf16 v65, v34, s61, v65
v_dot2_f32_bf16 v67, v34, v34, v67
v_dot2_f32_bf16 v66, v35, s61, v66
v_dot2_f32_bf16 v69, v35, v35, v69
s_waitcnt vmcnt(22)
v_dot2_f32_bf16 v65, v36, s61, v65
v_dot2_f32_bf16 v67, v36, v36, v67
v_dot2_f32_bf16 v66, v37, s61, v66
v_dot2_f32_bf16 v69, v37, v37, v69
v_dot2_f32_bf16 v65, v38, s61, v65
v_dot2_f32_bf16 v67, v38, v38, v67
v_dot2_f32_bf16 v66, v39, s61, v66
v_dot2_f32_bf16 v69, v39, v39, v69
s_waitcnt vmcnt(21)
v_dot2_f32_bf16 v65, v40, s61, v65
v_dot2_f32_bf16 v67, v40, v40, v67
v_dot2_f32_bf16 v66, v41, s61, v66
v_dot2_f32_bf16 v69, v41, v41, v69
v_dot2_f32_bf16 v65, v42, s61, v65
v_dot2_f32_bf16 v67, v42, v42, v67
v_dot2_f32_bf16 v66, v43, s61, v66
v_dot2_f32_bf16 v69, v43, v43, v69
s_waitcnt vmcnt(20)
v_dot2_f32_bf16 v65, v44, s61, v65
v_dot2_f32_bf16 v67, v44, v44, v67
v_dot2_f32_bf16 v66, v45, s61, v66
v_dot2_f32_bf16 v69, v45, v45, v69
v_dot2_f32_bf16 v65, v46, s61, v65
v_dot2_f32_bf16 v67, v46, v46, v67
v_dot2_f32_bf16 v66, v47, s61, v66
v_dot2_f32_bf16 v69, v47, v47, v69
s_waitcnt vmcnt(19)
v_dot2_f32_bf16 v65, v48, s61, v65
v_dot2_f32_bf16 v67, v48, v48, v67
v_dot2_f32_bf16 v66, v49, s61, v66
v_dot2_f32_bf16 v69, v49, v49, v69
v_dot2_f32_bf16 v65, v50, s61, v65
v_dot2_f32_bf16 v67, v50, v50, v67
v_dot2_f32_bf16 v66, v51, s61, v66
v_dot2_f32_bf16 v69, v51, v51, v69
s_waitcnt vmcnt(18)
v_dot2_f32_bf16 v65, v52, s61, v65
v_dot2_f32_bf16 v67, v52, v52, v67
v_dot2_f32_bf16 v66, v53, s61, v66
v_dot2_f32_bf16 v69, v53, v53, v69
v_dot2_f32_bf16 v65, v54, s61, v65
v_dot2_f32_bf16 v67, v54, v54, v67
v_dot2_f32_bf16 v66, v55, s61, v66
v_dot2_f32_bf16 v69, v55, v55, v69
s_waitcnt vmcnt(17)
v_dot2_f32_bf16 v65, v56, s61, v65
v_dot2_f32_bf16 v67, v56, v56, v67
v_dot2_f32_bf16 v66, v57, s61, v66
v_dot2_f32_bf16 v69, v57, v57, v69
v_dot2_f32_bf16 v65, v58, s61, v65
v_dot2_f32_bf16 v67, v58, v58, v67
v_dot2_f32_bf16 v66, v59, s61, v66
v_dot2_f32_bf16 v69, v59, v59, v69
s_waitcnt vmcnt(16)
v_dot2_f32_bf16 v65, v60, s61, v65
v_dot2_f32_bf16 v67, v60, v60, v67
v_dot2_f32_bf16 v66, v61, s61, v66
v_dot2_f32_bf16 v69, v61, v61, v69
v_dot2_f32_bf16 v65, v62, s61, v65
v_dot2_f32_bf16 v67, v62, v62, v67
v_dot2_f32_bf16 v66, v63, s61, v66
v_dot2_f32_bf16 v69, v63, v63, v69
s_nop 1
v_add_f32 v65, v65, v66
v_add_f32 v67, v67, v69
s_nop 0
v_add_f32_dpp v65, v65, v65 quad_perm:[1,0,3,2] row_mask:0xf bank_mask:0xf
v_add_f32_dpp v67, v67, v67 quad_perm:[1,0,3,2] row_mask:0xf bank_mask:0xf
s_nop 0
v_add_f32_dpp v65, v65, v65 quad_perm:[2,3,0,1] row_mask:0xf bank_mask:0xf
v_add_f32_dpp v67, v67, v67 quad_perm:[2,3,0,1] row_mask:0xf bank_mask:0xf
v_mul_f32 v68, 0x3b000000, v65
v_mul_f32 v71, 0x3b000000, v67
v_fma_f32 v71, -v68, v68, v71
v_max_f32 v71, 0, v71
v_add_f32 v71, 0x3727c5ac, v71
v_rsq_f32 v70, v71
s_nop 0
v_mul_f32 v72, v68, v70
v_sub_f32 v72, 0, v72
v_lshrrev_b32 v75, 2, v232
v_and_b32 v76, 3, v232
v_lshlrev_b32 v74, 4, v76
v_add_u32 v75, v75, v74
v_lshlrev_b32 v76, 1, v76
v_xor_b32 v75, v75, v76
v_lshlrev_b32 v75, 4, v75
s_lshl_b32 s62, s5, 10
s_add_u32 s62, s62, 0x7000
v_add_u32 v74, s62, v75
v_lshlrev_b32 v80, 16, v0
v_and_b32 v81, 0xffff0000, v0
v_lshlrev_b32 v82, 16, v1
v_and_b32 v83, 0xffff0000, v1
v_lshlrev_b32 v84, 16, v2
v_and_b32 v85, 0xffff0000, v2
v_lshlrev_b32 v86, 16, v3
v_and_b32 v87, 0xffff0000, v3
v_pk_fma_f32 v[80:81], v[80:81], v[70:71], v[72:73] op_sel_hi:[1,0,0]
v_pk_fma_f32 v[82:83], v[82:83], v[70:71], v[72:73] op_sel_hi:[1,0,0]
v_pk_fma_f32 v[84:85], v[84:85], v[70:71], v[72:73] op_sel_hi:[1,0,0]
v_pk_fma_f32 v[86:87], v[86:87], v[70:71], v[72:73] op_sel_hi:[1,0,0]
v_cvt_pk_bf16_f32 v0, v80, v81
v_cvt_pk_bf16_f32 v1, v82, v83
v_cvt_pk_bf16_f32 v2, v84, v85
v_cvt_pk_bf16_f32 v3, v86, v87
ds_write_b128 v74, v[0:3]
s_add_u32 m0, s48, 0x3000
s_mov_b32 s49, 0x54000
buffer_load_dwordx4 v240, s[20:23], s49 offen lds
buffer_load_dwordx4 v241, s[20:23], s49 offen offset:1024 lds
v_lshlrev_b32 v88, 16, v4
v_and_b32 v89, 0xffff0000, v4
v_lshlrev_b32 v90, 16, v5
v_and_b32 v91, 0xffff0000, v5
v_lshlrev_b32 v92, 16, v6
v_and_b32 v93, 0xffff0000, v6
v_lshlrev_b32 v94, 16, v7
v_and_b32 v95, 0xffff0000, v7
v_pk_fma_f32 v[88:89], v[88:89], v[70:71], v[72:73] op_sel_hi:[1,0,0]
v_pk_fma_f32 v[90:91], v[90:91], v[70:71], v[72:73] op_sel_hi:[1,0,0]
v_pk_fma_f32 v[92:93], v[92:93], v[70:71], v[72:73] op_sel_hi:[1,0,0]
v_pk_fma_f32 v[94:95], v[94:95], v[70:71], v[72:73] op_sel_hi:[1,0,0]
v_cvt_pk_bf16_f32 v4, v88, v89
v_cvt_pk_bf16_f32 v5, v90, v91
v_cvt_pk_bf16_f32 v6, v92, v93
v_cvt_pk_bf16_f32 v7, v94, v95
ds_write_b128 v74, v[4:7] offset:4096
s_add_u32 m0, s48, 0x3800
s_mov_b32 s49, 0x62000
buffer_load_dwordx4 v240, s[20:23], s49 offen lds
buffer_load_dwordx4 v241, s[20:23], s49 offen offset:1024 lds
v_lshlrev_b32 v80, 16, v8
v_and_b32 v81, 0xffff0000, v8
v_lshlrev_b32 v82, 16, v9
v_and_b32 v83, 0xffff0000, v9
v_lshlrev_b32 v84, 16, v10
v_and_b32 v85, 0xffff0000, v10
v_lshlrev_b32 v86, 16, v11
v_and_b32 v87, 0xffff0000, v11
v_pk_fma_f32 v[80:81], v[80:81], v[70:71], v[72:73] op_sel_hi:[1,0,0]
v_pk_fma_f32 v[82:83], v[82:83], v[70:71], v[72:73] op_sel_hi:[1,0,0]
v_pk_fma_f32 v[84:85], v[84:85], v[70:71], v[72:73] op_sel_hi:[1,0,0]
v_pk_fma_f32 v[86:87], v[86:87], v[70:71], v[72:73] op_sel_hi:[1,0,0]
v_cvt_pk_bf16_f32 v8, v80, v81
v_cvt_pk_bf16_f32 v9, v82, v83
v_cvt_pk_bf16_f32 v10, v84, v85
v_cvt_pk_bf16_f32 v11, v86, v87
ds_write_b128 v74, v[8:11] offset:8192
s_add_u32 m0, s96, 0
s_mov_b32 s49, 0x70000
buffer_load_dwordx4 v240, s[20:23], s49 offen lds
buffer_load_dwordx4 v241, s[20:23], s49 offen offset:1024 lds
v_lshlrev_b32 v88, 16, v12
v_and_b32 v89, 0xffff0000, v12
v_lshlrev_b32 v90, 16, v13
v_and_b32 v91, 0xffff0000, v13
v_lshlrev_b32 v92, 16, v14
v_and_b32 v93, 0xffff0000, v14
v_lshlrev_b32 v94, 16, v15
v_and_b32 v95, 0xffff0000, v15
v_pk_fma_f32 v[88:89], v[88:89], v[70:71], v[72:73] op_sel_hi:[1,0,0]
v_pk_fma_f32 v[90:91], v[90:91], v[70:71], v[72:73] op_sel_hi:[1,0,0]
v_pk_fma_f32 v[92:93], v[92:93], v[70:71], v[72:73] op_sel_hi:[1,0,0]
v_pk_fma_f32 v[94:95], v[94:95], v[70:71], v[72:73] op_sel_hi:[1,0,0]
v_cvt_pk_bf16_f32 v12, v88, v89
v_cvt_pk_bf16_f32 v13, v90, v91
v_cvt_pk_bf16_f32 v14, v92, v93
v_cvt_pk_bf16_f32 v15, v94, v95
ds_write_b128 v74, v[12:15] offset:12288
s_add_u32 m0, s96, 0x800
s_mov_b32 s49, 0x7e000
buffer_load_dwordx4 v240, s[20:23], s49 offen lds
buffer_load_dwordx4 v241, s[20:23], s49 offen offset:1024 lds
v_lshlrev_b32 v80, 16, v16
v_and_b32 v81, 0xffff0000, v16
v_lshlrev_b32 v82, 16, v17
v_and_b32 v83, 0xffff0000, v17
v_lshlrev_b32 v84, 16, v18
v_and_b32 v85, 0xffff0000, v18
v_lshlrev_b32 v86, 16, v19
v_and_b32 v87, 0xffff0000, v19
v_pk_fma_f32 v[80:81], v[80:81], v[70:71], v[72:73] op_sel_hi:[1,0,0]
v_pk_fma_f32 v[82:83], v[82:83], v[70:71], v[72:73] op_sel_hi:[1,0,0]
v_pk_fma_f32 v[84:85], v[84:85], v[70:71], v[72:73] op_sel_hi:[1,0,0]
v_pk_fma_f32 v[86:87], v[86:87], v[70:71], v[72:73] op_sel_hi:[1,0,0]
v_cvt_pk_bf16_f32 v16, v80, v81
v_cvt_pk_bf16_f32 v17, v82, v83
v_cvt_pk_bf16_f32 v18, v84, v85
v_cvt_pk_bf16_f32 v19, v86, v87
ds_write_b128 v74, v[16:19] offset:16384
s_mul_i32 s6, s101, 0xe000
buffer_load_dword v222, v240, s[20:23], s6 offen
buffer_load_dword v223, v241, s[20:23], s6 offen offset:1024
v_lshlrev_b32 v88, 16, v20
v_and_b32 v89, 0xffff0000, v20
v_lshlrev_b32 v90, 16, v21
v_and_b32 v91, 0xffff0000, v21
v_lshlrev_b32 v92, 16, v22
v_and_b32 v93, 0xffff0000, v22
v_lshlrev_b32 v94, 16, v23
v_and_b32 v95, 0xffff0000, v23
v_pk_fma_f32 v[88:89], v[88:89], v[70:71], v[72:73] op_sel_hi:[1,0,0]
v_pk_fma_f32 v[90:91], v[90:91], v[70:71], v[72:73] op_sel_hi:[1,0,0]
v_pk_fma_f32 v[92:93], v[92:93], v[70:71], v[72:73] op_sel_hi:[1,0,0]
v_pk_fma_f32 v[94:95], v[94:95], v[70:71], v[72:73] op_sel_hi:[1,0,0]
v_cvt_pk_bf16_f32 v20, v88, v89
v_cvt_pk_bf16_f32 v21, v90, v91
v_cvt_pk_bf16_f32 v22, v92, v93
v_cvt_pk_bf16_f32 v23, v94, v95
ds_write_b128 v74, v[20:23] offset:20480
s_mul_i32 s6, s101, 0xe000
buffer_load_dword v220, v240, s[24:27], s6 offen
buffer_load_dword v221, v241, s[24:27], s6 offen offset:1024
v_lshlrev_b32 v80, 16, v24
v_and_b32 v81, 0xffff0000, v24
v_lshlrev_b32 v82, 16, v25
v_and_b32 v83, 0xffff0000, v25
v_lshlrev_b32 v84, 16, v26
v_and_b32 v85, 0xffff0000, v26
v_lshlrev_b32 v86, 16, v27
v_and_b32 v87, 0xffff0000, v27
v_pk_fma_f32 v[80:81], v[80:81], v[70:71], v[72:73] op_sel_hi:[1,0,0]
v_pk_fma_f32 v[82:83], v[82:83], v[70:71], v[72:73] op_sel_hi:[1,0,0]
v_pk_fma_f32 v[84:85], v[84:85], v[70:71], v[72:73] op_sel_hi:[1,0,0]
v_pk_fma_f32 v[86:87], v[86:87], v[70:71], v[72:73] op_sel_hi:[1,0,0]
v_cvt_pk_bf16_f32 v24, v80, v81
v_cvt_pk_bf16_f32 v25, v82, v83
v_cvt_pk_bf16_f32 v26, v84, v85
v_cvt_pk_bf16_f32 v27, v86, v87
ds_write_b128 v74, v[24:27] offset:24576
v_lshlrev_b32 v88, 16, v28
v_and_b32 v89, 0xffff0000, v28
v_lshlrev_b32 v90, 16, v29
v_and_b32 v91, 0xffff0000, v29
v_lshlrev_b32 v92, 16, v30
v_and_b32 v93, 0xffff0000, v30
v_lshlrev_b32 v94, 16, v31
v_and_b32 v95, 0xffff0000, v31
v_pk_fma_f32 v[88:89], v[88:89], v[70:71], v[72:73] op_sel_hi:[1,0,0]
v_pk_fma_f32 v[90:91], v[90:91], v[70:71], v[72:73] op_sel_hi:[1,0,0]
v_pk_fma_f32 v[92:93], v[92:93], v[70:71], v[72:73] op_sel_hi:[1,0,0]
v_pk_fma_f32 v[94:95], v[94:95], v[70:71], v[72:73] op_sel_hi:[1,0,0]
v_cvt_pk_bf16_f32 v28, v88, v89
v_cvt_pk_bf16_f32 v29, v90, v91
v_cvt_pk_bf16_f32 v30, v92, v93
v_cvt_pk_bf16_f32 v31, v94, v95
ds_write_b128 v74, v[28:31] offset:28672
v_lshlrev_b32 v80, 16, v32
v_and_b32 v81, 0xffff0000, v32
v_lshlrev_b32 v82, 16, v33
v_and_b32 v83, 0xffff0000, v33
v_lshlrev_b32 v84, 16, v34
v_and_b32 v85, 0xffff0000, v34
v_lshlrev_b32 v86, 16, v35
v_and_b32 v87, 0xffff0000, v35
v_pk_fma_f32 v[80:81], v[80:81], v[70:71], v[72:73] op_sel_hi:[1,0,0]
v_pk_fma_f32 v[82:83], v[82:83], v[70:71], v[72:73] op_sel_hi:[1,0,0]
v_pk_fma_f32 v[84:85], v[84:85], v[70:71], v[72:73] op_sel_hi:[1,0,0]
v_pk_fma_f32 v[86:87], v[86:87], v[70:71], v[72:73] op_sel_hi:[1,0,0]
v_cvt_pk_bf16_f32 v32, v80, v81
v_cvt_pk_bf16_f32 v33, v82, v83
v_cvt_pk_bf16_f32 v34, v84, v85
v_cvt_pk_bf16_f32 v35, v86, v87
ds_write_b128 v74, v[32:35] offset:32768
v_lshlrev_b32 v88, 16, v36
v_and_b32 v89, 0xffff0000, v36
v_lshlrev_b32 v90, 16, v37
v_and_b32 v91, 0xffff0000, v37
v_lshlrev_b32 v92, 16, v38
v_and_b32 v93, 0xffff0000, v38
v_lshlrev_b32 v94, 16, v39
v_and_b32 v95, 0xffff0000, v39
v_pk_fma_f32 v[88:89], v[88:89], v[70:71], v[72:73] op_sel_hi:[1,0,0]
v_pk_fma_f32 v[90:91], v[90:91], v[70:71], v[72:73] op_sel_hi:[1,0,0]
v_pk_fma_f32 v[92:93], v[92:93], v[70:71], v[72:73] op_sel_hi:[1,0,0]
v_pk_fma_f32 v[94:95], v[94:95], v[70:71], v[72:73] op_sel_hi:[1,0,0]
v_cvt_pk_bf16_f32 v36, v88, v89
v_cvt_pk_bf16_f32 v37, v90, v91
v_cvt_pk_bf16_f32 v38, v92, v93
v_cvt_pk_bf16_f32 v39, v94, v95
ds_write_b128 v74, v[36:39] offset:36864
v_lshlrev_b32 v80, 16, v40
v_and_b32 v81, 0xffff0000, v40
v_lshlrev_b32 v82, 16, v41
v_and_b32 v83, 0xffff0000, v41
v_lshlrev_b32 v84, 16, v42
v_and_b32 v85, 0xffff0000, v42
v_lshlrev_b32 v86, 16, v43
v_and_b32 v87, 0xffff0000, v43
v_pk_fma_f32 v[80:81], v[80:81], v[70:71], v[72:73] op_sel_hi:[1,0,0]
v_pk_fma_f32 v[82:83], v[82:83], v[70:71], v[72:73] op_sel_hi:[1,0,0]
v_pk_fma_f32 v[84:85], v[84:85], v[70:71], v[72:73] op_sel_hi:[1,0,0]
v_pk_fma_f32 v[86:87], v[86:87], v[70:71], v[72:73] op_sel_hi:[1,0,0]
v_cvt_pk_bf16_f32 v40, v80, v81
v_cvt_pk_bf16_f32 v41, v82, v83
v_cvt_pk_bf16_f32 v42, v84, v85
v_cvt_pk_bf16_f32 v43, v86, v87
ds_write_b128 v74, v[40:43] offset:40960
v_lshlrev_b32 v88, 16, v44
v_and_b32 v89, 0xffff0000, v44
v_lshlrev_b32 v90, 16, v45
v_and_b32 v91, 0xffff0000, v45
v_lshlrev_b32 v92, 16, v46
v_and_b32 v93, 0xffff0000, v46
v_lshlrev_b32 v94, 16, v47
v_and_b32 v95, 0xffff0000, v47
v_pk_fma_f32 v[88:89], v[88:89], v[70:71], v[72:73] op_sel_hi:[1,0,0]
v_pk_fma_f32 v[90:91], v[90:91], v[70:71], v[72:73] op_sel_hi:[1,0,0]
v_pk_fma_f32 v[92:93], v[92:93], v[70:71], v[72:73] op_sel_hi:[1,0,0]
v_pk_fma_f32 v[94:95], v[94:95], v[70:71], v[72:73] op_sel_hi:[1,0,0]
v_cvt_pk_bf16_f32 v44, v88, v89
v_cvt_pk_bf16_f32 v45, v90, v91
v_cvt_pk_bf16_f32 v46, v92, v93
v_cvt_pk_bf16_f32 v47, v94, v95
ds_write_b128 v74, v[44:47] offset:45056
v_lshlrev_b32 v80, 16, v48
v_and_b32 v81, 0xffff0000, v48
v_lshlrev_b32 v82, 16, v49
v_and_b32 v83, 0xffff0000, v49
v_lshlrev_b32 v84, 16, v50
v_and_b32 v85, 0xffff0000, v50
v_lshlrev_b32 v86, 16, v51
v_and_b32 v87, 0xffff0000, v51
v_pk_fma_f32 v[80:81], v[80:81], v[70:71], v[72:73] op_sel_hi:[1,0,0]
v_pk_fma_f32 v[82:83], v[82:83], v[70:71], v[72:73] op_sel_hi:[1,0,0]
v_pk_fma_f32 v[84:85], v[84:85], v[70:71], v[72:73] op_sel_hi:[1,0,0]
v_pk_fma_f32 v[86:87], v[86:87], v[70:71], v[72:73] op_sel_hi:[1,0,0]
v_cvt_pk_bf16_f32 v48, v80, v81
v_cvt_pk_bf16_f32 v49, v82, v83
v_cvt_pk_bf16_f32 v50, v84, v85
v_cvt_pk_bf16_f32 v51, v86, v87
ds_write_b128 v74, v[48:51] offset:49152
v_lshlrev_b32 v88, 16, v52
v_and_b32 v89, 0xffff0000, v52
v_lshlrev_b32 v90, 16, v53
v_and_b32 v91, 0xffff0000, v53
v_lshlrev_b32 v92, 16, v54
v_and_b32 v93, 0xffff0000, v54
v_lshlrev_b32 v94, 16, v55
v_and_b32 v95, 0xffff0000, v55
v_pk_fma_f32 v[88:89], v[88:89], v[70:71], v[72:73] op_sel_hi:[1,0,0]
v_pk_fma_f32 v[90:91], v[90:91], v[70:71], v[72:73] op_sel_hi:[1,0,0]
v_pk_fma_f32 v[92:93], v[92:93], v[70:71], v[72:73] op_sel_hi:[1,0,0]
v_pk_fma_f32 v[94:95], v[94:95], v[70:71], v[72:73] op_sel_hi:[1,0,0]
v_cvt_pk_bf16_f32 v52, v88, v89
v_cvt_pk_bf16_f32 v53, v90, v91
v_cvt_pk_bf16_f32 v54, v92, v93
v_cvt_pk_bf16_f32 v55, v94, v95
ds_write_b128 v74, v[52:55] offset:53248
v_lshlrev_b32 v80, 16, v56
v_and_b32 v81, 0xffff0000, v56
v_lshlrev_b32 v82, 16, v57
v_and_b32 v83, 0xffff0000, v57
v_lshlrev_b32 v84, 16, v58
v_and_b32 v85, 0xffff0000, v58
v_lshlrev_b32 v86, 16, v59
v_and_b32 v87, 0xffff0000, v59
v_pk_fma_f32 v[80:81], v[80:81], v[70:71], v[72:73] op_sel_hi:[1,0,0]
v_pk_fma_f32 v[82:83], v[82:83], v[70:71], v[72:73] op_sel_hi:[1,0,0]
v_pk_fma_f32 v[84:85], v[84:85], v[70:71], v[72:73] op_sel_hi:[1,0,0]
v_pk_fma_f32 v[86:87], v[86:87], v[70:71], v[72:73] op_sel_hi:[1,0,0]
v_cvt_pk_bf16_f32 v56, v80, v81
v_cvt_pk_bf16_f32 v57, v82, v83
v_cvt_pk_bf16_f32 v58, v84, v85
v_cvt_pk_bf16_f32 v59, v86, v87
ds_write_b128 v74, v[56:59] offset:57344
v_lshlrev_b32 v88, 16, v60
v_and_b32 v89, 0xffff0000, v60
v_lshlrev_b32 v90, 16, v61
v_and_b32 v91, 0xffff0000, v61
v_lshlrev_b32 v92, 16, v62
v_and_b32 v93, 0xffff0000, v62
v_lshlrev_b32 v94, 16, v63
v_and_b32 v95, 0xffff0000, v63
v_pk_fma_f32 v[88:89], v[88:89], v[70:71], v[72:73] op_sel_hi:[1,0,0]
v_pk_fma_f32 v[90:91], v[90:91], v[70:71], v[72:73] op_sel_hi:[1,0,0]
v_pk_fma_f32 v[92:93], v[92:93], v[70:71], v[72:73] op_sel_hi:[1,0,0]
v_pk_fma_f32 v[94:95], v[94:95], v[70:71], v[72:73] op_sel_hi:[1,0,0]
v_cvt_pk_bf16_f32 v60, v88, v89
v_cvt_pk_bf16_f32 v61, v90, v91
v_cvt_pk_bf16_f32 v62, v92, v93
v_cvt_pk_bf16_f32 v63, v94, v95
ds_write_b128 v74, v[60:63] offset:61440
s_lshl_b32 s62, s4, 3
s_cmp_eq_u32 s5, 0
s_cselect_b32 s7, s62, 0x7ff00000
v_mov_b32 v77, 0x7ff00000
v_cmp_eq_u32 vcc, 0, v232
v_mov_b32 v79, s7
s_nop 0
v_cndmask_b32 v77, v77, v79, vcc
v_mov_b32 v78, 1
s_waitcnt vmcnt(24)
buffer_atomic_add v78, v77, s[68:71], 0 offen sc1
s_bfe_u32 s62, s101, 0x20000
s_cmp_eq_u32 s62, 0
s_cbranch_scc0 L_pfa
s_lshl_b32 s6, s101, 17
buffer_load_dword v200, v242, s[12:15], s6 offen
buffer_load_dword v201, v243, s[12:15], s6 offen offset:1024
s_lshl_b32 s6, s101, 17
s_add_u32 s6, s6, 0x80
buffer_load_dword v204, v242, s[12:15], s6 offen
buffer_load_dword v205, v243, s[12:15], s6 offen offset:1024
s_lshl_b32 s6, s101, 14
s_cmp_ge_u32 s101, 14
s_cselect_b32 s63, 0x37f80, 0
s_sub_u32 s6, s6, s63
s_add_u32 s6, s6, s54
s_cmp_ge_u32 s101, 28
s_cselect_b32 s6, 0x7ff00000, s6
buffer_load_dword v208, v244, s[28:31], s6 offen
buffer_load_dword v209, v245, s[28:31], s6 offen offset:1024
s_lshr_b32 s6, s101, 1
s_lshl_b32 s6, s6, 13
s_lshl_b32 s63, s5, 11
s_add_u32 s6, s6, s63
s_mul_i32 s63, s3, 0x80000
s_add_u32 s6, s6, s63
s_add_u32 s6, s6, 0x60000
v_lshlrev_b32 v215, 3, v248
v_and_b32 v215, 0x780, v215
s_and_b32 s63, s101, 1
s_cmp_eq_u32 s63, 0
s_cselect_b32 s44, s32, s36
s_cselect_b32 s45, s33, s37
s_cselect_b32 s46, s34, s38
s_mov_b32 s47, 0x20000
buffer_load_dword v212, v215, s[44:47], s6 offen
L_pfa:
s_waitcnt lgkmcnt(0)
s_barrier
s_waitcnt vmcnt(20)
ds_read_b64_tr_b16 v[224:225], v249
ds_read_b64_tr_b16 v[226:227], v249 offset:512
ds_read_b128 a[0:3], v250
ds_read_b128 a[4:7], v250 offset:1024
ds_read_b128 a[8:11], v250 offset:2048
ds_read_b128 a[12:15], v250 offset:3072
ds_read_b64_tr_b16 v[228:229], v251
ds_read_b64_tr_b16 v[230:231], v251 offset:512
ds_read_b64_tr_b16 v[232:233], v254
ds_read_b64_tr_b16 v[234:235], v254 offset:512
s_waitcnt lgkmcnt(7)
v_mfma_f32_16x16x32_bf16 v[0:3], v[224:227], a[0:3], 0
ds_read_b64_tr_b16 v[236:237], v255
s_waitcnt lgkmcnt(7)
v_mfma_f32_16x16x32_bf16 v[4:7], v[224:227], a[4:7], 0
ds_read_b64_tr_b16 v[238:239], v255 offset:512
s_waitcnt lgkmcnt(7)
v_mfma_f32_16x16x32_bf16 v[8:11], v[224:227], a[8:11], 0
s_waitcnt lgkmcnt(6)
v_mfma_f32_16x16x32_bf16 v[12:15], v[224:227], a[12:15], 0
s_waitcnt vmcnt(16) lgkmcnt(4)
v_mfma_f32_16x16x32_bf16 v[16:19], v[228:231], a[0:3], 0
ds_read_b64_tr_b16 v[224:225], v249 offset:4096
v_mfma_f32_16x16x32_bf16 v[20:23], v[228:231], a[4:7], 0
ds_read_b64_tr_b16 v[226:227], v249 offset:4608
v_mfma_f32_16x16x32_bf16 v[24:27], v[228:231], a[8:11], 0
ds_read_b128 a[16:19], v250 offset:4096
v_mfma_f32_16x16x32_bf16 v[28:31], v[228:231], a[12:15], 0
ds_read_b128 a[20:23], v250 offset:5120
s_waitcnt lgkmcnt(6)
v_mfma_f32_16x16x32_bf16 v[32:35], v[232:235], a[0:3], 0
ds_read_b64_tr_b16 v[228:229], v251 offset:4096
v_mfma_f32_16x16x32_bf16 v[36:39], v[232:235], a[4:7], 0
ds_read_b64_tr_b16 v[230:231], v251 offset:4608
v_mfma_f32_16x16x32_bf16 v[40:43], v[232:235], a[8:11], 0
ds_read_b128 a[24:27], v250 offset:6144
v_mfma_f32_16x16x32_bf16 v[44:47], v[232:235], a[12:15], 0
ds_read_b128 a[28:31], v250 offset:7168
s_waitcnt lgkmcnt(8)
v_mfma_f32_16x16x32_bf16 v[48:51], v[236:239], a[0:3], 0
ds_read_b64_tr_b16 v[232:233], v254 offset:4096
s_add_u32 m0, s48, 0
v_mfma_f32_16x16x32_bf16 v[52:55], v[236:239], a[4:7], 0
ds_read_b64_tr_b16 v[234:235], v254 offset:4608
s_mov_b32 s49, 0x8c000
v_mfma_f32_16x16x32_bf16 v[56:59], v[236:239], a[8:11], 0
buffer_load_dwordx4 v240, s[20:23], s49 offen lds
v_mfma_f32_16x16x32_bf16 v[60:63], v[236:239], a[12:15], 0
buffer_load_dwordx4 v241, s[20:23], s49 offen offset:1024 lds
s_bfe_u32 s62, s101, 0x20000
s_cmp_eq_u32 s62, 1
s_cbranch_scc0 L_pfb
s_lshl_b32 s6, s101, 17
buffer_load_dword v200, v242, s[12:15], s6 offen
buffer_load_dword v201, v243, s[12:15], s6 offen offset:1024
s_lshl_b32 s6, s101, 17
s_add_u32 s6, s6, 0x80
buffer_load_dword v204, v242, s[12:15], s6 offen
buffer_load_dword v205, v243, s[12:15], s6 offen offset:1024
s_lshl_b32 s6, s101, 14
s_cmp_ge_u32 s101, 14
s_cselect_b32 s63, 0x37f80, 0
s_sub_u32 s6, s6, s63
s_add_u32 s6, s6, s54
s_cmp_ge_u32 s101, 28
s_cselect_b32 s6, 0x7ff00000, s6
buffer_load_dword v208, v244, s[28:31], s6 offen
buffer_load_dword v209, v245, s[28:31], s6 offen offset:1024
s_lshr_b32 s6, s101, 1
s_lshl_b32 s6, s6, 13
s_lshl_b32 s63, s5, 11
s_add_u32 s6, s6, s63
s_mul_i32 s63, s3, 0x80000
s_add_u32 s6, s6, s63
s_add_u32 s6, s6, 0x60000
v_lshlrev_b32 v215, 3, v248
v_and_b32 v215, 0x780, v215
s_and_b32 s63, s101, 1
s_cmp_eq_u32 s63, 0
s_cselect_b32 s44, s32, s36
s_cselect_b32 s45, s33, s37
s_cselect_b32 s46, s34, s38
s_mov_b32 s47, 0x20000
buffer_load_dword v212, v215, s[44:47], s6 offen
L_pfb:
s_waitcnt lgkmcnt(7)
v_mfma_f32_16x16x32_bf16 v[0:3], v[224:227], a[16:19], v[0:3]
ds_read_b64_tr_b16 v[236:237], v255 offset:4096
s_add_u32 m0, s48, 0x800
s_waitcnt lgkmcnt(7)
v_mfma_f32_16x16x32_bf16 v[4:7], v[224:227], a[20:23], v[4:7]
ds_read_b64_tr_b16 v[238:239], v255 offset:4608
s_mov_b32 s49, 0x9a000
s_waitcnt lgkmcnt(5)
v_mfma_f32_16x16x32_bf16 v[8:11], v[224:227], a[24:27], v[8:11]
buffer_load_dwordx4 v240, s[20:23], s49 offen lds
s_waitcnt lgkmcnt(4)
v_mfma_f32_16x16x32_bf16 v[12:15], v[224:227], a[28:31], v[12:15]
buffer_load_dwordx4 v241, s[20:23], s49 offen offset:1024 lds
s_waitcnt vmcnt(16)
v_mfma_f32_16x16x32_bf16 v[16:19], v[228:231], a[16:19], v[16:19]
ds_read_b64_tr_b16 v[224:225], v249 offset:8192
v_mfma_f32_16x16x32_bf16 v[20:23], v[228:231], a[20:23], v[20:23]
ds_read_b64_tr_b16 v[226:227], v249 offset:8704
v_mfma_f32_16x16x32_bf16 v[24:27], v[228:231], a[24:27], v[24:27]
ds_read_b128 a[32:35], v250 offset:8192
v_mfma_f32_16x16x32_bf16 v[28:31], v[228:231], a[28:31], v[28:31]
ds_read_b128 a[36:39], v250 offset:9216
s_waitcnt lgkmcnt(6)
v_mfma_f32_16x16x32_bf16 v[32:35], v[232:235], a[16:19], v[32:35]
ds_read_b64_tr_b16 v[228:229], v251 offset:8192
v_mfma_f32_16x16x32_bf16 v[36:39], v[232:235], a[20:23], v[36:39]
ds_read_b64_tr_b16 v[230:231], v251 offset:8704
v_mfma_f32_16x16x32_bf16 v[40:43], v[232:235], a[24:27], v[40:43]
ds_read_b128 a[40:43], v250 offset:10240
v_mfma_f32_16x16x32_bf16 v[44:47], v[232:235], a[28:31], v[44:47]
ds_read_b128 a[44:47], v250 offset:11264
s_waitcnt lgkmcnt(8)
v_mfma_f32_16x16x32_bf16 v[48:51], v[236:239], a[16:19], v[48:51]
ds_read_b64_tr_b16 v[232:233], v254 offset:8192
s_add_u32 m0, s48, 0x1000
v_mfma_f32_16x16x32_bf16 v[52:55], v[236:239], a[20:23], v[52:55]
ds_read_b64_tr_b16 v[234:235], v254 offset:8704
s_mov_b32 s49, 0xa8000
v_mfma_f32_16x16x32_bf16 v[56:59], v[236:239], a[24:27], v[56:59]
buffer_load_dwordx4 v240, s[20:23], s49 offen lds
v_mfma_f32_16x16x32_bf16 v[60:63], v[236:239], a[28:31], v[60:63]
buffer_load_dwordx4 v241, s[20:23], s49 offen offset:1024 lds
s_waitcnt lgkmcnt(7)
v_mfma_f32_16x16x32_bf16 v[0:3], v[224:227], a[32:35], v[0:3]
ds_read_b64_tr_b16 v[236:237], v255 offset:8192
s_add_u32 m0, s48, 0x1800
s_waitcnt lgkmcnt(7)
v_mfma_f32_16x16x32_bf16 v[4:7], v[224:227], a[36:39], v[4:7]
ds_read_b64_tr_b16 v[238:239], v255 offset:8704
s_mov_b32 s49, 0xb6000
s_waitcnt lgkmcnt(5)
v_mfma_f32_16x16x32_bf16 v[8:11], v[224:227], a[40:43], v[8:11]
buffer_load_dwordx4 v240, s[20:23], s49 offen lds
s_waitcnt lgkmcnt(4)
v_mfma_f32_16x16x32_bf16 v[12:15], v[224:227], a[44:47], v[12:15]
buffer_load_dwordx4 v241, s[20:23], s49 offen offset:1024 lds
s_waitcnt vmcnt(16)
v_mfma_f32_16x16x32_bf16 v[16:19], v[228:231], a[32:35], v[16:19]
ds_read_b64_tr_b16 v[224:225], v249 offset:12288
v_mfma_f32_16x16x32_bf16 v[20:23], v[228:231], a[36:39], v[20:23]
ds_read_b64_tr_b16 v[226:227], v249 offset:12800
v_mfma_f32_16x16x32_bf16 v[24:27], v[228:231], a[40:43], v[24:27]
ds_read_b128 a[48:51], v250 offset:12288
v_mfma_f32_16x16x32_bf16 v[28:31], v[228:231], a[44:47], v[28:31]
ds_read_b128 a[52:55], v250 offset:13312
s_waitcnt lgkmcnt(6)
v_mfma_f32_16x16x32_bf16 v[32:35], v[232:235], a[32:35], v[32:35]
ds_read_b64_tr_b16 v[228:229], v251 offset:12288
v_mfma_f32_16x16x32_bf16 v[36:39], v[232:235], a[36:39], v[36:39]
ds_read_b64_tr_b16 v[230:231], v251 offset:12800
v_mfma_f32_16x16x32_bf16 v[40:43], v[232:235], a[40:43], v[40:43]
ds_read_b128 a[56:59], v250 offset:14336
v_mfma_f32_16x16x32_bf16 v[44:47], v[232:235], a[44:47], v[44:47]
ds_read_b128 a[60:63], v250 offset:15360
s_waitcnt lgkmcnt(8)
v_mfma_f32_16x16x32_bf16 v[48:51], v[236:239], a[32:35], v[48:51]
ds_read_b64_tr_b16 v[232:233], v254 offset:12288
s_add_u32 m0, s48, 0x2000
v_mfma_f32_16x16x32_bf16 v[52:55], v[236:239], a[36:39], v[52:55]
ds_read_b64_tr_b16 v[234:235], v254 offset:12800
s_mov_b32 s49, 0xc4000
v_mfma_f32_16x16x32_bf16 v[56:59], v[236:239], a[40:43], v[56:59]
buffer_load_dwordx4 v240, s[20:23], s49 offen lds
v_mfma_f32_16x16x32_bf16 v[60:63], v[236:239], a[44:47], v[60:63]
buffer_load_dwordx4 v241, s[20:23], s49 offen offset:1024 lds
s_waitcnt lgkmcnt(7)
v_mfma_f32_16x16x32_bf16 v[0:3], v[224:227], a[48:51], v[0:3]
ds_read_b64_tr_b16 v[236:237], v255 offset:12288
s_add_u32 m0, s48, 0x2800
s_waitcnt lgkmcnt(7)
v_mfma_f32_16x16x32_bf16 v[4:7], v[224:227], a[52:55], v[4:7]
ds_read_b64_tr_b16 v[238:239], v255 offset:12800
s_mov_b32 s49, 0xd2000
s_waitcnt lgkmcnt(5)
v_mfma_f32_16x16x32_bf16 v[8:11], v[224:227], a[56:59], v[8:11]
buffer_load_dwordx4 v240, s[20:23], s49 offen lds
s_waitcnt lgkmcnt(4)
v_mfma_f32_16x16x32_bf16 v[12:15], v[224:227], a[60:63], v[12:15]
buffer_load_dwordx4 v241, s[20:23], s49 offen offset:1024 lds
s_waitcnt vmcnt(16)
v_mfma_f32_16x16x32_bf16 v[16:19], v[228:231], a[48:51], v[16:19]
ds_read_b64_tr_b16 v[224:225], v192
v_mfma_f32_16x16x32_bf16 v[20:23], v[228:231], a[52:55], v[20:23]
ds_read_b64_tr_b16 v[226:227], v192 offset:512
v_mfma_f32_16x16x32_bf16 v[24:27], v[228:231], a[56:59], v[24:27]
ds_read_b128 a[64:67], v250 offset:16384
v_mfma_f32_16x16x32_bf16 v[28:31], v[228:231], a[60:63], v[28:31]
ds_read_b128 a[68:71], v250 offset:17408
s_waitcnt lgkmcnt(6)
v_mfma_f32_16x16x32_bf16 v[32:35], v[232:235], a[48:51], v[32:35]
ds_read_b64_tr_b16 v[228:229], v193
v_mfma_f32_16x16x32_bf16 v[36:39], v[232:235], a[52:55], v[36:39]
ds_read_b64_tr_b16 v[230:231], v193 offset:512
v_mfma_f32_16x16x32_bf16 v[40:43], v[232:235], a[56:59], v[40:43]
ds_read_b128 a[72:75], v250 offset:18432
v_mfma_f32_16x16x32_bf16 v[44:47], v[232:235], a[60:63], v[44:47]
ds_read_b128 a[76:79], v250 offset:19456
s_waitcnt lgkmcnt(8)
v_mfma_f32_16x16x32_bf16 v[48:51], v[236:239], a[48:51], v[48:51]
ds_read_b64_tr_b16 v[232:233], v194
s_add_u32 m0, s48, 0x3000
v_mfma_f32_16x16x32_bf16 v[52:55], v[236:239], a[52:55], v[52:55]
ds_read_b64_tr_b16 v[234:235], v194 offset:512
s_mov_b32 s49, 0xe0000
v_mfma_f32_16x16x32_bf16 v[56:59], v[236:239], a[56:59], v[56:59]
buffer_load_dwordx4 v240, s[20:23], s49 offen lds
v_mfma_f32_16x16x32_bf16 v[60:63], v[236:239], a[60:63], v[60:63]
buffer_load_dwordx4 v241, s[20:23], s49 offen offset:1024 lds
s_waitcnt lgkmcnt(7)
v_mfma_f32_16x16x32_bf16 v[0:3], v[224:227], a[64:67], v[0:3]
ds_read_b64_tr_b16 v[236:237], v195
s_add_u32 m0, s48, 0x3800
s_waitcnt lgkmcnt(7)
v_mfma_f32_16x16x32_bf16 v[4:7], v[224:227], a[68:71], v[4:7]
ds_read_b64_tr_b16 v[238:239], v195 offset:512
s_mov_b32 s49, 0xee000
s_waitcnt lgkmcnt(5)
v_mfma_f32_16x16x32_bf16 v[8:11], v[224:227], a[72:75], v[8:11]
buffer_load_dwordx4 v240, s[20:23], s49 offen lds
s_waitcnt lgkmcnt(4)
v_mfma_f32_16x16x32_bf16 v[12:15], v[224:227], a[76:79], v[12:15]
buffer_load_dwordx4 v241, s[20:23], s49 offen offset:1024 lds
s_waitcnt vmcnt(12)
v_mfma_f32_16x16x32_bf16 v[16:19], v[228:231], a[64:67], v[16:19]
ds_read_b64_tr_b16 v[224:225], v249
v_mfma_f32_16x16x32_bf16 v[20:23], v[228:231], a[68:71], v[20:23]
ds_read_b64_tr_b16 v[226:227], v249 offset:512
v_mfma_f32_16x16x32_bf16 v[24:27], v[228:231], a[72:75], v[24:27]
ds_read_b128 a[80:83], v250 offset:20480
v_mfma_f32_16x16x32_bf16 v[28:31], v[228:231], a[76:79], v[28:31]
ds_read_b128 a[84:87], v250 offset:21504
s_waitcnt lgkmcnt(6)
v_mfma_f32_16x16x32_bf16 v[32:35], v[232:235], a[64:67], v[32:35]
ds_read_b64_tr_b16 v[228:229], v251
v_mfma_f32_16x16x32_bf16 v[36:39], v[232:235], a[68:71], v[36:39]
ds_read_b64_tr_b16 v[230:231], v251 offset:512
v_mfma_f32_16x16x32_bf16 v[40:43], v[232:235], a[72:75], v[40:43]
ds_read_b128 a[88:91], v250 offset:22528
v_mfma_f32_16x16x32_bf16 v[44:47], v[232:235], a[76:79], v[44:47]
ds_read_b128 a[92:95], v250 offset:23552
s_waitcnt lgkmcnt(8)
v_mfma_f32_16x16x32_bf16 v[48:51], v[236:239], a[64:67], v[48:51]
ds_read_b64_tr_b16 v[232:233], v254
s_add_u32 m0, s96, 0
v_mfma_f32_16x16x32_bf16 v[52:55], v[236:239], a[68:71], v[52:55]
ds_read_b64_tr_b16 v[234:235], v254 offset:512
s_mov_b32 s49, 0xfc000
v_mfma_f32_16x16x32_bf16 v[56:59], v[236:239], a[72:75], v[56:59]
buffer_load_dwordx4 v240, s[20:23], s49 offen lds
v_mfma_f32_16x16x32_bf16 v[60:63], v[236:239], a[76:79], v[60:63]
buffer_load_dwordx4 v241, s[20:23], s49 offen offset:1024 lds
s_waitcnt lgkmcnt(7)
v_mfma_f32_16x16x32_bf16 v[0:3], v[224:227], a[80:83], v[0:3]
ds_read_b64_tr_b16 v[236:237], v255
s_add_u32 m0, s96, 0x800
s_waitcnt lgkmcnt(7)
v_mfma_f32_16x16x32_bf16 v[4:7], v[224:227], a[84:87], v[4:7]
ds_read_b64_tr_b16 v[238:239], v255 offset:512
s_mov_b32 s49, 0x10a000
s_waitcnt lgkmcnt(5)
v_mfma_f32_16x16x32_bf16 v[8:11], v[224:227], a[88:91], v[8:11]
buffer_load_dwordx4 v240, s[20:23], s49 offen lds
s_waitcnt lgkmcnt(4)
v_mfma_f32_16x16x32_bf16 v[12:15], v[224:227], a[92:95], v[12:15]
buffer_load_dwordx4 v241, s[20:23], s49 offen offset:1024 lds
s_waitcnt vmcnt(12)
v_mfma_f32_16x16x32_bf16 v[16:19], v[228:231], a[80:83], v[16:19]
ds_read_b64_tr_b16 v[224:225], v249 offset:4096
v_mfma_f32_16x16x32_bf16 v[20:23], v[228:231], a[84:87], v[20:23]
ds_read_b64_tr_b16 v[226:227], v249 offset:4608
v_mfma_f32_16x16x32_bf16 v[24:27], v[228:231], a[88:91], v[24:27]
ds_read_b128 a[96:99], v250 offset:24576
v_mfma_f32_16x16x32_bf16 v[28:31], v[228:231], a[92:95], v[28:31]
ds_read_b128 a[100:103], v250 offset:25600
s_waitcnt lgkmcnt(6)
v_mfma_f32_16x16x32_bf16 v[32:35], v[232:235], a[80:83], v[32:35]
ds_read_b64_tr_b16 v[228:229], v251 offset:4096
v_mfma_f32_16x16x32_bf16 v[36:39], v[232:235], a[84:87], v[36:39]
ds_read_b64_tr_b16 v[230:231], v251 offset:4608
v_mfma_f32_16x16x32_bf16 v[40:43], v[232:235], a[88:91], v[40:43]
ds_read_b128 a[104:107], v250 offset:26624
v_mfma_f32_16x16x32_bf16 v[44:47], v[232:235], a[92:95], v[44:47]
ds_read_b128 a[108:111], v250 offset:27648
s_waitcnt lgkmcnt(8)
v_mfma_f32_16x16x32_bf16 v[48:51], v[236:239], a[80:83], v[48:51]
ds_read_b64_tr_b16 v[232:233], v254 offset:4096
s_add_u32 m0, s48, 0
v_mfma_f32_16x16x32_bf16 v[52:55], v[236:239], a[84:87], v[52:55]
ds_read_b64_tr_b16 v[234:235], v254 offset:4608
s_mov_b32 s49, 0x118000
v_mfma_f32_16x16x32_bf16 v[56:59], v[236:239], a[88:91], v[56:59]
buffer_load_dwordx4 v240, s[20:23], s49 offen lds
v_mfma_f32_16x16x32_bf16 v[60:63], v[236:239], a[92:95], v[60:63]
buffer_load_dwordx4 v241, s[20:23], s49 offen offset:1024 lds
s_bfe_u32 s62, s101, 0x20000
s_cmp_eq_u32 s62, 2
s_cbranch_scc0 L_pfc
s_lshl_b32 s6, s101, 17
buffer_load_dword v200, v242, s[12:15], s6 offen
buffer_load_dword v201, v243, s[12:15], s6 offen offset:1024
s_lshl_b32 s6, s101, 17
s_add_u32 s6, s6, 0x80
buffer_load_dword v204, v242, s[12:15], s6 offen
buffer_load_dword v205, v243, s[12:15], s6 offen offset:1024
s_lshl_b32 s6, s101, 14
s_cmp_ge_u32 s101, 14
s_cselect_b32 s63, 0x37f80, 0
s_sub_u32 s6, s6, s63
s_add_u32 s6, s6, s54
s_cmp_ge_u32 s101, 28
s_cselect_b32 s6, 0x7ff00000, s6
buffer_load_dword v208, v244, s[28:31], s6 offen
buffer_load_dword v209, v245, s[28:31], s6 offen offset:1024
s_lshr_b32 s6, s101, 1
s_lshl_b32 s6, s6, 13
s_lshl_b32 s63, s5, 11
s_add_u32 s6, s6, s63
s_mul_i32 s63, s3, 0x80000
s_add_u32 s6, s6, s63
s_add_u32 s6, s6, 0x60000
v_lshlrev_b32 v215, 3, v248
v_and_b32 v215, 0x780, v215
s_and_b32 s63, s101, 1
s_cmp_eq_u32 s63, 0
s_cselect_b32 s44, s32, s36
s_cselect_b32 s45, s33, s37
s_cselect_b32 s46, s34, s38
s_mov_b32 s47, 0x20000
buffer_load_dword v212, v215, s[44:47], s6 offen
L_pfc:
s_waitcnt lgkmcnt(7)
v_mfma_f32_16x16x32_bf16 v[0:3], v[224:227], a[96:99], v[0:3]
ds_read_b64_tr_b16 v[236:237], v255 offset:4096
s_add_u32 m0, s48, 0x800
s_waitcnt lgkmcnt(7)
v_mfma_f32_16x16x32_bf16 v[4:7], v[224:227], a[100:103], v[4:7]
ds_read_b64_tr_b16 v[238:239], v255 offset:4608
s_mov_b32 s49, 0x126000
s_waitcnt lgkmcnt(5)
v_mfma_f32_16x16x32_bf16 v[8:11], v[224:227], a[104:107], v[8:11]
buffer_load_dwordx4 v240, s[20:23], s49 offen lds
s_waitcnt lgkmcnt(4)
v_mfma_f32_16x16x32_bf16 v[12:15], v[224:227], a[108:111], v[12:15]
buffer_load_dwordx4 v241, s[20:23], s49 offen offset:1024 lds
s_waitcnt vmcnt(12)
v_mfma_f32_16x16x32_bf16 v[16:19], v[228:231], a[96:99], v[16:19]
ds_read_b64_tr_b16 v[224:225], v249 offset:8192
v_mfma_f32_16x16x32_bf16 v[20:23], v[228:231], a[100:103], v[20:23]
ds_read_b64_tr_b16 v[226:227], v249 offset:8704
v_mfma_f32_16x16x32_bf16 v[24:27], v[228:231], a[104:107], v[24:27]
ds_read_b128 a[112:115], v250 offset:28672
v_mfma_f32_16x16x32_bf16 v[28:31], v[228:231], a[108:111], v[28:31]
ds_read_b128 a[116:119], v250 offset:29696
s_waitcnt lgkmcnt(6)
v_mfma_f32_16x16x32_bf16 v[32:35], v[232:235], a[96:99], v[32:35]
ds_read_b64_tr_b16 v[228:229], v251 offset:8192
v_mfma_f32_16x16x32_bf16 v[36:39], v[232:235], a[100:103], v[36:39]
ds_read_b64_tr_b16 v[230:231], v251 offset:8704
v_mfma_f32_16x16x32_bf16 v[40:43], v[232:235], a[104:107], v[40:43]
ds_read_b128 a[120:123], v250 offset:30720
v_mfma_f32_16x16x32_bf16 v[44:47], v[232:235], a[108:111], v[44:47]
ds_read_b128 a[124:127], v250 offset:31744
s_waitcnt lgkmcnt(8)
v_mfma_f32_16x16x32_bf16 v[48:51], v[236:239], a[96:99], v[48:51]
ds_read_b64_tr_b16 v[232:233], v254 offset:8192
s_add_u32 m0, s48, 0x1000
v_mfma_f32_16x16x32_bf16 v[52:55], v[236:239], a[100:103], v[52:55]
ds_read_b64_tr_b16 v[234:235], v254 offset:8704
s_mov_b32 s49, 0x134000
v_mfma_f32_16x16x32_bf16 v[56:59], v[236:239], a[104:107], v[56:59]
buffer_load_dwordx4 v240, s[20:23], s49 offen lds
v_mfma_f32_16x16x32_bf16 v[60:63], v[236:239], a[108:111], v[60:63]
buffer_load_dwordx4 v241, s[20:23], s49 offen offset:1024 lds
s_waitcnt lgkmcnt(7)
v_mfma_f32_16x16x32_bf16 v[0:3], v[224:227], a[112:115], v[0:3]
ds_read_b64_tr_b16 v[236:237], v255 offset:8192
s_add_u32 m0, s48, 0x1800
s_waitcnt lgkmcnt(7)
v_mfma_f32_16x16x32_bf16 v[4:7], v[224:227], a[116:119], v[4:7]
ds_read_b64_tr_b16 v[238:239], v255 offset:8704
s_mov_b32 s49, 0x142000
s_waitcnt lgkmcnt(5)
v_mfma_f32_16x16x32_bf16 v[8:11], v[224:227], a[120:123], v[8:11]
buffer_load_dwordx4 v240, s[20:23], s49 offen lds
s_waitcnt lgkmcnt(4)
v_mfma_f32_16x16x32_bf16 v[12:15], v[224:227], a[124:127], v[12:15]
buffer_load_dwordx4 v241, s[20:23], s49 offen offset:1024 lds
s_waitcnt vmcnt(12)
v_mfma_f32_16x16x32_bf16 v[16:19], v[228:231], a[112:115], v[16:19]
ds_read_b64_tr_b16 v[224:225], v249 offset:12288
v_mfma_f32_16x16x32_bf16 v[20:23], v[228:231], a[116:119], v[20:23]
ds_read_b64_tr_b16 v[226:227], v249 offset:12800
v_mfma_f32_16x16x32_bf16 v[24:27], v[228:231], a[120:123], v[24:27]
ds_read_b128 a[128:131], v250 offset:32768
v_mfma_f32_16x16x32_bf16 v[28:31], v[228:231], a[124:127], v[28:31]
ds_read_b128 a[132:135], v250 offset:33792
s_waitcnt lgkmcnt(6)
v_mfma_f32_16x16x32_bf16 v[32:35], v[232:235], a[112:115], v[32:35]
ds_read_b64_tr_b16 v[228:229], v251 offset:12288
v_mfma_f32_16x16x32_bf16 v[36:39], v[232:235], a[116:119], v[36:39]
ds_read_b64_tr_b16 v[230:231], v251 offset:12800
v_mfma_f32_16x16x32_bf16 v[40:43], v[232:235], a[120:123], v[40:43]
ds_read_b128 a[136:139], v250 offset:34816
v_mfma_f32_16x16x32_bf16 v[44:47], v[232:235], a[124:127], v[44:47]
ds_read_b128 a[140:143], v250 offset:35840
s_waitcnt lgkmcnt(8)
v_mfma_f32_16x16x32_bf16 v[48:51], v[236:239], a[112:115], v[48:51]
ds_read_b64_tr_b16 v[232:233], v254 offset:12288
s_add_u32 m0, s48, 0x2000
v_mfma_f32_16x16x32_bf16 v[52:55], v[236:239], a[116:119], v[52:55]
ds_read_b64_tr_b16 v[234:235], v254 offset:12800
s_mov_b32 s49, 0x150000
v_mfma_f32_16x16x32_bf16 v[56:59], v[236:239], a[120:123], v[56:59]
buffer_load_dwordx4 v240, s[20:23], s49 offen lds
v_mfma_f32_16x16x32_bf16 v[60:63], v[236:239], a[124:127], v[60:63]
buffer_load_dwordx4 v241, s[20:23], s49 offen offset:1024 lds
s_waitcnt lgkmcnt(7)
v_mfma_f32_16x16x32_bf16 v[0:3], v[224:227], a[128:131], v[0:3]
ds_read_b64_tr_b16 v[236:237], v255 offset:12288
s_add_u32 m0, s48, 0x2800
s_waitcnt lgkmcnt(7)
v_mfma_f32_16x16x32_bf16 v[4:7], v[224:227], a[132:135], v[4:7]
ds_read_b64_tr_b16 v[238:239], v255 offset:12800
s_mov_b32 s49, 0x15e000
s_waitcnt lgkmcnt(5)
v_mfma_f32_16x16x32_bf16 v[8:11], v[224:227], a[136:139], v[8:11]
buffer_load_dwordx4 v240, s[20:23], s49 offen lds
s_waitcnt lgkmcnt(4)
v_mfma_f32_16x16x32_bf16 v[12:15], v[224:227], a[140:143], v[12:15]
buffer_load_dwordx4 v241, s[20:23], s49 offen offset:1024 lds
s_waitcnt vmcnt(12)
v_mfma_f32_16x16x32_bf16 v[16:19], v[228:231], a[128:131], v[16:19]
ds_read_b64_tr_b16 v[224:225], v192
v_mfma_f32_16x16x32_bf16 v[20:23], v[228:231], a[132:135], v[20:23]
ds_read_b64_tr_b16 v[226:227], v192 offset:512
v_mfma_f32_16x16x32_bf16 v[24:27], v[228:231], a[136:139], v[24:27]
ds_read_b128 a[144:147], v250 offset:36864
v_mfma_f32_16x16x32_bf16 v[28:31], v[228:231], a[140:143], v[28:31]
ds_read_b128 a[148:151], v250 offset:37888
s_waitcnt lgkmcnt(6)
v_mfma_f32_16x16x32_bf16 v[32:35], v[232:235], a[128:131], v[32:35]
ds_read_b64_tr_b16 v[228:229], v193
v_mfma_f32_16x16x32_bf16 v[36:39], v[232:235], a[132:135], v[36:39]
ds_read_b64_tr_b16 v[230:231], v193 offset:512
v_mfma_f32_16x16x32_bf16 v[40:43], v[232:235], a[136:139], v[40:43]
ds_read_b128 a[152:155], v250 offset:38912
v_mfma_f32_16x16x32_bf16 v[44:47], v[232:235], a[140:143], v[44:47]
ds_read_b128 a[156:159], v250 offset:39936
s_waitcnt lgkmcnt(8)
v_mfma_f32_16x16x32_bf16 v[48:51], v[236:239], a[128:131], v[48:51]
ds_read_b64_tr_b16 v[232:233], v194
s_add_u32 m0, s48, 0x3000
v_mfma_f32_16x16x32_bf16 v[52:55], v[236:239], a[132:135], v[52:55]
ds_read_b64_tr_b16 v[234:235], v194 offset:512
s_mov_b32 s49, 0x16c000
v_mfma_f32_16x16x32_bf16 v[56:59], v[236:239], a[136:139], v[56:59]
buffer_load_dwordx4 v240, s[20:23], s49 offen lds
v_mfma_f32_16x16x32_bf16 v[60:63], v[236:239], a[140:143], v[60:63]
buffer_load_dwordx4 v241, s[20:23], s49 offen offset:1024 lds
s_waitcnt lgkmcnt(7)
v_mfma_f32_16x16x32_bf16 v[0:3], v[224:227], a[144:147], v[0:3]
ds_read_b64_tr_b16 v[236:237], v195
s_add_u32 m0, s48, 0x3800
s_waitcnt lgkmcnt(7)
v_mfma_f32_16x16x32_bf16 v[4:7], v[224:227], a[148:151], v[4:7]
ds_read_b64_tr_b16 v[238:239], v195 offset:512
s_mov_b32 s49, 0x17a000
s_waitcnt lgkmcnt(5)
v_mfma_f32_16x16x32_bf16 v[8:11], v[224:227], a[152:155], v[8:11]
buffer_load_dwordx4 v240, s[20:23], s49 offen lds
s_waitcnt lgkmcnt(4)
v_mfma_f32_16x16x32_bf16 v[12:15], v[224:227], a[156:159], v[12:15]
buffer_load_dwordx4 v241, s[20:23], s49 offen offset:1024 lds
s_waitcnt vmcnt(12)
v_mfma_f32_16x16x32_bf16 v[16:19], v[228:231], a[144:147], v[16:19]
ds_read_b64_tr_b16 v[224:225], v249
v_mfma_f32_16x16x32_bf16 v[20:23], v[228:231], a[148:151], v[20:23]
ds_read_b64_tr_b16 v[226:227], v249 offset:512
v_mfma_f32_16x16x32_bf16 v[24:27], v[228:231], a[152:155], v[24:27]
ds_read_b128 a[160:163], v250 offset:40960
v_mfma_f32_16x16x32_bf16 v[28:31], v[228:231], a[156:159], v[28:31]
ds_read_b128 a[164:167], v250 offset:41984
s_waitcnt lgkmcnt(6)
v_mfma_f32_16x16x32_bf16 v[32:35], v[232:235], a[144:147], v[32:35]
ds_read_b64_tr_b16 v[228:229], v251
v_mfma_f32_16x16x32_bf16 v[36:39], v[232:235], a[148:151], v[36:39]
ds_read_b64_tr_b16 v[230:231], v251 offset:512
v_mfma_f32_16x16x32_bf16 v[40:43], v[232:235], a[152:155], v[40:43]
ds_read_b128 a[168:171], v250 offset:43008
v_mfma_f32_16x16x32_bf16 v[44:47], v[232:235], a[156:159], v[44:47]
ds_read_b128 a[172:175], v250 offset:44032
s_waitcnt lgkmcnt(8)
v_mfma_f32_16x16x32_bf16 v[48:51], v[236:239], a[144:147], v[48:51]
ds_read_b64_tr_b16 v[232:233], v254
s_add_u32 m0, s96, 0
v_mfma_f32_16x16x32_bf16 v[52:55], v[236:239], a[148:151], v[52:55]
ds_read_b64_tr_b16 v[234:235], v254 offset:512
s_mov_b32 s49, 0x188000
v_mfma_f32_16x16x32_bf16 v[56:59], v[236:239], a[152:155], v[56:59]
buffer_load_dwordx4 v240, s[20:23], s49 offen lds
v_mfma_f32_16x16x32_bf16 v[60:63], v[236:239], a[156:159], v[60:63]
buffer_load_dwordx4 v241, s[20:23], s49 offen offset:1024 lds
s_bfe_u32 s62, s101, 0x20000
s_cmp_eq_u32 s62, 3
s_cbranch_scc0 L_pfd
s_lshl_b32 s6, s101, 17
buffer_load_dword v200, v242, s[12:15], s6 offen
buffer_load_dword v201, v243, s[12:15], s6 offen offset:1024
s_lshl_b32 s6, s101, 17
s_add_u32 s6, s6, 0x80
buffer_load_dword v204, v242, s[12:15], s6 offen
buffer_load_dword v205, v243, s[12:15], s6 offen offset:1024
s_lshl_b32 s6, s101, 14
s_cmp_ge_u32 s101, 14
s_cselect_b32 s63, 0x37f80, 0
s_sub_u32 s6, s6, s63
s_add_u32 s6, s6, s54
s_cmp_ge_u32 s101, 28
s_cselect_b32 s6, 0x7ff00000, s6
buffer_load_dword v208, v244, s[28:31], s6 offen
buffer_load_dword v209, v245, s[28:31], s6 offen offset:1024
s_lshr_b32 s6, s101, 1
s_lshl_b32 s6, s6, 13
s_lshl_b32 s63, s5, 11
s_add_u32 s6, s6, s63
s_mul_i32 s63, s3, 0x80000
s_add_u32 s6, s6, s63
s_add_u32 s6, s6, 0x60000
v_lshlrev_b32 v215, 3, v248
v_and_b32 v215, 0x780, v215
s_and_b32 s63, s101, 1
s_cmp_eq_u32 s63, 0
s_cselect_b32 s44, s32, s36
s_cselect_b32 s45, s33, s37
s_cselect_b32 s46, s34, s38
s_mov_b32 s47, 0x20000
buffer_load_dword v212, v215, s[44:47], s6 offen
L_pfd:
s_waitcnt lgkmcnt(7)
v_mfma_f32_16x16x32_bf16 v[0:3], v[224:227], a[160:163], v[0:3]
ds_read_b64_tr_b16 v[236:237], v255
s_add_u32 m0, s96, 0x800
s_waitcnt lgkmcnt(7)
v_mfma_f32_16x16x32_bf16 v[4:7], v[224:227], a[164:167], v[4:7]
ds_read_b64_tr_b16 v[238:239], v255 offset:512
s_mov_b32 s49, 0x196000
s_waitcnt lgkmcnt(5)
v_mfma_f32_16x16x32_bf16 v[8:11], v[224:227], a[168:171], v[8:11]
buffer_load_dwordx4 v240, s[20:23], s49 offen lds
s_waitcnt lgkmcnt(4)
v_mfma_f32_16x16x32_bf16 v[12:15], v[224:227], a[172:175], v[12:15]
buffer_load_dwordx4 v241, s[20:23], s49 offen offset:1024 lds
s_waitcnt vmcnt(12)
v_mfma_f32_16x16x32_bf16 v[16:19], v[228:231], a[160:163], v[16:19]
ds_read_b64_tr_b16 v[224:225], v249 offset:4096
v_mfma_f32_16x16x32_bf16 v[20:23], v[228:231], a[164:167], v[20:23]
ds_read_b64_tr_b16 v[226:227], v249 offset:4608
v_mfma_f32_16x16x32_bf16 v[24:27], v[228:231], a[168:171], v[24:27]
ds_read_b128 a[176:179], v250 offset:45056
v_mfma_f32_16x16x32_bf16 v[28:31], v[228:231], a[172:175], v[28:31]
ds_read_b128 a[180:183], v250 offset:46080
s_waitcnt lgkmcnt(6)
v_mfma_f32_16x16x32_bf16 v[32:35], v[232:235], a[160:163], v[32:35]
ds_read_b64_tr_b16 v[228:229], v251 offset:4096
v_mfma_f32_16x16x32_bf16 v[36:39], v[232:235], a[164:167], v[36:39]
ds_read_b64_tr_b16 v[230:231], v251 offset:4608
v_mfma_f32_16x16x32_bf16 v[40:43], v[232:235], a[168:171], v[40:43]
ds_read_b128 a[184:187], v250 offset:47104
v_mfma_f32_16x16x32_bf16 v[44:47], v[232:235], a[172:175], v[44:47]
ds_read_b128 a[188:191], v250 offset:48128
s_waitcnt lgkmcnt(8)
v_mfma_f32_16x16x32_bf16 v[48:51], v[236:239], a[160:163], v[48:51]
ds_read_b64_tr_b16 v[232:233], v254 offset:4096
s_add_u32 m0, s48, 0
v_mfma_f32_16x16x32_bf16 v[52:55], v[236:239], a[164:167], v[52:55]
ds_read_b64_tr_b16 v[234:235], v254 offset:4608
s_mov_b32 s49, 0x1a4000
v_mfma_f32_16x16x32_bf16 v[56:59], v[236:239], a[168:171], v[56:59]
buffer_load_dwordx4 v240, s[20:23], s49 offen lds
v_mfma_f32_16x16x32_bf16 v[60:63], v[236:239], a[172:175], v[60:63]
buffer_load_dwordx4 v241, s[20:23], s49 offen offset:1024 lds
s_waitcnt lgkmcnt(7)
v_mfma_f32_16x16x32_bf16 v[0:3], v[224:227], a[176:179], v[0:3]
ds_read_b64_tr_b16 v[236:237], v255 offset:4096
s_add_u32 m0, s48, 0x800
s_waitcnt lgkmcnt(7)
v_mfma_f32_16x16x32_bf16 v[4:7], v[224:227], a[180:183], v[4:7]
ds_read_b64_tr_b16 v[238:239], v255 offset:4608
s_mov_b32 s49, 0x1b2000
s_waitcnt lgkmcnt(5)
v_mfma_f32_16x16x32_bf16 v[8:11], v[224:227], a[184:187], v[8:11]
buffer_load_dwordx4 v240, s[20:23], s49 offen lds
s_waitcnt lgkmcnt(4)
v_mfma_f32_16x16x32_bf16 v[12:15], v[224:227], a[188:191], v[12:15]
buffer_load_dwordx4 v241, s[20:23], s49 offen offset:1024 lds
s_waitcnt vmcnt(12)
v_mfma_f32_16x16x32_bf16 v[16:19], v[228:231], a[176:179], v[16:19]
ds_read_b64_tr_b16 v[224:225], v249 offset:8192
v_mfma_f32_16x16x32_bf16 v[20:23], v[228:231], a[180:183], v[20:23]
ds_read_b64_tr_b16 v[226:227], v249 offset:8704
v_mfma_f32_16x16x32_bf16 v[24:27], v[228:231], a[184:187], v[24:27]
ds_read_b128 a[192:195], v250 offset:49152
v_mfma_f32_16x16x32_bf16 v[28:31], v[228:231], a[188:191], v[28:31]
ds_read_b128 a[196:199], v250 offset:50176
s_waitcnt lgkmcnt(6)
v_mfma_f32_16x16x32_bf16 v[32:35], v[232:235], a[176:179], v[32:35]
ds_read_b64_tr_b16 v[228:229], v251 offset:8192
v_mfma_f32_16x16x32_bf16 v[36:39], v[232:235], a[180:183], v[36:39]
ds_read_b64_tr_b16 v[230:231], v251 offset:8704
v_mfma_f32_16x16x32_bf16 v[40:43], v[232:235], a[184:187], v[40:43]
ds_read_b128 a[200:203], v250 offset:51200
v_mfma_f32_16x16x32_bf16 v[44:47], v[232:235], a[188:191], v[44:47]
ds_read_b128 a[204:207], v250 offset:52224
s_waitcnt lgkmcnt(8)
v_mfma_f32_16x16x32_bf16 v[48:51], v[236:239], a[176:179], v[48:51]
ds_read_b64_tr_b16 v[232:233], v254 offset:8192
s_add_u32 m0, s48, 0x1000
v_mfma_f32_16x16x32_bf16 v[52:55], v[236:239], a[180:183], v[52:55]
ds_read_b64_tr_b16 v[234:235], v254 offset:8704
s_mov_b32 s49, 0
v_mfma_f32_16x16x32_bf16 v[56:59], v[236:239], a[184:187], v[56:59]
buffer_load_dwordx4 v240, s[24:27], s49 offen lds
v_mfma_f32_16x16x32_bf16 v[60:63], v[236:239], a[188:191], v[60:63]
buffer_load_dwordx4 v241, s[24:27], s49 offen offset:1024 lds
s_waitcnt lgkmcnt(7)
v_mfma_f32_16x16x32_bf16 v[0:3], v[224:227], a[192:195], v[0:3]
ds_read_b64_tr_b16 v[236:237], v255 offset:8192
s_add_u32 m0, s48, 0x1800
s_waitcnt lgkmcnt(7)
v_mfma_f32_16x16x32_bf16 v[4:7], v[224:227], a[196:199], v[4:7]
ds_read_b64_tr_b16 v[238:239], v255 offset:8704
s_mov_b32 s49, 0xe000
s_waitcnt lgkmcnt(5)
v_mfma_f32_16x16x32_bf16 v[8:11], v[224:227], a[200:203], v[8:11]
buffer_load_dwordx4 v240, s[24:27], s49 offen lds
s_waitcnt lgkmcnt(4)
v_mfma_f32_16x16x32_bf16 v[12:15], v[224:227], a[204:207], v[12:15]
buffer_load_dwordx4 v241, s[24:27], s49 offen offset:1024 lds
s_waitcnt vmcnt(12)
v_mfma_f32_16x16x32_bf16 v[16:19], v[228:231], a[192:195], v[16:19]
ds_read_b64_tr_b16 v[224:225], v249 offset:12288
v_mfma_f32_16x16x32_bf16 v[20:23], v[228:231], a[196:199], v[20:23]
ds_read_b64_tr_b16 v[226:227], v249 offset:12800
v_mfma_f32_16x16x32_bf16 v[24:27], v[228:231], a[200:203], v[24:27]
ds_read_b128 a[208:211], v250 offset:53248
v_mfma_f32_16x16x32_bf16 v[28:31], v[228:231], a[204:207], v[28:31]
ds_read_b128 a[212:215], v250 offset:54272
s_waitcnt lgkmcnt(6)
v_mfma_f32_16x16x32_bf16 v[32:35], v[232:235], a[192:195], v[32:35]
ds_read_b64_tr_b16 v[228:229], v251 offset:12288
v_mfma_f32_16x16x32_bf16 v[36:39], v[232:235], a[196:199], v[36:39]
ds_read_b64_tr_b16 v[230:231], v251 offset:12800
v_mfma_f32_16x16x32_bf16 v[40:43], v[232:235], a[200:203], v[40:43]
ds_read_b128 a[216:219], v250 offset:55296
v_mfma_f32_16x16x32_bf16 v[44:47], v[232:235], a[204:207], v[44:47]
ds_read_b128 a[220:223], v250 offset:56320
s_waitcnt lgkmcnt(8)
v_mfma_f32_16x16x32_bf16 v[48:51], v[236:239], a[192:195], v[48:51]
ds_read_b64_tr_b16 v[232:233], v254 offset:12288
s_add_u32 m0, s48, 0x2000
v_mfma_f32_16x16x32_bf16 v[52:55], v[236:239], a[196:199], v[52:55]
ds_read_b64_tr_b16 v[234:235], v254 offset:12800
s_mov_b32 s49, 0x1c000
v_mfma_f32_16x16x32_bf16 v[56:59], v[236:239], a[200:203], v[56:59]
buffer_load_dwordx4 v240, s[24:27], s49 offen lds
v_mfma_f32_16x16x32_bf16 v[60:63], v[236:239], a[204:207], v[60:63]
buffer_load_dwordx4 v241, s[24:27], s49 offen offset:1024 lds
s_waitcnt lgkmcnt(7)
v_mfma_f32_16x16x32_bf16 v[0:3], v[224:227], a[208:211], v[0:3]
ds_read_b64_tr_b16 v[236:237], v255 offset:12288
s_add_u32 m0, s48, 0x2800
s_waitcnt lgkmcnt(7)
v_mfma_f32_16x16x32_bf16 v[4:7], v[224:227], a[212:215], v[4:7]
ds_read_b64_tr_b16 v[238:239], v255 offset:12800
s_mov_b32 s49, 0x2a000
s_waitcnt lgkmcnt(5)
v_mfma_f32_16x16x32_bf16 v[8:11], v[224:227], a[216:219], v[8:11]
buffer_load_dwordx4 v240, s[24:27], s49 offen lds
s_waitcnt lgkmcnt(4)
v_mfma_f32_16x16x32_bf16 v[12:15], v[224:227], a[220:223], v[12:15]
buffer_load_dwordx4 v241, s[24:27], s49 offen offset:1024 lds
s_waitcnt vmcnt(12)
v_mfma_f32_16x16x32_bf16 v[16:19], v[228:231], a[208:211], v[16:19]
ds_read_b64_tr_b16 v[224:225], v192
v_mfma_f32_16x16x32_bf16 v[20:23], v[228:231], a[212:215], v[20:23]
ds_read_b64_tr_b16 v[226:227], v192 offset:512
v_mfma_f32_16x16x32_bf16 v[24:27], v[228:231], a[216:219], v[24:27]
ds_read_b128 a[224:227], v250 offset:57344
v_mfma_f32_16x16x32_bf16 v[28:31], v[228:231], a[220:223], v[28:31]
ds_read_b128 a[228:231], v250 offset:58368
s_waitcnt lgkmcnt(6)
v_mfma_f32_16x16x32_bf16 v[32:35], v[232:235], a[208:211], v[32:35]
ds_read_b64_tr_b16 v[228:229], v193
v_mfma_f32_16x16x32_bf16 v[36:39], v[232:235], a[212:215], v[36:39]
ds_read_b64_tr_b16 v[230:231], v193 offset:512
v_mfma_f32_16x16x32_bf16 v[40:43], v[232:235], a[216:219], v[40:43]
ds_read_b128 a[232:235], v250 offset:59392
v_mfma_f32_16x16x32_bf16 v[44:47], v[232:235], a[220:223], v[44:47]
ds_read_b128 a[236:239], v250 offset:60416
s_waitcnt lgkmcnt(8)
v_mfma_f32_16x16x32_bf16 v[48:51], v[236:239], a[208:211], v[48:51]
ds_read_b64_tr_b16 v[232:233], v194
s_add_u32 m0, s48, 0x3000
v_mfma_f32_16x16x32_bf16 v[52:55], v[236:239], a[212:215], v[52:55]
ds_read_b64_tr_b16 v[234:235], v194 offset:512
s_mov_b32 s49, 0x38000
v_mfma_f32_16x16x32_bf16 v[56:59], v[236:239], a[216:219], v[56:59]
buffer_load_dwordx4 v240, s[24:27], s49 offen lds
v_mfma_f32_16x16x32_bf16 v[60:63], v[236:239], a[220:223], v[60:63]
buffer_load_dwordx4 v241, s[24:27], s49 offen offset:1024 lds
s_waitcnt lgkmcnt(7)
v_mfma_f32_16x16x32_bf16 v[0:3], v[224:227], a[224:227], v[0:3]
ds_read_b64_tr_b16 v[236:237], v195
s_add_u32 m0, s48, 0x3800
s_waitcnt lgkmcnt(7)
v_mfma_f32_16x16x32_bf16 v[4:7], v[224:227], a[228:231], v[4:7]
ds_read_b64_tr_b16 v[238:239], v195 offset:512
s_mov_b32 s49, 0x46000
s_waitcnt lgkmcnt(5)
v_mfma_f32_16x16x32_bf16 v[8:11], v[224:227], a[232:235], v[8:11]
buffer_load_dwordx4 v240, s[24:27], s49 offen lds
s_waitcnt lgkmcnt(4)
v_mfma_f32_16x16x32_bf16 v[12:15], v[224:227], a[236:239], v[12:15]
buffer_load_dwordx4 v241, s[24:27], s49 offen offset:1024 lds
s_waitcnt vmcnt(12)
v_mfma_f32_16x16x32_bf16 v[16:19], v[228:231], a[224:227], v[16:19]
ds_read_b64_tr_b16 v[224:225], v249
v_mfma_f32_16x16x32_bf16 v[20:23], v[228:231], a[228:231], v[20:23]
ds_read_b64_tr_b16 v[226:227], v249 offset:512
v_mfma_f32_16x16x32_bf16 v[24:27], v[228:231], a[232:235], v[24:27]
ds_read_b128 a[240:243], v250 offset:61440
v_mfma_f32_16x16x32_bf16 v[28:31], v[228:231], a[236:239], v[28:31]
ds_read_b128 a[244:247], v250 offset:62464
s_waitcnt lgkmcnt(6)
v_mfma_f32_16x16x32_bf16 v[32:35], v[232:235], a[224:227], v[32:35]
ds_read_b64_tr_b16 v[228:229], v251
v_mfma_f32_16x16x32_bf16 v[36:39], v[232:235], a[228:231], v[36:39]
ds_read_b64_tr_b16 v[230:231], v251 offset:512
v_mfma_f32_16x16x32_bf16 v[40:43], v[232:235], a[232:235], v[40:43]
ds_read_b128 a[248:251], v250 offset:63488
v_mfma_f32_16x16x32_bf16 v[44:47], v[232:235], a[236:239], v[44:47]
ds_read_b128 a[252:255], v250 offset:64512
s_waitcnt lgkmcnt(8)
v_mfma_f32_16x16x32_bf16 v[48:51], v[236:239], a[224:227], v[48:51]
ds_read_b64_tr_b16 v[232:233], v254
v_mfma_f32_16x16x32_bf16 v[52:55], v[236:239], a[228:231], v[52:55]
ds_read_b64_tr_b16 v[234:235], v254 offset:512
v_mfma_f32_16x16x32_bf16 v[56:59], v[236:239], a[232:235], v[56:59]
v_mfma_f32_16x16x32_bf16 v[60:63], v[236:239], a[236:239], v[60:63]
s_waitcnt lgkmcnt(7)
v_mfma_f32_16x16x32_bf16 v[0:3], v[224:227], a[240:243], v[0:3]
ds_read_b64_tr_b16 v[236:237], v255
s_waitcnt lgkmcnt(7)
v_mfma_f32_16x16x32_bf16 v[4:7], v[224:227], a[244:247], v[4:7]
ds_read_b64_tr_b16 v[238:239], v255 offset:512
s_waitcnt lgkmcnt(5)
v_mfma_f32_16x16x32_bf16 v[8:11], v[224:227], a[248:251], v[8:11]
s_waitcnt lgkmcnt(4)
v_mfma_f32_16x16x32_bf16 v[12:15], v[224:227], a[252:255], v[12:15]
s_waitcnt vmcnt(8)
v_mfma_f32_16x16x32_bf16 v[16:19], v[228:231], a[240:243], v[16:19]
ds_read_b64_tr_b16 v[224:225], v249 offset:4096
v_mfma_f32_16x16x32_bf16 v[20:23], v[228:231], a[244:247], v[20:23]
ds_read_b64_tr_b16 v[226:227], v249 offset:4608
v_mfma_f32_16x16x32_bf16 v[24:27], v[228:231], a[248:251], v[24:27]
v_mfma_f32_16x16x32_bf16 v[28:31], v[228:231], a[252:255], v[28:31]
s_waitcnt lgkmcnt(4)
v_mfma_f32_16x16x32_bf16 v[32:35], v[232:235], a[240:243], v[32:35]
ds_read_b64_tr_b16 v[228:229], v251 offset:4096
v_mfma_f32_16x16x32_bf16 v[36:39], v[232:235], a[244:247], v[36:39]
ds_read_b64_tr_b16 v[230:231], v251 offset:4608
v_mfma_f32_16x16x32_bf16 v[40:43], v[232:235], a[248:251], v[40:43]
v_mfma_f32_16x16x32_bf16 v[44:47], v[232:235], a[252:255], v[44:47]
s_waitcnt lgkmcnt(4)
v_mfma_f32_16x16x32_bf16 v[48:51], v[236:239], a[240:243], v[48:51]
ds_read_b64_tr_b16 v[232:233], v254 offset:4096
s_add_u32 m0, s48, 0
v_mfma_f32_16x16x32_bf16 v[52:55], v[236:239], a[244:247], v[52:55]
ds_read_b64_tr_b16 v[234:235], v254 offset:4608
s_mov_b32 s49, 0x54000
v_mfma_f32_16x16x32_bf16 v[56:59], v[236:239], a[248:251], v[56:59]
buffer_load_dwordx4 v240, s[24:27], s49 offen lds
v_mfma_f32_16x16x32_bf16 v[60:63], v[236:239], a[252:255], v[60:63]
buffer_load_dwordx4 v241, s[24:27], s49 offen offset:1024 lds
s_barrier
s_waitcnt lgkmcnt(4)
v_mfma_f32_16x16x32_bf16 v[64:67], v[224:227], a[0:3], 0
ds_read_b64_tr_b16 v[236:237], v255 offset:4096
s_add_u32 m0, s48, 0x800
v_mfma_f32_16x16x32_bf16 v[68:71], v[224:227], a[4:7], 0
ds_read_b64_tr_b16 v[238:239], v255 offset:4608
s_mov_b32 s49, 0x62000
v_mfma_f32_16x16x32_bf16 v[72:75], v[224:227], a[8:11], 0
buffer_load_dwordx4 v240, s[24:27], s49 offen lds
v_mfma_f32_16x16x32_bf16 v[76:79], v[224:227], a[12:15], 0
buffer_load_dwordx4 v241, s[24:27], s49 offen offset:1024 lds
s_waitcnt vmcnt(8) lgkmcnt(4)
v_mfma_f32_16x16x32_bf16 v[80:83], v[228:231], a[0:3], 0
ds_read_b64_tr_b16 v[224:225], v249 offset:8192
s_add_u32 m0, s48, 0x1000
v_mfma_f32_16x16x32_bf16 v[84:87], v[228:231], a[4:7], 0
ds_read_b64_tr_b16 v[226:227], v249 offset:8704
s_mov_b32 s49, 0x70000
v_mfma_f32_16x16x32_bf16 v[88:91], v[228:231], a[8:11], 0
s_waitcnt lgkmcnt(2)
buffer_load_dwordx4 v240, s[24:27], s49 offen lds
v_mfma_f32_16x16x32_bf16 v[92:95], v[228:231], a[12:15], 0
buffer_load_dwordx4 v241, s[24:27], s49 offen offset:1024 lds
v_mfma_f32_16x16x32_bf16 v[96:99], v[232:235], a[0:3], 0
ds_read_b64_tr_b16 v[228:229], v251 offset:8192
s_add_u32 m0, s48, 0x1800
v_mfma_f32_16x16x32_bf16 v[100:103], v[232:235], a[4:7], 0
ds_read_b64_tr_b16 v[230:231], v251 offset:8704
s_mov_b32 s49, 0x7e000
v_mfma_f32_16x16x32_bf16 v[104:107], v[232:235], a[8:11], 0
buffer_load_dwordx4 v240, s[24:27], s49 offen lds
v_mfma_f32_16x16x32_bf16 v[108:111], v[232:235], a[12:15], 0
buffer_load_dwordx4 v241, s[24:27], s49 offen offset:1024 lds
v_mfma_f32_16x16x32_bf16 v[112:115], v[236:239], a[0:3], 0
ds_read_b64_tr_b16 v[232:233], v254 offset:8192
v_max_f32 v0, 0, v0
v_mfma_f32_16x16x32_bf16 v[116:119], v[236:239], a[4:7], 0
ds_read_b64_tr_b16 v[234:235], v254 offset:8704
v_max_f32 v1, 0, v1
v_mfma_f32_16x16x32_bf16 v[120:123], v[236:239], a[8:11], 0
v_max_f32 v2, 0, v2
v_max_f32 v3, 0, v3
v_mfma_f32_16x16x32_bf16 v[124:127], v[236:239], a[12:15], 0
v_max_f32 v4, 0, v4
v_max_f32 v5, 0, v5
s_waitcnt lgkmcnt(4)
v_mfma_f32_16x16x32_bf16 v[64:67], v[224:227], a[16:19], v[64:67]
ds_read_b64_tr_b16 v[236:237], v255 offset:8192
v_max_f32 v6, 0, v6
v_mfma_f32_16x16x32_bf16 v[68:71], v[224:227], a[20:23], v[68:71]
ds_read_b64_tr_b16 v[238:239], v255 offset:8704
v_max_f32 v7, 0, v7
v_mfma_f32_16x16x32_bf16 v[72:75], v[224:227], a[24:27], v[72:75]
v_max_f32 v8, 0, v8
v_max_f32 v9, 0, v9
v_mfma_f32_16x16x32_bf16 v[76:79], v[224:227], a[28:31], v[76:79]
v_max_f32 v10, 0, v10
v_max_f32 v11, 0, v11
s_waitcnt vmcnt(8) lgkmcnt(4)
v_mfma_f32_16x16x32_bf16 v[80:83], v[228:231], a[16:19], v[80:83]
ds_read_b64_tr_b16 v[224:225], v249 offset:12288
s_add_u32 m0, s48, 0x2000
v_mfma_f32_16x16x32_bf16 v[84:87], v[228:231], a[20:23], v[84:87]
ds_read_b64_tr_b16 v[226:227], v249 offset:12800
s_mov_b32 s49, 0x8c000
v_mfma_f32_16x16x32_bf16 v[88:91], v[228:231], a[24:27], v[88:91]
s_waitcnt lgkmcnt(2)
buffer_load_dwordx4 v240, s[24:27], s49 offen lds
v_max_f32 v12, 0, v12
v_mfma_f32_16x16x32_bf16 v[92:95], v[228:231], a[28:31], v[92:95]
buffer_load_dwordx4 v241, s[24:27], s49 offen offset:1024 lds
v_max_f32 v13, 0, v13
v_mfma_f32_16x16x32_bf16 v[96:99], v[232:235], a[16:19], v[96:99]
ds_read_b64_tr_b16 v[228:229], v251 offset:12288
s_add_u32 m0, s48, 0x2800
v_mfma_f32_16x16x32_bf16 v[100:103], v[232:235], a[20:23], v[100:103]
ds_read_b64_tr_b16 v[230:231], v251 offset:12800
s_mov_b32 s49, 0x9a000
v_mfma_f32_16x16x32_bf16 v[104:107], v[232:235], a[24:27], v[104:107]
buffer_load_dwordx4 v240, s[24:27], s49 offen lds
v_max_f32 v14, 0, v14
v_mfma_f32_16x16x32_bf16 v[108:111], v[232:235], a[28:31], v[108:111]
buffer_load_dwordx4 v241, s[24:27], s49 offen offset:1024 lds
v_max_f32 v15, 0, v15
v_mfma_f32_16x16x32_bf16 v[112:115], v[236:239], a[16:19], v[112:115]
ds_read_b64_tr_b16 v[232:233], v254 offset:12288
v_max_f32 v16, 0, v16
v_mfma_f32_16x16x32_bf16 v[116:119], v[236:239], a[20:23], v[116:119]
ds_read_b64_tr_b16 v[234:235], v254 offset:12800
v_max_f32 v17, 0, v17
v_mfma_f32_16x16x32_bf16 v[120:123], v[236:239], a[24:27], v[120:123]
v_max_f32 v18, 0, v18
v_max_f32 v19, 0, v19
v_mfma_f32_16x16x32_bf16 v[124:127], v[236:239], a[28:31], v[124:127]
v_max_f32 v20, 0, v20
v_max_f32 v21, 0, v21
s_waitcnt lgkmcnt(4)
v_mfma_f32_16x16x32_bf16 v[64:67], v[224:227], a[32:35], v[64:67]
ds_read_b64_tr_b16 v[236:237], v255 offset:12288
v_max_f32 v22, 0, v22
v_mfma_f32_16x16x32_bf16 v[68:71], v[224:227], a[36:39], v[68:71]
ds_read_b64_tr_b16 v[238:239], v255 offset:12800
v_max_f32 v23, 0, v23
v_mfma_f32_16x16x32_bf16 v[72:75], v[224:227], a[40:43], v[72:75]
v_max_f32 v24, 0, v24
v_max_f32 v25, 0, v25
v_mfma_f32_16x16x32_bf16 v[76:79], v[224:227], a[44:47], v[76:79]
v_max_f32 v26, 0, v26
v_max_f32 v27, 0, v27
s_waitcnt vmcnt(8) lgkmcnt(4)
v_mfma_f32_16x16x32_bf16 v[80:83], v[228:231], a[32:35], v[80:83]
ds_read_b64_tr_b16 v[224:225], v249
s_add_u32 m0, s48, 0x3000
v_mfma_f32_16x16x32_bf16 v[84:87], v[228:231], a[36:39], v[84:87]
ds_read_b64_tr_b16 v[226:227], v249 offset:512
s_mov_b32 s49, 0xa8000
v_mfma_f32_16x16x32_bf16 v[88:91], v[228:231], a[40:43], v[88:91]
s_waitcnt lgkmcnt(2)
buffer_load_dwordx4 v240, s[24:27], s49 offen lds
v_max_f32 v28, 0, v28
v_mfma_f32_16x16x32_bf16 v[92:95], v[228:231], a[44:47], v[92:95]
buffer_load_dwordx4 v241, s[24:27], s49 offen offset:1024 lds
v_max_f32 v29, 0, v29
v_mfma_f32_16x16x32_bf16 v[96:99], v[232:235], a[32:35], v[96:99]
ds_read_b64_tr_b16 v[228:229], v251
s_add_u32 m0, s48, 0x3800
v_mfma_f32_16x16x32_bf16 v[100:103], v[232:235], a[36:39], v[100:103]
ds_read_b64_tr_b16 v[230:231], v251 offset:512
s_mov_b32 s49, 0xb6000
v_mfma_f32_16x16x32_bf16 v[104:107], v[232:235], a[40:43], v[104:107]
buffer_load_dwordx4 v240, s[24:27], s49 offen lds
v_max_f32 v30, 0, v30
v_mfma_f32_16x16x32_bf16 v[108:111], v[232:235], a[44:47], v[108:111]
buffer_load_dwordx4 v241, s[24:27], s49 offen offset:1024 lds
v_max_f32 v31, 0, v31
v_mfma_f32_16x16x32_bf16 v[112:115], v[236:239], a[32:35], v[112:115]
ds_read_b64_tr_b16 v[232:233], v254
v_max_f32 v32, 0, v32
v_mfma_f32_16x16x32_bf16 v[116:119], v[236:239], a[36:39], v[116:119]
ds_read_b64_tr_b16 v[234:235], v254 offset:512
v_max_f32 v33, 0, v33
v_mfma_f32_16x16x32_bf16 v[120:123], v[236:239], a[40:43], v[120:123]
v_max_f32 v34, 0, v34
v_max_f32 v35, 0, v35
v_mfma_f32_16x16x32_bf16 v[124:127], v[236:239], a[44:47], v[124:127]
v_max_f32 v36, 0, v36
v_max_f32 v37, 0, v37
s_waitcnt lgkmcnt(4)
v_mfma_f32_16x16x32_bf16 v[64:67], v[224:227], a[48:51], v[64:67]
ds_read_b64_tr_b16 v[236:237], v255
v_max_f32 v38, 0, v38
v_mfma_f32_16x16x32_bf16 v[68:71], v[224:227], a[52:55], v[68:71]
ds_read_b64_tr_b16 v[238:239], v255 offset:512
v_max_f32 v39, 0, v39
v_mfma_f32_16x16x32_bf16 v[72:75], v[224:227], a[56:59], v[72:75]
v_max_f32 v40, 0, v40
v_max_f32 v41, 0, v41
v_mfma_f32_16x16x32_bf16 v[76:79], v[224:227], a[60:63], v[76:79]
v_max_f32 v42, 0, v42
v_max_f32 v43, 0, v43
s_waitcnt vmcnt(8) lgkmcnt(4)
v_mfma_f32_16x16x32_bf16 v[80:83], v[228:231], a[48:51], v[80:83]
ds_read_b64_tr_b16 v[224:225], v249 offset:4096
s_add_u32 m0, s48, 0
v_mfma_f32_16x16x32_bf16 v[84:87], v[228:231], a[52:55], v[84:87]
ds_read_b64_tr_b16 v[226:227], v249 offset:4608
s_mov_b32 s49, 0xc4000
v_mfma_f32_16x16x32_bf16 v[88:91], v[228:231], a[56:59], v[88:91]
s_waitcnt lgkmcnt(2)
buffer_load_dwordx4 v240, s[24:27], s49 offen lds
v_max_f32 v44, 0, v44
v_mfma_f32_16x16x32_bf16 v[92:95], v[228:231], a[60:63], v[92:95]
buffer_load_dwordx4 v241, s[24:27], s49 offen offset:1024 lds
v_max_f32 v45, 0, v45
v_mfma_f32_16x16x32_bf16 v[96:99], v[232:235], a[48:51], v[96:99]
ds_read_b64_tr_b16 v[228:229], v251 offset:4096
s_add_u32 m0, s48, 0x800
v_mfma_f32_16x16x32_bf16 v[100:103], v[232:235], a[52:55], v[100:103]
ds_read_b64_tr_b16 v[230:231], v251 offset:4608
s_mov_b32 s49, 0xd2000
v_mfma_f32_16x16x32_bf16 v[104:107], v[232:235], a[56:59], v[104:107]
buffer_load_dwordx4 v240, s[24:27], s49 offen lds
v_max_f32 v46, 0, v46
v_mfma_f32_16x16x32_bf16 v[108:111], v[232:235], a[60:63], v[108:111]
buffer_load_dwordx4 v241, s[24:27], s49 offen offset:1024 lds
v_max_f32 v47, 0, v47
v_mfma_f32_16x16x32_bf16 v[112:115], v[236:239], a[48:51], v[112:115]
ds_read_b64_tr_b16 v[232:233], v254 offset:4096
v_max_f32 v48, 0, v48
v_mfma_f32_16x16x32_bf16 v[116:119], v[236:239], a[52:55], v[116:119]
ds_read_b64_tr_b16 v[234:235], v254 offset:4608
v_max_f32 v49, 0, v49
v_mfma_f32_16x16x32_bf16 v[120:123], v[236:239], a[56:59], v[120:123]
v_max_f32 v50, 0, v50
v_max_f32 v51, 0, v51
v_mfma_f32_16x16x32_bf16 v[124:127], v[236:239], a[60:63], v[124:127]
v_max_f32 v52, 0, v52
v_max_f32 v53, 0, v53
s_waitcnt lgkmcnt(4)
v_mfma_f32_16x16x32_bf16 v[64:67], v[224:227], a[64:67], v[64:67]
ds_read_b64_tr_b16 v[236:237], v255 offset:4096
v_max_f32 v54, 0, v54
v_mfma_f32_16x16x32_bf16 v[68:71], v[224:227], a[68:71], v[68:71]
ds_read_b64_tr_b16 v[238:239], v255 offset:4608
v_max_f32 v55, 0, v55
v_mfma_f32_16x16x32_bf16 v[72:75], v[224:227], a[72:75], v[72:75]
v_max_f32 v56, 0, v56
v_max_f32 v57, 0, v57
v_mfma_f32_16x16x32_bf16 v[76:79], v[224:227], a[76:79], v[76:79]
v_max_f32 v58, 0, v58
v_max_f32 v59, 0, v59
s_waitcnt vmcnt(8) lgkmcnt(4)
v_mfma_f32_16x16x32_bf16 v[80:83], v[228:231], a[64:67], v[80:83]
ds_read_b64_tr_b16 v[224:225], v249 offset:8192
s_add_u32 m0, s48, 0x1000
v_mfma_f32_16x16x32_bf16 v[84:87], v[228:231], a[68:71], v[84:87]
ds_read_b64_tr_b16 v[226:227], v249 offset:8704
s_mov_b32 s49, 0xe0000
v_mfma_f32_16x16x32_bf16 v[88:91], v[228:231], a[72:75], v[88:91]
s_waitcnt lgkmcnt(2)
buffer_load_dwordx4 v240, s[24:27], s49 offen lds
v_max_f32 v60, 0, v60
v_mfma_f32_16x16x32_bf16 v[92:95], v[228:231], a[76:79], v[92:95]
buffer_load_dwordx4 v241, s[24:27], s49 offen offset:1024 lds
v_max_f32 v61, 0, v61
v_mfma_f32_16x16x32_bf16 v[96:99], v[232:235], a[64:67], v[96:99]
ds_read_b64_tr_b16 v[228:229], v251 offset:8192
s_add_u32 m0, s48, 0x1800
v_mfma_f32_16x16x32_bf16 v[100:103], v[232:235], a[68:71], v[100:103]
ds_read_b64_tr_b16 v[230:231], v251 offset:8704
s_mov_b32 s49, 0xee000
v_mfma_f32_16x16x32_bf16 v[104:107], v[232:235], a[72:75], v[104:107]
buffer_load_dwordx4 v240, s[24:27], s49 offen lds
v_max_f32 v62, 0, v62
v_mfma_f32_16x16x32_bf16 v[108:111], v[232:235], a[76:79], v[108:111]
buffer_load_dwordx4 v241, s[24:27], s49 offen offset:1024 lds
v_max_f32 v63, 0, v63
v_mfma_f32_16x16x32_bf16 v[112:115], v[236:239], a[64:67], v[112:115]
ds_read_b64_tr_b16 v[232:233], v254 offset:8192
v_mfma_f32_16x16x32_bf16 v[116:119], v[236:239], a[68:71], v[116:119]
ds_read_b64_tr_b16 v[234:235], v254 offset:8704
v_mfma_f32_16x16x32_bf16 v[120:123], v[236:239], a[72:75], v[120:123]
v_mfma_f32_16x16x32_bf16 v[124:127], v[236:239], a[76:79], v[124:127]
s_waitcnt lgkmcnt(4)
v_mfma_f32_16x16x32_bf16 v[64:67], v[224:227], a[80:83], v[64:67]
ds_read_b64_tr_b16 v[236:237], v255 offset:8192
v_mfma_f32_16x16x32_bf16 v[68:71], v[224:227], a[84:87], v[68:71]
ds_read_b64_tr_b16 v[238:239], v255 offset:8704
v_mfma_f32_16x16x32_bf16 v[72:75], v[224:227], a[88:91], v[72:75]
v_mfma_f32_16x16x32_bf16 v[76:79], v[224:227], a[92:95], v[76:79]
s_waitcnt vmcnt(8) lgkmcnt(4)
v_mfma_f32_16x16x32_bf16 v[80:83], v[228:231], a[80:83], v[80:83]
ds_read_b64_tr_b16 v[224:225], v249 offset:12288
s_add_u32 m0, s48, 0x2000
v_mfma_f32_16x16x32_bf16 v[84:87], v[228:231], a[84:87], v[84:87]
ds_read_b64_tr_b16 v[226:227], v249 offset:12800
s_mov_b32 s49, 0xfc000
v_mfma_f32_16x16x32_bf16 v[88:91], v[228:231], a[88:91], v[88:91]
s_waitcnt lgkmcnt(2)
buffer_load_dwordx4 v240, s[24:27], s49 offen lds
v_mfma_f32_16x16x32_bf16 v[92:95], v[228:231], a[92:95], v[92:95]
buffer_load_dwordx4 v241, s[24:27], s49 offen offset:1024 lds
v_mfma_f32_16x16x32_bf16 v[96:99], v[232:235], a[80:83], v[96:99]
ds_read_b64_tr_b16 v[228:229], v251 offset:12288
s_add_u32 m0, s48, 0x2800
v_mfma_f32_16x16x32_bf16 v[100:103], v[232:235], a[84:87], v[100:103]
ds_read_b64_tr_b16 v[230:231], v251 offset:12800
s_mov_b32 s49, 0x10a000
v_mfma_f32_16x16x32_bf16 v[104:107], v[232:235], a[88:91], v[104:107]
buffer_load_dwordx4 v240, s[24:27], s49 offen lds
v_mfma_f32_16x16x32_bf16 v[108:111], v[232:235], a[92:95], v[108:111]
buffer_load_dwordx4 v241, s[24:27], s49 offen offset:1024 lds
v_mfma_f32_16x16x32_bf16 v[112:115], v[236:239], a[80:83], v[112:115]
ds_read_b64_tr_b16 v[232:233], v254 offset:12288
v_mfma_f32_16x16x32_bf16 v[116:119], v[236:239], a[84:87], v[116:119]
ds_read_b64_tr_b16 v[234:235], v254 offset:12800
v_mfma_f32_16x16x32_bf16 v[120:123], v[236:239], a[88:91], v[120:123]
v_mfma_f32_16x16x32_bf16 v[124:127], v[236:239], a[92:95], v[124:127]
s_waitcnt lgkmcnt(4)
v_mfma_f32_16x16x32_bf16 v[64:67], v[224:227], a[96:99], v[64:67]
ds_read_b64_tr_b16 v[236:237], v255 offset:12288
v_mfma_f32_16x16x32_bf16 v[68:71], v[224:227], a[100:103], v[68:71]
ds_read_b64_tr_b16 v[238:239], v255 offset:12800
v_mfma_f32_16x16x32_bf16 v[72:75], v[224:227], a[104:107], v[72:75]
v_mfma_f32_16x16x32_bf16 v[76:79], v[224:227], a[108:111], v[76:79]
s_waitcnt vmcnt(8) lgkmcnt(4)
v_mfma_f32_16x16x32_bf16 v[80:83], v[228:231], a[96:99], v[80:83]
ds_read_b64_tr_b16 v[224:225], v249
s_add_u32 m0, s48, 0x3000
v_mfma_f32_16x16x32_bf16 v[84:87], v[228:231], a[100:103], v[84:87]
ds_read_b64_tr_b16 v[226:227], v249 offset:512
s_mov_b32 s49, 0x118000
v_mfma_f32_16x16x32_bf16 v[88:91], v[228:231], a[104:107], v[88:91]
s_waitcnt lgkmcnt(2)
buffer_load_dwordx4 v240, s[24:27], s49 offen lds
v_mfma_f32_16x16x32_bf16 v[92:95], v[228:231], a[108:111], v[92:95]
buffer_load_dwordx4 v241, s[24:27], s49 offen offset:1024 lds
v_mfma_f32_16x16x32_bf16 v[96:99], v[232:235], a[96:99], v[96:99]
ds_read_b64_tr_b16 v[228:229], v251
s_add_u32 m0, s48, 0x3800
v_mfma_f32_16x16x32_bf16 v[100:103], v[232:235], a[100:103], v[100:103]
ds_read_b64_tr_b16 v[230:231], v251 offset:512
s_mov_b32 s49, 0x126000
v_mfma_f32_16x16x32_bf16 v[104:107], v[232:235], a[104:107], v[104:107]
buffer_load_dwordx4 v240, s[24:27], s49 offen lds
v_mfma_f32_16x16x32_bf16 v[108:111], v[232:235], a[108:111], v[108:111]
buffer_load_dwordx4 v241, s[24:27], s49 offen offset:1024 lds
v_mfma_f32_16x16x32_bf16 v[112:115], v[236:239], a[96:99], v[112:115]
ds_read_b64_tr_b16 v[232:233], v254
v_mfma_f32_16x16x32_bf16 v[116:119], v[236:239], a[100:103], v[116:119]
ds_read_b64_tr_b16 v[234:235], v254 offset:512
v_mfma_f32_16x16x32_bf16 v[120:123], v[236:239], a[104:107], v[120:123]
v_mfma_f32_16x16x32_bf16 v[124:127], v[236:239], a[108:111], v[124:127]
s_waitcnt lgkmcnt(4)
v_mfma_f32_16x16x32_bf16 v[64:67], v[224:227], a[112:115], v[64:67]
ds_read_b64_tr_b16 v[236:237], v255
v_mfma_f32_16x16x32_bf16 v[68:71], v[224:227], a[116:119], v[68:71]
ds_read_b64_tr_b16 v[238:239], v255 offset:512
v_mfma_f32_16x16x32_bf16 v[72:75], v[224:227], a[120:123], v[72:75]
v_mfma_f32_16x16x32_bf16 v[76:79], v[224:227], a[124:127], v[76:79]
s_waitcnt vmcnt(8) lgkmcnt(4)
v_mfma_f32_16x16x32_bf16 v[80:83], v[228:231], a[112:115], v[80:83]
ds_read_b64_tr_b16 v[224:225], v249 offset:4096
s_add_u32 m0, s48, 0
v_mfma_f32_16x16x32_bf16 v[84:87], v[228:231], a[116:119], v[84:87]
ds_read_b64_tr_b16 v[226:227], v249 offset:4608
s_mov_b32 s49, 0x134000
v_mfma_f32_16x16x32_bf16 v[88:91], v[228:231], a[120:123], v[88:91]
s_waitcnt lgkmcnt(2)
buffer_load_dwordx4 v240, s[24:27], s49 offen lds
v_mfma_f32_16x16x32_bf16 v[92:95], v[228:231], a[124:127], v[92:95]
buffer_load_dwordx4 v241, s[24:27], s49 offen offset:1024 lds
v_mfma_f32_16x16x32_bf16 v[96:99], v[232:235], a[112:115], v[96:99]
ds_read_b64_tr_b16 v[228:229], v251 offset:4096
s_add_u32 m0, s48, 0x800
v_mfma_f32_16x16x32_bf16 v[100:103], v[232:235], a[116:119], v[100:103]
ds_read_b64_tr_b16 v[230:231], v251 offset:4608
s_mov_b32 s49, 0x142000
v_mfma_f32_16x16x32_bf16 v[104:107], v[232:235], a[120:123], v[104:107]
buffer_load_dwordx4 v240, s[24:27], s49 offen lds
v_mfma_f32_16x16x32_bf16 v[108:111], v[232:235], a[124:127], v[108:111]
buffer_load_dwordx4 v241, s[24:27], s49 offen offset:1024 lds
v_mfma_f32_16x16x32_bf16 v[112:115], v[236:239], a[112:115], v[112:115]
ds_read_b64_tr_b16 v[232:233], v254 offset:4096
v_mfma_f32_16x16x32_bf16 v[116:119], v[236:239], a[116:119], v[116:119]
ds_read_b64_tr_b16 v[234:235], v254 offset:4608
v_mfma_f32_16x16x32_bf16 v[120:123], v[236:239], a[120:123], v[120:123]
v_mfma_f32_16x16x32_bf16 v[124:127], v[236:239], a[124:127], v[124:127]
s_waitcnt lgkmcnt(4)
v_mfma_f32_16x16x32_bf16 v[64:67], v[224:227], a[128:131], v[64:67]
ds_read_b64_tr_b16 v[236:237], v255 offset:4096
v_mfma_f32_16x16x32_bf16 v[68:71], v[224:227], a[132:135], v[68:71]
ds_read_b64_tr_b16 v[238:239], v255 offset:4608
v_mfma_f32_16x16x32_bf16 v[72:75], v[224:227], a[136:139], v[72:75]
v_mfma_f32_16x16x32_bf16 v[76:79], v[224:227], a[140:143], v[76:79]
s_waitcnt vmcnt(8) lgkmcnt(4)
v_mfma_f32_16x16x32_bf16 v[80:83], v[228:231], a[128:131], v[80:83]
ds_read_b64_tr_b16 v[224:225], v249 offset:8192
s_add_u32 m0, s48, 0x1000
v_mfma_f32_16x16x32_bf16 v[84:87], v[228:231], a[132:135], v[84:87]
ds_read_b64_tr_b16 v[226:227], v249 offset:8704
s_mov_b32 s49, 0x150000
v_mfma_f32_16x16x32_bf16 v[88:91], v[228:231], a[136:139], v[88:91]
s_waitcnt lgkmcnt(2)
buffer_load_dwordx4 v240, s[24:27], s49 offen lds
v_mfma_f32_16x16x32_bf16 v[92:95], v[228:231], a[140:143], v[92:95]
buffer_load_dwordx4 v241, s[24:27], s49 offen offset:1024 lds
v_mfma_f32_16x16x32_bf16 v[96:99], v[232:235], a[128:131], v[96:99]
ds_read_b64_tr_b16 v[228:229], v251 offset:8192
s_add_u32 m0, s48, 0x1800
v_mfma_f32_16x16x32_bf16 v[100:103], v[232:235], a[132:135], v[100:103]
ds_read_b64_tr_b16 v[230:231], v251 offset:8704
s_mov_b32 s49, 0x15e000
v_mfma_f32_16x16x32_bf16 v[104:107], v[232:235], a[136:139], v[104:107]
buffer_load_dwordx4 v240, s[24:27], s49 offen lds
v_mfma_f32_16x16x32_bf16 v[108:111], v[232:235], a[140:143], v[108:111]
buffer_load_dwordx4 v241, s[24:27], s49 offen offset:1024 lds
v_mfma_f32_16x16x32_bf16 v[112:115], v[236:239], a[128:131], v[112:115]
ds_read_b64_tr_b16 v[232:233], v254 offset:8192
v_mfma_f32_16x16x32_bf16 v[116:119], v[236:239], a[132:135], v[116:119]
ds_read_b64_tr_b16 v[234:235], v254 offset:8704
v_mfma_f32_16x16x32_bf16 v[120:123], v[236:239], a[136:139], v[120:123]
v_mfma_f32_16x16x32_bf16 v[124:127], v[236:239], a[140:143], v[124:127]
s_waitcnt lgkmcnt(4)
v_mfma_f32_16x16x32_bf16 v[64:67], v[224:227], a[144:147], v[64:67]
ds_read_b64_tr_b16 v[236:237], v255 offset:8192
v_mfma_f32_16x16x32_bf16 v[68:71], v[224:227], a[148:151], v[68:71]
ds_read_b64_tr_b16 v[238:239], v255 offset:8704
v_mfma_f32_16x16x32_bf16 v[72:75], v[224:227], a[152:155], v[72:75]
v_mfma_f32_16x16x32_bf16 v[76:79], v[224:227], a[156:159], v[76:79]
s_waitcnt vmcnt(8) lgkmcnt(4)
v_mfma_f32_16x16x32_bf16 v[80:83], v[228:231], a[144:147], v[80:83]
ds_read_b64_tr_b16 v[224:225], v249 offset:12288
s_add_u32 m0, s48, 0x2000
v_mfma_f32_16x16x32_bf16 v[84:87], v[228:231], a[148:151], v[84:87]
ds_read_b64_tr_b16 v[226:227], v249 offset:12800
s_mov_b32 s49, 0x16c000
v_mfma_f32_16x16x32_bf16 v[88:91], v[228:231], a[152:155], v[88:91]
s_waitcnt lgkmcnt(2)
buffer_load_dwordx4 v240, s[24:27], s49 offen lds
v_mfma_f32_16x16x32_bf16 v[92:95], v[228:231], a[156:159], v[92:95]
buffer_load_dwordx4 v241, s[24:27], s49 offen offset:1024 lds
v_mfma_f32_16x16x32_bf16 v[96:99], v[232:235], a[144:147], v[96:99]
ds_read_b64_tr_b16 v[228:229], v251 offset:12288
s_add_u32 m0, s48, 0x2800
v_mfma_f32_16x16x32_bf16 v[100:103], v[232:235], a[148:151], v[100:103]
ds_read_b64_tr_b16 v[230:231], v251 offset:12800
s_mov_b32 s49, 0x17a000
v_mfma_f32_16x16x32_bf16 v[104:107], v[232:235], a[152:155], v[104:107]
buffer_load_dwordx4 v240, s[24:27], s49 offen lds
v_mfma_f32_16x16x32_bf16 v[108:111], v[232:235], a[156:159], v[108:111]
buffer_load_dwordx4 v241, s[24:27], s49 offen offset:1024 lds
v_mfma_f32_16x16x32_bf16 v[112:115], v[236:239], a[144:147], v[112:115]
ds_read_b64_tr_b16 v[232:233], v254 offset:12288
v_mfma_f32_16x16x32_bf16 v[116:119], v[236:239], a[148:151], v[116:119]
ds_read_b64_tr_b16 v[234:235], v254 offset:12800
v_mfma_f32_16x16x32_bf16 v[120:123], v[236:239], a[152:155], v[120:123]
v_mfma_f32_16x16x32_bf16 v[124:127], v[236:239], a[156:159], v[124:127]
s_waitcnt lgkmcnt(4)
v_mfma_f32_16x16x32_bf16 v[64:67], v[224:227], a[160:163], v[64:67]
ds_read_b64_tr_b16 v[236:237], v255 offset:12288
v_mfma_f32_16x16x32_bf16 v[68:71], v[224:227], a[164:167], v[68:71]
ds_read_b64_tr_b16 v[238:239], v255 offset:12800
v_mfma_f32_16x16x32_bf16 v[72:75], v[224:227], a[168:171], v[72:75]
v_mfma_f32_16x16x32_bf16 v[76:79], v[224:227], a[172:175], v[76:79]
s_waitcnt vmcnt(8) lgkmcnt(4)
v_mfma_f32_16x16x32_bf16 v[80:83], v[228:231], a[160:163], v[80:83]
ds_read_b64_tr_b16 v[224:225], v249
s_add_u32 m0, s48, 0x3000
v_mfma_f32_16x16x32_bf16 v[84:87], v[228:231], a[164:167], v[84:87]
ds_read_b64_tr_b16 v[226:227], v249 offset:512
s_mov_b32 s49, 0x188000
v_mfma_f32_16x16x32_bf16 v[88:91], v[228:231], a[168:171], v[88:91]
s_waitcnt lgkmcnt(2)
buffer_load_dwordx4 v240, s[24:27], s49 offen lds
v_mfma_f32_16x16x32_bf16 v[92:95], v[228:231], a[172:175], v[92:95]
buffer_load_dwordx4 v241, s[24:27], s49 offen offset:1024 lds
v_mfma_f32_16x16x32_bf16 v[96:99], v[232:235], a[160:163], v[96:99]
ds_read_b64_tr_b16 v[228:229], v251
s_add_u32 m0, s48, 0x3800
v_mfma_f32_16x16x32_bf16 v[100:103], v[232:235], a[164:167], v[100:103]
ds_read_b64_tr_b16 v[230:231], v251 offset:512
s_mov_b32 s49, 0x196000
v_mfma_f32_16x16x32_bf16 v[104:107], v[232:235], a[168:171], v[104:107]
buffer_load_dwordx4 v240, s[24:27], s49 offen lds
v_mfma_f32_16x16x32_bf16 v[108:111], v[232:235], a[172:175], v[108:111]
buffer_load_dwordx4 v241, s[24:27], s49 offen offset:1024 lds
v_mfma_f32_16x16x32_bf16 v[112:115], v[236:239], a[160:163], v[112:115]
ds_read_b64_tr_b16 v[232:233], v254
v_mfma_f32_16x16x32_bf16 v[116:119], v[236:239], a[164:167], v[116:119]
ds_read_b64_tr_b16 v[234:235], v254 offset:512
v_mfma_f32_16x16x32_bf16 v[120:123], v[236:239], a[168:171], v[120:123]
v_mfma_f32_16x16x32_bf16 v[124:127], v[236:239], a[172:175], v[124:127]
s_waitcnt lgkmcnt(4)
v_mfma_f32_16x16x32_bf16 v[64:67], v[224:227], a[176:179], v[64:67]
ds_read_b64_tr_b16 v[236:237], v255
v_mfma_f32_16x16x32_bf16 v[68:71], v[224:227], a[180:183], v[68:71]
ds_read_b64_tr_b16 v[238:239], v255 offset:512
v_mfma_f32_16x16x32_bf16 v[72:75], v[224:227], a[184:187], v[72:75]
v_mfma_f32_16x16x32_bf16 v[76:79], v[224:227], a[188:191], v[76:79]
s_waitcnt vmcnt(8) lgkmcnt(4)
v_mfma_f32_16x16x32_bf16 v[80:83], v[228:231], a[176:179], v[80:83]
ds_read_b64_tr_b16 v[224:225], v249 offset:4096
s_add_u32 m0, s48, 0
v_mfma_f32_16x16x32_bf16 v[84:87], v[228:231], a[180:183], v[84:87]
ds_read_b64_tr_b16 v[226:227], v249 offset:4608
s_mov_b32 s49, 0x1a4000
v_mfma_f32_16x16x32_bf16 v[88:91], v[228:231], a[184:187], v[88:91]
s_waitcnt lgkmcnt(2)
buffer_load_dwordx4 v240, s[24:27], s49 offen lds
v_mfma_f32_16x16x32_bf16 v[92:95], v[228:231], a[188:191], v[92:95]
buffer_load_dwordx4 v241, s[24:27], s49 offen offset:1024 lds
v_mfma_f32_16x16x32_bf16 v[96:99], v[232:235], a[176:179], v[96:99]
ds_read_b64_tr_b16 v[228:229], v251 offset:4096
s_add_u32 m0, s48, 0x800
v_mfma_f32_16x16x32_bf16 v[100:103], v[232:235], a[180:183], v[100:103]
ds_read_b64_tr_b16 v[230:231], v251 offset:4608
s_mov_b32 s49, 0x1b2000
v_mfma_f32_16x16x32_bf16 v[104:107], v[232:235], a[184:187], v[104:107]
buffer_load_dwordx4 v240, s[24:27], s49 offen lds
v_mfma_f32_16x16x32_bf16 v[108:111], v[232:235], a[188:191], v[108:111]
buffer_load_dwordx4 v241, s[24:27], s49 offen offset:1024 lds
v_mfma_f32_16x16x32_bf16 v[112:115], v[236:239], a[176:179], v[112:115]
ds_read_b64_tr_b16 v[232:233], v254 offset:4096
v_mfma_f32_16x16x32_bf16 v[116:119], v[236:239], a[180:183], v[116:119]
ds_read_b64_tr_b16 v[234:235], v254 offset:4608
v_mfma_f32_16x16x32_bf16 v[120:123], v[236:239], a[184:187], v[120:123]
v_mfma_f32_16x16x32_bf16 v[124:127], v[236:239], a[188:191], v[124:127]
s_waitcnt lgkmcnt(4)
v_mfma_f32_16x16x32_bf16 v[64:67], v[224:227], a[192:195], v[64:67]
ds_read_b64_tr_b16 v[236:237], v255 offset:4096
v_mfma_f32_16x16x32_bf16 v[68:71], v[224:227], a[196:199], v[68:71]
ds_read_b64_tr_b16 v[238:239], v255 offset:4608
v_mfma_f32_16x16x32_bf16 v[72:75], v[224:227], a[200:203], v[72:75]
v_mfma_f32_16x16x32_bf16 v[76:79], v[224:227], a[204:207], v[76:79]
s_waitcnt vmcnt(8) lgkmcnt(4)
v_mfma_f32_16x16x32_bf16 v[80:83], v[228:231], a[192:195], v[80:83]
ds_read_b64_tr_b16 v[224:225], v249 offset:8192
s_add_u32 m0, s48, 0x1000
v_mfma_f32_16x16x32_bf16 v[84:87], v[228:231], a[196:199], v[84:87]
ds_read_b64_tr_b16 v[226:227], v249 offset:8704
s_mov_b32 s49, 0
v_mfma_f32_16x16x32_bf16 v[88:91], v[228:231], a[200:203], v[88:91]
s_waitcnt lgkmcnt(2)
buffer_load_dwordx4 v242, s[12:15], s49 offen lds
v_mfma_f32_16x16x32_bf16 v[92:95], v[228:231], a[204:207], v[92:95]
buffer_load_dwordx4 v243, s[12:15], s49 offen offset:1024 lds
v_mfma_f32_16x16x32_bf16 v[96:99], v[232:235], a[192:195], v[96:99]
ds_read_b64_tr_b16 v[228:229], v251 offset:8192
s_add_u32 m0, s48, 0x1800
v_mfma_f32_16x16x32_bf16 v[100:103], v[232:235], a[196:199], v[100:103]
ds_read_b64_tr_b16 v[230:231], v251 offset:8704
s_mov_b32 s49, 0x20000
v_mfma_f32_16x16x32_bf16 v[104:107], v[232:235], a[200:203], v[104:107]
buffer_load_dwordx4 v242, s[12:15], s49 offen lds
v_mfma_f32_16x16x32_bf16 v[108:111], v[232:235], a[204:207], v[108:111]
buffer_load_dwordx4 v243, s[12:15], s49 offen offset:1024 lds
v_mfma_f32_16x16x32_bf16 v[112:115], v[236:239], a[192:195], v[112:115]
ds_read_b64_tr_b16 v[232:233], v254 offset:8192
v_mfma_f32_16x16x32_bf16 v[116:119], v[236:239], a[196:199], v[116:119]
ds_read_b64_tr_b16 v[234:235], v254 offset:8704
v_mfma_f32_16x16x32_bf16 v[120:123], v[236:239], a[200:203], v[120:123]
v_mfma_f32_16x16x32_bf16 v[124:127], v[236:239], a[204:207], v[124:127]
s_waitcnt lgkmcnt(4)
v_mfma_f32_16x16x32_bf16 v[64:67], v[224:227], a[208:211], v[64:67]
ds_read_b64_tr_b16 v[236:237], v255 offset:8192
v_mfma_f32_16x16x32_bf16 v[68:71], v[224:227], a[212:215], v[68:71]
ds_read_b64_tr_b16 v[238:239], v255 offset:8704
v_mfma_f32_16x16x32_bf16 v[72:75], v[224:227], a[216:219], v[72:75]
v_mfma_f32_16x16x32_bf16 v[76:79], v[224:227], a[220:223], v[76:79]
s_waitcnt vmcnt(8) lgkmcnt(4)
v_mfma_f32_16x16x32_bf16 v[80:83], v[228:231], a[208:211], v[80:83]
ds_read_b64_tr_b16 v[224:225], v249 offset:12288
s_add_u32 m0, s48, 0x2000
v_mfma_f32_16x16x32_bf16 v[84:87], v[228:231], a[212:215], v[84:87]
ds_read_b64_tr_b16 v[226:227], v249 offset:12800
s_mov_b32 s49, 0x40000
v_mfma_f32_16x16x32_bf16 v[88:91], v[228:231], a[216:219], v[88:91]
s_waitcnt lgkmcnt(2)
buffer_load_dwordx4 v242, s[12:15], s49 offen lds
v_mfma_f32_16x16x32_bf16 v[92:95], v[228:231], a[220:223], v[92:95]
buffer_load_dwordx4 v243, s[12:15], s49 offen offset:1024 lds
v_mfma_f32_16x16x32_bf16 v[96:99], v[232:235], a[208:211], v[96:99]
ds_read_b64_tr_b16 v[228:229], v251 offset:12288
s_add_u32 m0, s48, 0x2800
v_mfma_f32_16x16x32_bf16 v[100:103], v[232:235], a[212:215], v[100:103]
ds_read_b64_tr_b16 v[230:231], v251 offset:12800
s_mov_b32 s49, 0x60000
v_mfma_f32_16x16x32_bf16 v[104:107], v[232:235], a[216:219], v[104:107]
buffer_load_dwordx4 v242, s[12:15], s49 offen lds
v_mfma_f32_16x16x32_bf16 v[108:111], v[232:235], a[220:223], v[108:111]
buffer_load_dwordx4 v243, s[12:15], s49 offen offset:1024 lds
v_mfma_f32_16x16x32_bf16 v[112:115], v[236:239], a[208:211], v[112:115]
ds_read_b64_tr_b16 v[232:233], v254 offset:12288
v_mfma_f32_16x16x32_bf16 v[116:119], v[236:239], a[212:215], v[116:119]
ds_read_b64_tr_b16 v[234:235], v254 offset:12800
v_mfma_f32_16x16x32_bf16 v[120:123], v[236:239], a[216:219], v[120:123]
v_mfma_f32_16x16x32_bf16 v[124:127], v[236:239], a[220:223], v[124:127]
s_waitcnt lgkmcnt(4)
v_mfma_f32_16x16x32_bf16 v[64:67], v[224:227], a[224:227], v[64:67]
ds_read_b64_tr_b16 v[236:237], v255 offset:12288
v_mfma_f32_16x16x32_bf16 v[68:71], v[224:227], a[228:231], v[68:71]
ds_read_b64_tr_b16 v[238:239], v255 offset:12800
v_mfma_f32_16x16x32_bf16 v[72:75], v[224:227], a[232:235], v[72:75]
v_mfma_f32_16x16x32_bf16 v[76:79], v[224:227], a[236:239], v[76:79]
s_waitcnt vmcnt(8) lgkmcnt(4)
v_mfma_f32_16x16x32_bf16 v[80:83], v[228:231], a[224:227], v[80:83]
ds_read_b64_tr_b16 v[224:225], v249
s_add_u32 m0, s48, 0x3000
v_mfma_f32_16x16x32_bf16 v[84:87], v[228:231], a[228:231], v[84:87]
ds_read_b64_tr_b16 v[226:227], v249 offset:512
s_mov_b32 s49, 0x80000
v_mfma_f32_16x16x32_bf16 v[88:91], v[228:231], a[232:235], v[88:91]
s_waitcnt lgkmcnt(2)
buffer_load_dwordx4 v242, s[12:15], s49 offen lds
v_mfma_f32_16x16x32_bf16 v[92:95], v[228:231], a[236:239], v[92:95]
buffer_load_dwordx4 v243, s[12:15], s49 offen offset:1024 lds
v_mfma_f32_16x16x32_bf16 v[96:99], v[232:235], a[224:227], v[96:99]
ds_read_b64_tr_b16 v[228:229], v251
s_add_u32 m0, s48, 0x3800
v_mfma_f32_16x16x32_bf16 v[100:103], v[232:235], a[228:231], v[100:103]
ds_read_b64_tr_b16 v[230:231], v251 offset:512
s_mov_b32 s49, 0xa0000
v_mfma_f32_16x16x32_bf16 v[104:107], v[232:235], a[232:235], v[104:107]
buffer_load_dwordx4 v242, s[12:15], s49 offen lds
v_mfma_f32_16x16x32_bf16 v[108:111], v[232:235], a[236:239], v[108:111]
buffer_load_dwordx4 v243, s[12:15], s49 offen offset:1024 lds
v_mfma_f32_16x16x32_bf16 v[112:115], v[236:239], a[224:227], v[112:115]
ds_read_b64_tr_b16 v[232:233], v254
v_mfma_f32_16x16x32_bf16 v[116:119], v[236:239], a[228:231], v[116:119]
ds_read_b64_tr_b16 v[234:235], v254 offset:512
v_mfma_f32_16x16x32_bf16 v[120:123], v[236:239], a[232:235], v[120:123]
v_mfma_f32_16x16x32_bf16 v[124:127], v[236:239], a[236:239], v[124:127]
s_waitcnt lgkmcnt(4)
v_mfma_f32_16x16x32_bf16 v[64:67], v[224:227], a[240:243], v[64:67]
ds_read_b64_tr_b16 v[236:237], v255
v_mfma_f32_16x16x32_bf16 v[68:71], v[224:227], a[244:247], v[68:71]
ds_read_b64_tr_b16 v[238:239], v255 offset:512
v_mfma_f32_16x16x32_bf16 v[72:75], v[224:227], a[248:251], v[72:75]
v_mfma_f32_16x16x32_bf16 v[76:79], v[224:227], a[252:255], v[76:79]
s_waitcnt vmcnt(8) lgkmcnt(4)
v_mfma_f32_16x16x32_bf16 v[80:83], v[228:231], a[240:243], v[80:83]
ds_read_b64_tr_b16 v[224:225], v249 offset:4096
s_add_u32 m0, s48, 0
v_mfma_f32_16x16x32_bf16 v[84:87], v[228:231], a[244:247], v[84:87]
ds_read_b64_tr_b16 v[226:227], v249 offset:4608
s_mov_b32 s49, 0xc0000
v_mfma_f32_16x16x32_bf16 v[88:91], v[228:231], a[248:251], v[88:91]
s_waitcnt lgkmcnt(2)
buffer_load_dwordx4 v242, s[12:15], s49 offen lds
v_mfma_f32_16x16x32_bf16 v[92:95], v[228:231], a[252:255], v[92:95]
buffer_load_dwordx4 v243, s[12:15], s49 offen offset:1024 lds
v_mfma_f32_16x16x32_bf16 v[96:99], v[232:235], a[240:243], v[96:99]
ds_read_b64_tr_b16 v[228:229], v251 offset:4096
s_add_u32 m0, s48, 0x800
v_mfma_f32_16x16x32_bf16 v[100:103], v[232:235], a[244:247], v[100:103]
ds_read_b64_tr_b16 v[230:231], v251 offset:4608
s_mov_b32 s49, 0xe0000
v_mfma_f32_16x16x32_bf16 v[104:107], v[232:235], a[248:251], v[104:107]
buffer_load_dwordx4 v242, s[12:15], s49 offen lds
v_mfma_f32_16x16x32_bf16 v[108:111], v[232:235], a[252:255], v[108:111]
buffer_load_dwordx4 v243, s[12:15], s49 offen offset:1024 lds
v_mfma_f32_16x16x32_bf16 v[112:115], v[236:239], a[240:243], v[112:115]
ds_read_b64_tr_b16 v[232:233], v254 offset:4096
v_mfma_f32_16x16x32_bf16 v[116:119], v[236:239], a[244:247], v[116:119]
ds_read_b64_tr_b16 v[234:235], v254 offset:4608
v_mfma_f32_16x16x32_bf16 v[120:123], v[236:239], a[248:251], v[120:123]
v_mfma_f32_16x16x32_bf16 v[124:127], v[236:239], a[252:255], v[124:127]
s_waitcnt lgkmcnt(4)
v_mfma_f32_16x16x32_bf16 v[128:131], v[224:227], a[0:3], 0
ds_read_b64_tr_b16 v[236:237], v255 offset:4096
v_mfma_f32_16x16x32_bf16 v[132:135], v[224:227], a[4:7], 0
ds_read_b64_tr_b16 v[238:239], v255 offset:4608
v_mfma_f32_16x16x32_bf16 v[136:139], v[224:227], a[8:11], 0
v_mfma_f32_16x16x32_bf16 v[140:143], v[224:227], a[12:15], 0
s_waitcnt vmcnt(8) lgkmcnt(4)
v_mfma_f32_16x16x32_bf16 v[144:147], v[228:231], a[0:3], 0
ds_read_b64_tr_b16 v[224:225], v249 offset:8192
v_mfma_f32_16x16x32_bf16 v[148:151], v[228:231], a[4:7], 0
ds_read_b64_tr_b16 v[226:227], v249 offset:8704
v_mfma_f32_16x16x32_bf16 v[152:155], v[228:231], a[8:11], 0
v_mfma_f32_16x16x32_bf16 v[156:159], v[228:231], a[12:15], 0
s_waitcnt lgkmcnt(4)
v_mfma_f32_16x16x32_bf16 v[160:163], v[232:235], a[0:3], 0
ds_read_b64_tr_b16 v[228:229], v251 offset:8192
v_mfma_f32_16x16x32_bf16 v[164:167], v[232:235], a[4:7], 0
ds_read_b64_tr_b16 v[230:231], v251 offset:8704
v_mfma_f32_16x16x32_bf16 v[168:171], v[232:235], a[8:11], 0
v_mfma_f32_16x16x32_bf16 v[172:175], v[232:235], a[12:15], 0
s_waitcnt lgkmcnt(4)
v_mfma_f32_16x16x32_bf16 v[176:179], v[236:239], a[0:3], 0
ds_read_b64_tr_b16 v[232:233], v254 offset:8192
s_add_u32 m0, s48, 0x1000
v_mfma_f32_16x16x32_bf16 v[180:183], v[236:239], a[4:7], 0
ds_read_b64_tr_b16 v[234:235], v254 offset:8704
s_mov_b32 s49, 0x100000
v_mfma_f32_16x16x32_bf16 v[184:187], v[236:239], a[8:11], 0
buffer_load_dwordx4 v242, s[12:15], s49 offen lds
v_mul_f32 v0, v0, v64
v_mfma_f32_16x16x32_bf16 v[188:191], v[236:239], a[12:15], 0
buffer_load_dwordx4 v243, s[12:15], s49 offen offset:1024 lds
v_mul_f32 v1, v1, v65
s_waitcnt lgkmcnt(4)
v_mfma_f32_16x16x32_bf16 v[128:131], v[224:227], a[16:19], v[128:131]
ds_read_b64_tr_b16 v[236:237], v255 offset:8192
s_add_u32 m0, s48, 0x1800
v_mfma_f32_16x16x32_bf16 v[132:135], v[224:227], a[20:23], v[132:135]
ds_read_b64_tr_b16 v[238:239], v255 offset:8704
s_mov_b32 s49, 0x120000
v_mfma_f32_16x16x32_bf16 v[136:139], v[224:227], a[24:27], v[136:139]
buffer_load_dwordx4 v242, s[12:15], s49 offen lds
v_mul_f32 v2, v2, v66
v_mfma_f32_16x16x32_bf16 v[140:143], v[224:227], a[28:31], v[140:143]
buffer_load_dwordx4 v243, s[12:15], s49 offen offset:1024 lds
v_mul_f32 v3, v3, v67
s_waitcnt vmcnt(8) lgkmcnt(4)
v_mfma_f32_16x16x32_bf16 v[144:147], v[228:231], a[16:19], v[144:147]
ds_read_b64_tr_b16 v[224:225], v249 offset:12288
v_mul_f32 v4, v4, v68
v_mfma_f32_16x16x32_bf16 v[148:151], v[228:231], a[20:23], v[148:151]
ds_read_b64_tr_b16 v[226:227], v249 offset:12800
v_mul_f32 v5, v5, v69
v_mfma_f32_16x16x32_bf16 v[152:155], v[228:231], a[24:27], v[152:155]
v_mul_f32 v6, v6, v70
v_mul_f32 v7, v7, v71
v_mfma_f32_16x16x32_bf16 v[156:159], v[228:231], a[28:31], v[156:159]
v_cvt_pk_bf16_f32 v64, v0, v1
v_cvt_pk_bf16_f32 v65, v2, v3
s_waitcnt lgkmcnt(4)
v_mfma_f32_16x16x32_bf16 v[160:163], v[232:235], a[16:19], v[160:163]
ds_read_b64_tr_b16 v[228:229], v251 offset:12288
v_cvt_pk_bf16_f32 v66, v4, v5
v_mfma_f32_16x16x32_bf16 v[164:167], v[232:235], a[20:23], v[164:167]
ds_read_b64_tr_b16 v[230:231], v251 offset:12800
v_cvt_pk_bf16_f32 v67, v6, v7
v_mfma_f32_16x16x32_bf16 v[168:171], v[232:235], a[24:27], v[168:171]
v_permlane16_swap_b32 v64, v66
v_mfma_f32_16x16x32_bf16 v[172:175], v[232:235], a[28:31], v[172:175]
v_permlane16_swap_b32 v65, v67
s_waitcnt lgkmcnt(4)
v_mfma_f32_16x16x32_bf16 v[176:179], v[236:239], a[16:19], v[176:179]
ds_read_b64_tr_b16 v[232:233], v254 offset:12288
s_add_u32 m0, s48, 0x2000
v_mfma_f32_16x16x32_bf16 v[180:183], v[236:239], a[20:23], v[180:183]
ds_read_b64_tr_b16 v[234:235], v254 offset:12800
s_mov_b32 s49, 0x140000
v_mfma_f32_16x16x32_bf16 v[184:187], v[236:239], a[24:27], v[184:187]
buffer_load_dwordx4 v242, s[12:15], s49 offen lds
v_mfma_f32_16x16x32_bf16 v[188:191], v[236:239], a[28:31], v[188:191]
buffer_load_dwordx4 v243, s[12:15], s49 offen offset:1024 lds
s_waitcnt lgkmcnt(4)
v_mfma_f32_16x16x32_bf16 v[128:131], v[224:227], a[32:35], v[128:131]
ds_read_b64_tr_b16 v[236:237], v255 offset:12288
s_add_u32 m0, s48, 0x2800
v_mfma_f32_16x16x32_bf16 v[132:135], v[224:227], a[36:39], v[132:135]
ds_read_b64_tr_b16 v[238:239], v255 offset:12800
s_mov_b32 s49, 0x160000
v_mfma_f32_16x16x32_bf16 v[136:139], v[224:227], a[40:43], v[136:139]
buffer_load_dwordx4 v242, s[12:15], s49 offen lds
v_mfma_f32_16x16x32_bf16 v[140:143], v[224:227], a[44:47], v[140:143]
buffer_load_dwordx4 v243, s[12:15], s49 offen offset:1024 lds
s_waitcnt vmcnt(8) lgkmcnt(4)
v_mfma_f32_16x16x32_bf16 v[144:147], v[228:231], a[32:35], v[144:147]
ds_read_b64_tr_b16 v[224:225], v249
v_mfma_f32_16x16x32_bf16 v[148:151], v[228:231], a[36:39], v[148:151]
ds_read_b64_tr_b16 v[226:227], v249 offset:512
v_mfma_f32_16x16x32_bf16 v[152:155], v[228:231], a[40:43], v[152:155]
ds_write_b128 v252, v[64:67]
v_mul_f32 v8, v8, v72
v_mfma_f32_16x16x32_bf16 v[156:159], v[228:231], a[44:47], v[156:159]
v_mul_f32 v9, v9, v73
v_mul_f32 v10, v10, v74
s_waitcnt lgkmcnt(5)
v_mfma_f32_16x16x32_bf16 v[160:163], v[232:235], a[32:35], v[160:163]
ds_read_b64_tr_b16 v[228:229], v251
v_mul_f32 v11, v11, v75
v_mfma_f32_16x16x32_bf16 v[164:167], v[232:235], a[36:39], v[164:167]
ds_read_b64_tr_b16 v[230:231], v251 offset:512
v_mul_f32 v12, v12, v76
v_mfma_f32_16x16x32_bf16 v[168:171], v[232:235], a[40:43], v[168:171]
v_mul_f32 v13, v13, v77
v_mul_f32 v14, v14, v78
v_mfma_f32_16x16x32_bf16 v[172:175], v[232:235], a[44:47], v[172:175]
v_mul_f32 v15, v15, v79
v_cvt_pk_bf16_f32 v72, v8, v9
s_waitcnt lgkmcnt(5)
v_mfma_f32_16x16x32_bf16 v[176:179], v[236:239], a[32:35], v[176:179]
ds_read_b64_tr_b16 v[232:233], v254
s_add_u32 m0, s48, 0x3000
v_mfma_f32_16x16x32_bf16 v[180:183], v[236:239], a[36:39], v[180:183]
ds_read_b64_tr_b16 v[234:235], v254 offset:512
s_mov_b32 s49, 0x180000
v_mfma_f32_16x16x32_bf16 v[184:187], v[236:239], a[40:43], v[184:187]
buffer_load_dwordx4 v242, s[12:15], s49 offen lds
v_cvt_pk_bf16_f32 v73, v10, v11
v_mfma_f32_16x16x32_bf16 v[188:191], v[236:239], a[44:47], v[188:191]
buffer_load_dwordx4 v243, s[12:15], s49 offen offset:1024 lds
v_cvt_pk_bf16_f32 v74, v12, v13
s_waitcnt lgkmcnt(5)
v_mfma_f32_16x16x32_bf16 v[128:131], v[224:227], a[48:51], v[128:131]
ds_read_b64_tr_b16 v[236:237], v255
s_add_u32 m0, s48, 0x3800
v_mfma_f32_16x16x32_bf16 v[132:135], v[224:227], a[52:55], v[132:135]
ds_read_b64_tr_b16 v[238:239], v255 offset:512
s_mov_b32 s49, 0x1a0000
v_mfma_f32_16x16x32_bf16 v[136:139], v[224:227], a[56:59], v[136:139]
buffer_load_dwordx4 v242, s[12:15], s49 offen lds
v_cvt_pk_bf16_f32 v75, v14, v15
v_mfma_f32_16x16x32_bf16 v[140:143], v[224:227], a[60:63], v[140:143]
buffer_load_dwordx4 v243, s[12:15], s49 offen offset:1024 lds
s_waitcnt vmcnt(8) lgkmcnt(4)
v_mfma_f32_16x16x32_bf16 v[144:147], v[228:231], a[48:51], v[144:147]
ds_read_b64_tr_b16 v[224:225], v249 offset:4096
v_mfma_f32_16x16x32_bf16 v[148:151], v[228:231], a[52:55], v[148:151]
ds_read_b64_tr_b16 v[226:227], v249 offset:4608
v_mfma_f32_16x16x32_bf16 v[152:155], v[228:231], a[56:59], v[152:155]
v_permlane16_swap_b32 v72, v74
v_mfma_f32_16x16x32_bf16 v[156:159], v[228:231], a[60:63], v[156:159]
v_permlane16_swap_b32 v73, v75
s_waitcnt lgkmcnt(4)
v_mfma_f32_16x16x32_bf16 v[160:163], v[232:235], a[48:51], v[160:163]
ds_read_b64_tr_b16 v[228:229], v251 offset:4096
v_mfma_f32_16x16x32_bf16 v[164:167], v[232:235], a[52:55], v[164:167]
ds_read_b64_tr_b16 v[230:231], v251 offset:4608
v_mfma_f32_16x16x32_bf16 v[168:171], v[232:235], a[56:59], v[168:171]
ds_write_b128 v252, v[72:75] offset:1024
v_mul_f32 v16, v16, v80
v_mfma_f32_16x16x32_bf16 v[172:175], v[232:235], a[60:63], v[172:175]
v_mul_f32 v17, v17, v81
v_mul_f32 v18, v18, v82
s_waitcnt lgkmcnt(5)
v_mfma_f32_16x16x32_bf16 v[176:179], v[236:239], a[48:51], v[176:179]
ds_read_b64_tr_b16 v[232:233], v254 offset:4096
s_add_u32 m0, s48, 0
v_mfma_f32_16x16x32_bf16 v[180:183], v[236:239], a[52:55], v[180:183]
ds_read_b64_tr_b16 v[234:235], v254 offset:4608
s_mov_b32 s49, 0x1c0000
v_mfma_f32_16x16x32_bf16 v[184:187], v[236:239], a[56:59], v[184:187]
buffer_load_dwordx4 v242, s[12:15], s49 offen lds
v_mul_f32 v19, v19, v83
v_mfma_f32_16x16x32_bf16 v[188:191], v[236:239], a[60:63], v[188:191]
buffer_load_dwordx4 v243, s[12:15], s49 offen offset:1024 lds
v_mul_f32 v20, v20, v84
s_waitcnt lgkmcnt(5)
v_mfma_f32_16x16x32_bf16 v[128:131], v[224:227], a[64:67], v[128:131]
ds_read_b64_tr_b16 v[236:237], v255 offset:4096
s_add_u32 m0, s48, 0x800
v_mfma_f32_16x16x32_bf16 v[132:135], v[224:227], a[68:71], v[132:135]
ds_read_b64_tr_b16 v[238:239], v255 offset:4608
s_mov_b32 s49, 0x1e0000
v_mfma_f32_16x16x32_bf16 v[136:139], v[224:227], a[72:75], v[136:139]
buffer_load_dwordx4 v242, s[12:15], s49 offen lds
v_mul_f32 v21, v21, v85
v_mfma_f32_16x16x32_bf16 v[140:143], v[224:227], a[76:79], v[140:143]
buffer_load_dwordx4 v243, s[12:15], s49 offen offset:1024 lds
v_mul_f32 v22, v22, v86
s_waitcnt vmcnt(8) lgkmcnt(5)
v_mfma_f32_16x16x32_bf16 v[144:147], v[228:231], a[64:67], v[144:147]
ds_read_b64_tr_b16 v[224:225], v249 offset:8192
v_mul_f32 v23, v23, v87
v_mfma_f32_16x16x32_bf16 v[148:151], v[228:231], a[68:71], v[148:151]
ds_read_b64_tr_b16 v[226:227], v249 offset:8704
v_cvt_pk_bf16_f32 v80, v16, v17
v_mfma_f32_16x16x32_bf16 v[152:155], v[228:231], a[72:75], v[152:155]
v_cvt_pk_bf16_f32 v81, v18, v19
v_cvt_pk_bf16_f32 v82, v20, v21
v_mfma_f32_16x16x32_bf16 v[156:159], v[228:231], a[76:79], v[156:159]
v_cvt_pk_bf16_f32 v83, v22, v23
s_waitcnt lgkmcnt(4)
v_mfma_f32_16x16x32_bf16 v[160:163], v[232:235], a[64:67], v[160:163]
ds_read_b64_tr_b16 v[228:229], v251 offset:8192
v_mfma_f32_16x16x32_bf16 v[164:167], v[232:235], a[68:71], v[164:167]
ds_read_b64_tr_b16 v[230:231], v251 offset:8704
v_mfma_f32_16x16x32_bf16 v[168:171], v[232:235], a[72:75], v[168:171]
v_permlane16_swap_b32 v80, v82
v_mfma_f32_16x16x32_bf16 v[172:175], v[232:235], a[76:79], v[172:175]
v_permlane16_swap_b32 v81, v83
s_waitcnt lgkmcnt(4)
v_mfma_f32_16x16x32_bf16 v[176:179], v[236:239], a[64:67], v[176:179]
ds_read_b64_tr_b16 v[232:233], v254 offset:8192
s_add_u32 m0, s48, 0x1000
v_mfma_f32_16x16x32_bf16 v[180:183], v[236:239], a[68:71], v[180:183]
ds_read_b64_tr_b16 v[234:235], v254 offset:8704
s_mov_b32 s49, 0x200000
v_mfma_f32_16x16x32_bf16 v[184:187], v[236:239], a[72:75], v[184:187]
buffer_load_dwordx4 v242, s[12:15], s49 offen lds
v_mfma_f32_16x16x32_bf16 v[188:191], v[236:239], a[76:79], v[188:191]
buffer_load_dwordx4 v243, s[12:15], s49 offen offset:1024 lds
s_waitcnt lgkmcnt(4)
v_mfma_f32_16x16x32_bf16 v[128:131], v[224:227], a[80:83], v[128:131]
ds_read_b64_tr_b16 v[236:237], v255 offset:8192
s_add_u32 m0, s48, 0x1800
v_mfma_f32_16x16x32_bf16 v[132:135], v[224:227], a[84:87], v[132:135]
ds_read_b64_tr_b16 v[238:239], v255 offset:8704
s_mov_b32 s49, 0x220000
v_mfma_f32_16x16x32_bf16 v[136:139], v[224:227], a[88:91], v[136:139]
buffer_load_dwordx4 v242, s[12:15], s49 offen lds
v_mfma_f32_16x16x32_bf16 v[140:143], v[224:227], a[92:95], v[140:143]
buffer_load_dwordx4 v243, s[12:15], s49 offen offset:1024 lds
s_waitcnt vmcnt(8) lgkmcnt(4)
v_mfma_f32_16x16x32_bf16 v[144:147], v[228:231], a[80:83], v[144:147]
ds_read_b64_tr_b16 v[224:225], v249 offset:12288
v_mfma_f32_16x16x32_bf16 v[148:151], v[228:231], a[84:87], v[148:151]
ds_read_b64_tr_b16 v[226:227], v249 offset:12800
v_mfma_f32_16x16x32_bf16 v[152:155], v[228:231], a[88:91], v[152:155]
ds_write_b128 v252, v[80:83] offset:2048
v_mul_f32 v24, v24, v88
v_mfma_f32_16x16x32_bf16 v[156:159], v[228:231], a[92:95], v[156:159]
v_mul_f32 v25, v25, v89
v_mul_f32 v26, v26, v90
s_waitcnt lgkmcnt(5)
v_mfma_f32_16x16x32_bf16 v[160:163], v[232:235], a[80:83], v[160:163]
ds_read_b64_tr_b16 v[228:229], v251 offset:12288
v_mul_f32 v27, v27, v91
v_mfma_f32_16x16x32_bf16 v[164:167], v[232:235], a[84:87], v[164:167]
ds_read_b64_tr_b16 v[230:231], v251 offset:12800
v_mul_f32 v28, v28, v92
v_mfma_f32_16x16x32_bf16 v[168:171], v[232:235], a[88:91], v[168:171]
v_mul_f32 v29, v29, v93
v_mul_f32 v30, v30, v94
v_mfma_f32_16x16x32_bf16 v[172:175], v[232:235], a[92:95], v[172:175]
v_mul_f32 v31, v31, v95
v_cvt_pk_bf16_f32 v88, v24, v25
s_waitcnt lgkmcnt(5)
v_mfma_f32_16x16x32_bf16 v[176:179], v[236:239], a[80:83], v[176:179]
ds_read_b64_tr_b16 v[232:233], v254 offset:12288
s_add_u32 m0, s48, 0x2000
v_mfma_f32_16x16x32_bf16 v[180:183], v[236:239], a[84:87], v[180:183]
ds_read_b64_tr_b16 v[234:235], v254 offset:12800
s_mov_b32 s49, 0x240000
v_mfma_f32_16x16x32_bf16 v[184:187], v[236:239], a[88:91], v[184:187]
buffer_load_dwordx4 v242, s[12:15], s49 offen lds
v_cvt_pk_bf16_f32 v89, v26, v27
v_mfma_f32_16x16x32_bf16 v[188:191], v[236:239], a[92:95], v[188:191]
buffer_load_dwordx4 v243, s[12:15], s49 offen offset:1024 lds
v_cvt_pk_bf16_f32 v90, v28, v29
s_waitcnt lgkmcnt(5)
v_mfma_f32_16x16x32_bf16 v[128:131], v[224:227], a[96:99], v[128:131]
ds_read_b64_tr_b16 v[236:237], v255 offset:12288
s_add_u32 m0, s48, 0x2800
v_mfma_f32_16x16x32_bf16 v[132:135], v[224:227], a[100:103], v[132:135]
ds_read_b64_tr_b16 v[238:239], v255 offset:12800
s_mov_b32 s49, 0x260000
v_mfma_f32_16x16x32_bf16 v[136:139], v[224:227], a[104:107], v[136:139]
buffer_load_dwordx4 v242, s[12:15], s49 offen lds
v_cvt_pk_bf16_f32 v91, v30, v31
v_mfma_f32_16x16x32_bf16 v[140:143], v[224:227], a[108:111], v[140:143]
buffer_load_dwordx4 v243, s[12:15], s49 offen offset:1024 lds
s_waitcnt vmcnt(8) lgkmcnt(4)
v_mfma_f32_16x16x32_bf16 v[144:147], v[228:231], a[96:99], v[144:147]
ds_read_b64_tr_b16 v[224:225], v249
v_mfma_f32_16x16x32_bf16 v[148:151], v[228:231], a[100:103], v[148:151]
ds_read_b64_tr_b16 v[226:227], v249 offset:512
v_mfma_f32_16x16x32_bf16 v[152:155], v[228:231], a[104:107], v[152:155]
v_permlane16_swap_b32 v88, v90
v_mfma_f32_16x16x32_bf16 v[156:159], v[228:231], a[108:111], v[156:159]
v_permlane16_swap_b32 v89, v91
s_waitcnt lgkmcnt(4)
v_mfma_f32_16x16x32_bf16 v[160:163], v[232:235], a[96:99], v[160:163]
ds_read_b64_tr_b16 v[228:229], v251
v_mfma_f32_16x16x32_bf16 v[164:167], v[232:235], a[100:103], v[164:167]
ds_read_b64_tr_b16 v[230:231], v251 offset:512
v_mfma_f32_16x16x32_bf16 v[168:171], v[232:235], a[104:107], v[168:171]
ds_write_b128 v252, v[88:91] offset:3072
v_mul_f32 v32, v32, v96
v_mfma_f32_16x16x32_bf16 v[172:175], v[232:235], a[108:111], v[172:175]
v_mul_f32 v33, v33, v97
v_mul_f32 v34, v34, v98
s_waitcnt lgkmcnt(5)
v_mfma_f32_16x16x32_bf16 v[176:179], v[236:239], a[96:99], v[176:179]
ds_read_b64_tr_b16 v[232:233], v254
s_add_u32 m0, s48, 0x3000
v_mfma_f32_16x16x32_bf16 v[180:183], v[236:239], a[100:103], v[180:183]
ds_read_b64_tr_b16 v[234:235], v254 offset:512
s_mov_b32 s49, 0x280000
v_mfma_f32_16x16x32_bf16 v[184:187], v[236:239], a[104:107], v[184:187]
buffer_load_dwordx4 v242, s[12:15], s49 offen lds
v_mul_f32 v35, v35, v99
v_mfma_f32_16x16x32_bf16 v[188:191], v[236:239], a[108:111], v[188:191]
buffer_load_dwordx4 v243, s[12:15], s49 offen offset:1024 lds
v_mul_f32 v36, v36, v100
s_waitcnt lgkmcnt(5)
v_mfma_f32_16x16x32_bf16 v[128:131], v[224:227], a[112:115], v[128:131]
ds_read_b64_tr_b16 v[236:237], v255
s_add_u32 m0, s48, 0x3800
v_mfma_f32_16x16x32_bf16 v[132:135], v[224:227], a[116:119], v[132:135]
ds_read_b64_tr_b16 v[238:239], v255 offset:512
s_mov_b32 s49, 0x2a0000
v_mfma_f32_16x16x32_bf16 v[136:139], v[224:227], a[120:123], v[136:139]
buffer_load_dwordx4 v242, s[12:15], s49 offen lds
v_mul_f32 v37, v37, v101
v_mfma_f32_16x16x32_bf16 v[140:143], v[224:227], a[124:127], v[140:143]
buffer_load_dwordx4 v243, s[12:15], s49 offen offset:1024 lds
v_mul_f32 v38, v38, v102
s_waitcnt vmcnt(8) lgkmcnt(5)
v_mfma_f32_16x16x32_bf16 v[144:147], v[228:231], a[112:115], v[144:147]
ds_read_b64_tr_b16 v[224:225], v249 offset:4096
v_mul_f32 v39, v39, v103
v_mfma_f32_16x16x32_bf16 v[148:151], v[228:231], a[116:119], v[148:151]
ds_read_b64_tr_b16 v[226:227], v249 offset:4608
v_cvt_pk_bf16_f32 v96, v32, v33
v_mfma_f32_16x16x32_bf16 v[152:155], v[228:231], a[120:123], v[152:155]
v_cvt_pk_bf16_f32 v97, v34, v35
v_cvt_pk_bf16_f32 v98, v36, v37
v_mfma_f32_16x16x32_bf16 v[156:159], v[228:231], a[124:127], v[156:159]
v_cvt_pk_bf16_f32 v99, v38, v39
s_waitcnt lgkmcnt(4)
v_mfma_f32_16x16x32_bf16 v[160:163], v[232:235], a[112:115], v[160:163]
ds_read_b64_tr_b16 v[228:229], v251 offset:4096
v_mfma_f32_16x16x32_bf16 v[164:167], v[232:235], a[116:119], v[164:167]
ds_read_b64_tr_b16 v[230:231], v251 offset:4608
v_mfma_f32_16x16x32_bf16 v[168:171], v[232:235], a[120:123], v[168:171]
v_permlane16_swap_b32 v96, v98
v_mfma_f32_16x16x32_bf16 v[172:175], v[232:235], a[124:127], v[172:175]
v_permlane16_swap_b32 v97, v99
s_waitcnt lgkmcnt(4)
v_mfma_f32_16x16x32_bf16 v[176:179], v[236:239], a[112:115], v[176:179]
ds_read_b64_tr_b16 v[232:233], v254 offset:4096
s_add_u32 m0, s48, 0
v_mfma_f32_16x16x32_bf16 v[180:183], v[236:239], a[116:119], v[180:183]
ds_read_b64_tr_b16 v[234:235], v254 offset:4608
s_mov_b32 s49, 0x2c0000
v_mfma_f32_16x16x32_bf16 v[184:187], v[236:239], a[120:123], v[184:187]
buffer_load_dwordx4 v242, s[12:15], s49 offen lds
v_mfma_f32_16x16x32_bf16 v[188:191], v[236:239], a[124:127], v[188:191]
buffer_load_dwordx4 v243, s[12:15], s49 offen offset:1024 lds
s_waitcnt lgkmcnt(4)
v_mfma_f32_16x16x32_bf16 v[128:131], v[224:227], a[128:131], v[128:131]
ds_read_b64_tr_b16 v[236:237], v255 offset:4096
s_add_u32 m0, s48, 0x800
v_mfma_f32_16x16x32_bf16 v[132:135], v[224:227], a[132:135], v[132:135]
ds_read_b64_tr_b16 v[238:239], v255 offset:4608
s_mov_b32 s49, 0x2e0000
v_mfma_f32_16x16x32_bf16 v[136:139], v[224:227], a[136:139], v[136:139]
buffer_load_dwordx4 v242, s[12:15], s49 offen lds
v_mfma_f32_16x16x32_bf16 v[140:143], v[224:227], a[140:143], v[140:143]
buffer_load_dwordx4 v243, s[12:15], s49 offen offset:1024 lds
s_waitcnt vmcnt(8) lgkmcnt(4)
v_mfma_f32_16x16x32_bf16 v[144:147], v[228:231], a[128:131], v[144:147]
ds_read_b64_tr_b16 v[224:225], v249 offset:8192
v_mfma_f32_16x16x32_bf16 v[148:151], v[228:231], a[132:135], v[148:151]
ds_read_b64_tr_b16 v[226:227], v249 offset:8704
v_mfma_f32_16x16x32_bf16 v[152:155], v[228:231], a[136:139], v[152:155]
ds_write_b128 v253, v[96:99]
v_mul_f32 v40, v40, v104
v_mfma_f32_16x16x32_bf16 v[156:159], v[228:231], a[140:143], v[156:159]
v_mul_f32 v41, v41, v105
v_mul_f32 v42, v42, v106
s_waitcnt lgkmcnt(5)
v_mfma_f32_16x16x32_bf16 v[160:163], v[232:235], a[128:131], v[160:163]
ds_read_b64_tr_b16 v[228:229], v251 offset:8192
v_mul_f32 v43, v43, v107
v_mfma_f32_16x16x32_bf16 v[164:167], v[232:235], a[132:135], v[164:167]
ds_read_b64_tr_b16 v[230:231], v251 offset:8704
v_mul_f32 v44, v44, v108
v_mfma_f32_16x16x32_bf16 v[168:171], v[232:235], a[136:139], v[168:171]
v_mul_f32 v45, v45, v109
v_mul_f32 v46, v46, v110
v_mfma_f32_16x16x32_bf16 v[172:175], v[232:235], a[140:143], v[172:175]
v_mul_f32 v47, v47, v111
v_cvt_pk_bf16_f32 v104, v40, v41
s_waitcnt lgkmcnt(5)
v_mfma_f32_16x16x32_bf16 v[176:179], v[236:239], a[128:131], v[176:179]
ds_read_b64_tr_b16 v[232:233], v254 offset:8192
s_add_u32 m0, s48, 0x1000
v_mfma_f32_16x16x32_bf16 v[180:183], v[236:239], a[132:135], v[180:183]
ds_read_b64_tr_b16 v[234:235], v254 offset:8704
s_mov_b32 s49, 0x300000
v_mfma_f32_16x16x32_bf16 v[184:187], v[236:239], a[136:139], v[184:187]
buffer_load_dwordx4 v242, s[12:15], s49 offen lds
v_cvt_pk_bf16_f32 v105, v42, v43
v_mfma_f32_16x16x32_bf16 v[188:191], v[236:239], a[140:143], v[188:191]
buffer_load_dwordx4 v243, s[12:15], s49 offen offset:1024 lds
v_cvt_pk_bf16_f32 v106, v44, v45
s_waitcnt lgkmcnt(5)
v_mfma_f32_16x16x32_bf16 v[128:131], v[224:227], a[144:147], v[128:131]
ds_read_b64_tr_b16 v[236:237], v255 offset:8192
s_add_u32 m0, s48, 0x1800
v_mfma_f32_16x16x32_bf16 v[132:135], v[224:227], a[148:151], v[132:135]
ds_read_b64_tr_b16 v[238:239], v255 offset:8704
s_mov_b32 s49, 0x320000
v_mfma_f32_16x16x32_bf16 v[136:139], v[224:227], a[152:155], v[136:139]
buffer_load_dwordx4 v242, s[12:15], s49 offen lds
v_cvt_pk_bf16_f32 v107, v46, v47
v_mfma_f32_16x16x32_bf16 v[140:143], v[224:227], a[156:159], v[140:143]
buffer_load_dwordx4 v243, s[12:15], s49 offen offset:1024 lds
s_waitcnt vmcnt(8) lgkmcnt(4)
v_mfma_f32_16x16x32_bf16 v[144:147], v[228:231], a[144:147], v[144:147]
ds_read_b64_tr_b16 v[224:225], v249 offset:12288
v_mfma_f32_16x16x32_bf16 v[148:151], v[228:231], a[148:151], v[148:151]
ds_read_b64_tr_b16 v[226:227], v249 offset:12800
v_mfma_f32_16x16x32_bf16 v[152:155], v[228:231], a[152:155], v[152:155]
v_permlane16_swap_b32 v104, v106
v_mfma_f32_16x16x32_bf16 v[156:159], v[228:231], a[156:159], v[156:159]
v_permlane16_swap_b32 v105, v107
s_waitcnt lgkmcnt(4)
v_mfma_f32_16x16x32_bf16 v[160:163], v[232:235], a[144:147], v[160:163]
ds_read_b64_tr_b16 v[228:229], v251 offset:12288
v_mfma_f32_16x16x32_bf16 v[164:167], v[232:235], a[148:151], v[164:167]
ds_read_b64_tr_b16 v[230:231], v251 offset:12800
v_mfma_f32_16x16x32_bf16 v[168:171], v[232:235], a[152:155], v[168:171]
ds_write_b128 v253, v[104:107] offset:1024
v_mul_f32 v48, v48, v112
v_mfma_f32_16x16x32_bf16 v[172:175], v[232:235], a[156:159], v[172:175]
v_mul_f32 v49, v49, v113
v_mul_f32 v50, v50, v114
s_waitcnt lgkmcnt(5)
v_mfma_f32_16x16x32_bf16 v[176:179], v[236:239], a[144:147], v[176:179]
ds_read_b64_tr_b16 v[232:233], v254 offset:12288
s_add_u32 m0, s48, 0x2000
v_mfma_f32_16x16x32_bf16 v[180:183], v[236:239], a[148:151], v[180:183]
ds_read_b64_tr_b16 v[234:235], v254 offset:12800
s_mov_b32 s49, 0x340000
v_mfma_f32_16x16x32_bf16 v[184:187], v[236:239], a[152:155], v[184:187]
buffer_load_dwordx4 v242, s[12:15], s49 offen lds
v_mul_f32 v51, v51, v115
v_mfma_f32_16x16x32_bf16 v[188:191], v[236:239], a[156:159], v[188:191]
buffer_load_dwordx4 v243, s[12:15], s49 offen offset:1024 lds
v_mul_f32 v52, v52, v116
s_waitcnt lgkmcnt(5)
v_mfma_f32_16x16x32_bf16 v[128:131], v[224:227], a[160:163], v[128:131]
ds_read_b64_tr_b16 v[236:237], v255 offset:12288
s_add_u32 m0, s48, 0x2800
v_mfma_f32_16x16x32_bf16 v[132:135], v[224:227], a[164:167], v[132:135]
ds_read_b64_tr_b16 v[238:239], v255 offset:12800
s_mov_b32 s49, 0x360000
v_mfma_f32_16x16x32_bf16 v[136:139], v[224:227], a[168:171], v[136:139]
buffer_load_dwordx4 v242, s[12:15], s49 offen lds
v_mul_f32 v53, v53, v117
v_mfma_f32_16x16x32_bf16 v[140:143], v[224:227], a[172:175], v[140:143]
buffer_load_dwordx4 v243, s[12:15], s49 offen offset:1024 lds
v_mul_f32 v54, v54, v118
s_waitcnt vmcnt(8) lgkmcnt(5)
v_mfma_f32_16x16x32_bf16 v[144:147], v[228:231], a[160:163], v[144:147]
ds_read_b64_tr_b16 v[224:225], v249
v_mul_f32 v55, v55, v119
v_mfma_f32_16x16x32_bf16 v[148:151], v[228:231], a[164:167], v[148:151]
ds_read_b64_tr_b16 v[226:227], v249 offset:512
v_cvt_pk_bf16_f32 v112, v48, v49
v_mfma_f32_16x16x32_bf16 v[152:155], v[228:231], a[168:171], v[152:155]
v_cvt_pk_bf16_f32 v113, v50, v51
v_cvt_pk_bf16_f32 v114, v52, v53
v_mfma_f32_16x16x32_bf16 v[156:159], v[228:231], a[172:175], v[156:159]
v_cvt_pk_bf16_f32 v115, v54, v55
s_waitcnt lgkmcnt(4)
v_mfma_f32_16x16x32_bf16 v[160:163], v[232:235], a[160:163], v[160:163]
ds_read_b64_tr_b16 v[228:229], v251
v_mfma_f32_16x16x32_bf16 v[164:167], v[232:235], a[164:167], v[164:167]
ds_read_b64_tr_b16 v[230:231], v251 offset:512
v_mfma_f32_16x16x32_bf16 v[168:171], v[232:235], a[168:171], v[168:171]
v_permlane16_swap_b32 v112, v114
v_mfma_f32_16x16x32_bf16 v[172:175], v[232:235], a[172:175], v[172:175]
v_permlane16_swap_b32 v113, v115
s_waitcnt lgkmcnt(4)
v_mfma_f32_16x16x32_bf16 v[176:179], v[236:239], a[160:163], v[176:179]
ds_read_b64_tr_b16 v[232:233], v254
s_add_u32 m0, s48, 0x3000
v_mfma_f32_16x16x32_bf16 v[180:183], v[236:239], a[164:167], v[180:183]
ds_read_b64_tr_b16 v[234:235], v254 offset:512
s_mov_b32 s49, 0x380000
v_mfma_f32_16x16x32_bf16 v[184:187], v[236:239], a[168:171], v[184:187]
buffer_load_dwordx4 v242, s[12:15], s49 offen lds
v_mfma_f32_16x16x32_bf16 v[188:191], v[236:239], a[172:175], v[188:191]
buffer_load_dwordx4 v243, s[12:15], s49 offen offset:1024 lds
s_waitcnt lgkmcnt(4)
v_mfma_f32_16x16x32_bf16 v[128:131], v[224:227], a[176:179], v[128:131]
ds_read_b64_tr_b16 v[236:237], v255
s_add_u32 m0, s48, 0x3800
v_mfma_f32_16x16x32_bf16 v[132:135], v[224:227], a[180:183], v[132:135]
ds_read_b64_tr_b16 v[238:239], v255 offset:512
s_mov_b32 s49, 0x3a0000
v_mfma_f32_16x16x32_bf16 v[136:139], v[224:227], a[184:187], v[136:139]
buffer_load_dwordx4 v242, s[12:15], s49 offen lds
v_mfma_f32_16x16x32_bf16 v[140:143], v[224:227], a[188:191], v[140:143]
buffer_load_dwordx4 v243, s[12:15], s49 offen offset:1024 lds
s_waitcnt vmcnt(8) lgkmcnt(4)
v_mfma_f32_16x16x32_bf16 v[144:147], v[228:231], a[176:179], v[144:147]
ds_read_b64_tr_b16 v[224:225], v249 offset:4096
v_mfma_f32_16x16x32_bf16 v[148:151], v[228:231], a[180:183], v[148:151]
ds_read_b64_tr_b16 v[226:227], v249 offset:4608
v_mfma_f32_16x16x32_bf16 v[152:155], v[228:231], a[184:187], v[152:155]
ds_write_b128 v253, v[112:115] offset:2048
v_mul_f32 v56, v56, v120
v_mfma_f32_16x16x32_bf16 v[156:159], v[228:231], a[188:191], v[156:159]
v_mul_f32 v57, v57, v121
v_mul_f32 v58, v58, v122
s_waitcnt lgkmcnt(5)
v_mfma_f32_16x16x32_bf16 v[160:163], v[232:235], a[176:179], v[160:163]
ds_read_b64_tr_b16 v[228:229], v251 offset:4096
v_mul_f32 v59, v59, v123
v_mfma_f32_16x16x32_bf16 v[164:167], v[232:235], a[180:183], v[164:167]
ds_read_b64_tr_b16 v[230:231], v251 offset:4608
v_mul_f32 v60, v60, v124
v_mfma_f32_16x16x32_bf16 v[168:171], v[232:235], a[184:187], v[168:171]
v_mul_f32 v61, v61, v125
v_mul_f32 v62, v62, v126
v_mfma_f32_16x16x32_bf16 v[172:175], v[232:235], a[188:191], v[172:175]
v_mul_f32 v63, v63, v127
v_cvt_pk_bf16_f32 v120, v56, v57
s_waitcnt lgkmcnt(5)
v_mfma_f32_16x16x32_bf16 v[176:179], v[236:239], a[176:179], v[176:179]
ds_read_b64_tr_b16 v[232:233], v254 offset:4096
s_add_u32 m0, s48, 0
v_mfma_f32_16x16x32_bf16 v[180:183], v[236:239], a[180:183], v[180:183]
ds_read_b64_tr_b16 v[234:235], v254 offset:4608
s_mov_b32 s49, 0x3c0000
v_mfma_f32_16x16x32_bf16 v[184:187], v[236:239], a[184:187], v[184:187]
buffer_load_dwordx4 v242, s[12:15], s49 offen lds
v_cvt_pk_bf16_f32 v121, v58, v59
v_mfma_f32_16x16x32_bf16 v[188:191], v[236:239], a[188:191], v[188:191]
buffer_load_dwordx4 v243, s[12:15], s49 offen offset:1024 lds
v_cvt_pk_bf16_f32 v122, v60, v61
s_waitcnt lgkmcnt(5)
v_mfma_f32_16x16x32_bf16 v[128:131], v[224:227], a[192:195], v[128:131]
ds_read_b64_tr_b16 v[236:237], v255 offset:4096
s_add_u32 m0, s48, 0x800
v_mfma_f32_16x16x32_bf16 v[132:135], v[224:227], a[196:199], v[132:135]
ds_read_b64_tr_b16 v[238:239], v255 offset:4608
s_mov_b32 s49, 0x3e0000
v_mfma_f32_16x16x32_bf16 v[136:139], v[224:227], a[200:203], v[136:139]
buffer_load_dwordx4 v242, s[12:15], s49 offen lds
v_cvt_pk_bf16_f32 v123, v62, v63
v_mfma_f32_16x16x32_bf16 v[140:143], v[224:227], a[204:207], v[140:143]
buffer_load_dwordx4 v243, s[12:15], s49 offen offset:1024 lds
s_waitcnt vmcnt(8) lgkmcnt(4)
v_mfma_f32_16x16x32_bf16 v[144:147], v[228:231], a[192:195], v[144:147]
ds_read_b64_tr_b16 v[224:225], v249 offset:8192
v_mfma_f32_16x16x32_bf16 v[148:151], v[228:231], a[196:199], v[148:151]
ds_read_b64_tr_b16 v[226:227], v249 offset:8704
v_mfma_f32_16x16x32_bf16 v[152:155], v[228:231], a[200:203], v[152:155]
v_permlane16_swap_b32 v120, v122
v_mfma_f32_16x16x32_bf16 v[156:159], v[228:231], a[204:207], v[156:159]
v_permlane16_swap_b32 v121, v123
s_waitcnt lgkmcnt(4)
v_mfma_f32_16x16x32_bf16 v[160:163], v[232:235], a[192:195], v[160:163]
ds_read_b64_tr_b16 v[228:229], v251 offset:8192
v_mfma_f32_16x16x32_bf16 v[164:167], v[232:235], a[196:199], v[164:167]
ds_read_b64_tr_b16 v[230:231], v251 offset:8704
v_mfma_f32_16x16x32_bf16 v[168:171], v[232:235], a[200:203], v[168:171]
ds_write_b128 v253, v[120:123] offset:3072
v_mfma_f32_16x16x32_bf16 v[172:175], v[232:235], a[204:207], v[172:175]
s_waitcnt lgkmcnt(5)
v_mfma_f32_16x16x32_bf16 v[176:179], v[236:239], a[192:195], v[176:179]
ds_read_b64_tr_b16 v[232:233], v254 offset:8192
s_add_u32 m0, s48, 0x1000
v_mfma_f32_16x16x32_bf16 v[180:183], v[236:239], a[196:199], v[180:183]
ds_read_b64_tr_b16 v[234:235], v254 offset:8704
s_mov_b32 s49, 0x80
v_mfma_f32_16x16x32_bf16 v[184:187], v[236:239], a[200:203], v[184:187]
buffer_load_dwordx4 v242, s[12:15], s49 offen lds
v_mfma_f32_16x16x32_bf16 v[188:191], v[236:239], a[204:207], v[188:191]
buffer_load_dwordx4 v243, s[12:15], s49 offen offset:1024 lds
s_waitcnt lgkmcnt(5)
v_mfma_f32_16x16x32_bf16 v[128:131], v[224:227], a[208:211], v[128:131]
ds_read_b64_tr_b16 v[236:237], v255 offset:8192
s_add_u32 m0, s48, 0x1800
v_mfma_f32_16x16x32_bf16 v[132:135], v[224:227], a[212:215], v[132:135]
ds_read_b64_tr_b16 v[238:239], v255 offset:8704
s_mov_b32 s49, 0x20080
v_mfma_f32_16x16x32_bf16 v[136:139], v[224:227], a[216:219], v[136:139]
buffer_load_dwordx4 v242, s[12:15], s49 offen lds
v_mfma_f32_16x16x32_bf16 v[140:143], v[224:227], a[220:223], v[140:143]
buffer_load_dwordx4 v243, s[12:15], s49 offen offset:1024 lds
s_waitcnt vmcnt(8) lgkmcnt(5)
v_mfma_f32_16x16x32_bf16 v[144:147], v[228:231], a[208:211], v[144:147]
ds_read_b64_tr_b16 v[224:225], v249 offset:12288
v_mfma_f32_16x16x32_bf16 v[148:151], v[228:231], a[212:215], v[148:151]
ds_read_b64_tr_b16 v[226:227], v249 offset:12800
v_mfma_f32_16x16x32_bf16 v[152:155], v[228:231], a[216:219], v[152:155]
v_mfma_f32_16x16x32_bf16 v[156:159], v[228:231], a[220:223], v[156:159]
s_waitcnt lgkmcnt(4)
v_mfma_f32_16x16x32_bf16 v[160:163], v[232:235], a[208:211], v[160:163]
ds_read_b64_tr_b16 v[228:229], v251 offset:12288
v_mfma_f32_16x16x32_bf16 v[164:167], v[232:235], a[212:215], v[164:167]
ds_read_b64_tr_b16 v[230:231], v251 offset:12800
v_mfma_f32_16x16x32_bf16 v[168:171], v[232:235], a[216:219], v[168:171]
v_mfma_f32_16x16x32_bf16 v[172:175], v[232:235], a[220:223], v[172:175]
s_waitcnt lgkmcnt(4)
v_mfma_f32_16x16x32_bf16 v[176:179], v[236:239], a[208:211], v[176:179]
ds_read_b64_tr_b16 v[232:233], v254 offset:12288
s_add_u32 m0, s48, 0x2000
v_mfma_f32_16x16x32_bf16 v[180:183], v[236:239], a[212:215], v[180:183]
ds_read_b64_tr_b16 v[234:235], v254 offset:12800
s_mov_b32 s49, 0x40080
v_mfma_f32_16x16x32_bf16 v[184:187], v[236:239], a[216:219], v[184:187]
buffer_load_dwordx4 v242, s[12:15], s49 offen lds
v_mfma_f32_16x16x32_bf16 v[188:191], v[236:239], a[220:223], v[188:191]
buffer_load_dwordx4 v243, s[12:15], s49 offen offset:1024 lds
s_waitcnt lgkmcnt(4)
v_mfma_f32_16x16x32_bf16 v[128:131], v[224:227], a[224:227], v[128:131]
ds_read_b64_tr_b16 v[236:237], v255 offset:12288
s_add_u32 m0, s48, 0x2800
v_mfma_f32_16x16x32_bf16 v[132:135], v[224:227], a[228:231], v[132:135]
ds_read_b64_tr_b16 v[238:239], v255 offset:12800
s_mov_b32 s49, 0x60080
v_mfma_f32_16x16x32_bf16 v[136:139], v[224:227], a[232:235], v[136:139]
buffer_load_dwordx4 v242, s[12:15], s49 offen lds
v_mfma_f32_16x16x32_bf16 v[140:143], v[224:227], a[236:239], v[140:143]
buffer_load_dwordx4 v243, s[12:15], s49 offen offset:1024 lds
s_waitcnt vmcnt(8) lgkmcnt(4)
v_mfma_f32_16x16x32_bf16 v[144:147], v[228:231], a[224:227], v[144:147]
ds_read_b64_tr_b16 v[224:225], v249
v_mfma_f32_16x16x32_bf16 v[148:151], v[228:231], a[228:231], v[148:151]
ds_read_b64_tr_b16 v[226:227], v249 offset:512
v_mfma_f32_16x16x32_bf16 v[152:155], v[228:231], a[232:235], v[152:155]
v_mfma_f32_16x16x32_bf16 v[156:159], v[228:231], a[236:239], v[156:159]
s_waitcnt lgkmcnt(4)
v_mfma_f32_16x16x32_bf16 v[160:163], v[232:235], a[224:227], v[160:163]
ds_read_b64_tr_b16 v[228:229], v251
v_mfma_f32_16x16x32_bf16 v[164:167], v[232:235], a[228:231], v[164:167]
ds_read_b64_tr_b16 v[230:231], v251 offset:512
v_mfma_f32_16x16x32_bf16 v[168:171], v[232:235], a[232:235], v[168:171]
v_mfma_f32_16x16x32_bf16 v[172:175], v[232:235], a[236:239], v[172:175]
s_waitcnt lgkmcnt(4)
v_mfma_f32_16x16x32_bf16 v[176:179], v[236:239], a[224:227], v[176:179]
ds_read_b64_tr_b16 v[232:233], v254
s_add_u32 m0, s48, 0x3000
v_mfma_f32_16x16x32_bf16 v[180:183], v[236:239], a[228:231], v[180:183]
ds_read_b64_tr_b16 v[234:235], v254 offset:512
s_mov_b32 s49, 0x80080
v_mfma_f32_16x16x32_bf16 v[184:187], v[236:239], a[232:235], v[184:187]
buffer_load_dwordx4 v242, s[12:15], s49 offen lds
v_mfma_f32_16x16x32_bf16 v[188:191], v[236:239], a[236:239], v[188:191]
buffer_load_dwordx4 v243, s[12:15], s49 offen offset:1024 lds
s_waitcnt lgkmcnt(4)
v_mfma_f32_16x16x32_bf16 v[128:131], v[224:227], a[240:243], v[128:131]
ds_read_b64_tr_b16 v[236:237], v255
s_add_u32 m0, s48, 0x3800
v_mfma_f32_16x16x32_bf16 v[132:135], v[224:227], a[244:247], v[132:135]
ds_read_b64_tr_b16 v[238:239], v255 offset:512
s_mov_b32 s49, 0xa0080
v_mfma_f32_16x16x32_bf16 v[136:139], v[224:227], a[248:251], v[136:139]
buffer_load_dwordx4 v242, s[12:15], s49 offen lds
v_mfma_f32_16x16x32_bf16 v[140:143], v[224:227], a[252:255], v[140:143]
buffer_load_dwordx4 v243, s[12:15], s49 offen offset:1024 lds
s_waitcnt vmcnt(8) lgkmcnt(4)
v_mfma_f32_16x16x32_bf16 v[144:147], v[228:231], a[240:243], v[144:147]
ds_read_b64_tr_b16 v[224:225], v249 offset:4096
v_mfma_f32_16x16x32_bf16 v[148:151], v[228:231], a[244:247], v[148:151]
ds_read_b64_tr_b16 v[226:227], v249 offset:4608
v_mfma_f32_16x16x32_bf16 v[152:155], v[228:231], a[248:251], v[152:155]
v_mfma_f32_16x16x32_bf16 v[156:159], v[228:231], a[252:255], v[156:159]
s_waitcnt lgkmcnt(4)
v_mfma_f32_16x16x32_bf16 v[160:163], v[232:235], a[240:243], v[160:163]
ds_read_b64_tr_b16 v[228:229], v251 offset:4096
v_mfma_f32_16x16x32_bf16 v[164:167], v[232:235], a[244:247], v[164:167]
ds_read_b64_tr_b16 v[230:231], v251 offset:4608
v_mfma_f32_16x16x32_bf16 v[168:171], v[232:235], a[248:251], v[168:171]
v_mfma_f32_16x16x32_bf16 v[172:175], v[232:235], a[252:255], v[172:175]
s_waitcnt lgkmcnt(4)
v_mfma_f32_16x16x32_bf16 v[176:179], v[236:239], a[240:243], v[176:179]
ds_read_b64_tr_b16 v[232:233], v254 offset:4096
s_add_u32 m0, s48, 0
v_mfma_f32_16x16x32_bf16 v[180:183], v[236:239], a[244:247], v[180:183]
ds_read_b64_tr_b16 v[234:235], v254 offset:4608
s_mov_b32 s49, 0xc0080
v_mfma_f32_16x16x32_bf16 v[184:187], v[236:239], a[248:251], v[184:187]
buffer_load_dwordx4 v242, s[12:15], s49 offen lds
v_mfma_f32_16x16x32_bf16 v[188:191], v[236:239], a[252:255], v[188:191]
buffer_load_dwordx4 v243, s[12:15], s49 offen offset:1024 lds
s_barrier
s_waitcnt lgkmcnt(4)
v_mfma_f32_16x16x32_bf16 v[0:3], v[224:227], a[0:3], 0
ds_read_b64_tr_b16 v[236:237], v255 offset:4096
s_add_u32 m0, s48, 0x800
v_mfma_f32_16x16x32_bf16 v[4:7], v[224:227], a[4:7], 0
ds_read_b64_tr_b16 v[238:239], v255 offset:4608
s_mov_b32 s49, 0xe0080
v_mfma_f32_16x16x32_bf16 v[8:11], v[224:227], a[8:11], 0
buffer_load_dwordx4 v242, s[12:15], s49 offen lds
v_mfma_f32_16x16x32_bf16 v[12:15], v[224:227], a[12:15], 0
buffer_load_dwordx4 v243, s[12:15], s49 offen offset:1024 lds
s_waitcnt vmcnt(8) lgkmcnt(4)
v_mfma_f32_16x16x32_bf16 v[16:19], v[228:231], a[0:3], 0
ds_read_b64_tr_b16 v[224:225], v249 offset:8192
s_add_u32 m0, s48, 0x1000
v_mfma_f32_16x16x32_bf16 v[20:23], v[228:231], a[4:7], 0
ds_read_b64_tr_b16 v[226:227], v249 offset:8704
s_mov_b32 s49, 0x100080
v_mfma_f32_16x16x32_bf16 v[24:27], v[228:231], a[8:11], 0
s_waitcnt lgkmcnt(2)
buffer_load_dwordx4 v242, s[12:15], s49 offen lds
v_mfma_f32_16x16x32_bf16 v[28:31], v[228:231], a[12:15], 0
buffer_load_dwordx4 v243, s[12:15], s49 offen offset:1024 lds
v_mfma_f32_16x16x32_bf16 v[32:35], v[232:235], a[0:3], 0
ds_read_b64_tr_b16 v[228:229], v251 offset:8192
s_add_u32 m0, s48, 0x1800
v_mfma_f32_16x16x32_bf16 v[36:39], v[232:235], a[4:7], 0
ds_read_b64_tr_b16 v[230:231], v251 offset:8704
s_mov_b32 s49, 0x120080
v_mfma_f32_16x16x32_bf16 v[40:43], v[232:235], a[8:11], 0
buffer_load_dwordx4 v242, s[12:15], s49 offen lds
v_mfma_f32_16x16x32_bf16 v[44:47], v[232:235], a[12:15], 0
buffer_load_dwordx4 v243, s[12:15], s49 offen offset:1024 lds
v_mfma_f32_16x16x32_bf16 v[48:51], v[236:239], a[0:3], 0
ds_read_b64_tr_b16 v[232:233], v254 offset:8192
v_mul_f32 v128, s58, v128
v_mfma_f32_16x16x32_bf16 v[52:55], v[236:239], a[4:7], 0
ds_read_b64_tr_b16 v[234:235], v254 offset:8704
v_mul_f32 v129, s58, v129
v_mfma_f32_16x16x32_bf16 v[56:59], v[236:239], a[8:11], 0
v_mul_f32 v130, s58, v130
v_mul_f32 v131, s58, v131
v_mfma_f32_16x16x32_bf16 v[60:63], v[236:239], a[12:15], 0
v_mul_f32 v132, s58, v132
v_mul_f32 v133, s58, v133
s_waitcnt lgkmcnt(4)
v_mfma_f32_16x16x32_bf16 v[0:3], v[224:227], a[16:19], v[0:3]
ds_read_b64_tr_b16 v[236:237], v255 offset:8192
v_mul_f32 v134, s58, v134
v_mfma_f32_16x16x32_bf16 v[4:7], v[224:227], a[20:23], v[4:7]
ds_read_b64_tr_b16 v[238:239], v255 offset:8704
v_mul_f32 v135, s58, v135
v_mfma_f32_16x16x32_bf16 v[8:11], v[224:227], a[24:27], v[8:11]
v_cvt_pk_bf16_f32 v192, v128, v129
v_cvt_pk_bf16_f32 v193, v130, v131
v_mfma_f32_16x16x32_bf16 v[12:15], v[224:227], a[28:31], v[12:15]
v_cvt_pk_bf16_f32 v194, v132, v133
v_cvt_pk_bf16_f32 v195, v134, v135
s_waitcnt vmcnt(8) lgkmcnt(4)
v_mfma_f32_16x16x32_bf16 v[16:19], v[228:231], a[16:19], v[16:19]
ds_read_b64_tr_b16 v[224:225], v249 offset:12288
s_add_u32 m0, s48, 0x2000
v_mfma_f32_16x16x32_bf16 v[20:23], v[228:231], a[20:23], v[20:23]
ds_read_b64_tr_b16 v[226:227], v249 offset:12800
s_mov_b32 s49, 0x140080
v_mfma_f32_16x16x32_bf16 v[24:27], v[228:231], a[24:27], v[24:27]
s_waitcnt lgkmcnt(2)
buffer_load_dwordx4 v242, s[12:15], s49 offen lds
v_mfma_f32_16x16x32_bf16 v[28:31], v[228:231], a[28:31], v[28:31]
buffer_load_dwordx4 v243, s[12:15], s49 offen offset:1024 lds
v_mfma_f32_16x16x32_bf16 v[32:35], v[232:235], a[16:19], v[32:35]
ds_read_b64_tr_b16 v[228:229], v251 offset:12288
s_add_u32 m0, s48, 0x2800
v_mfma_f32_16x16x32_bf16 v[36:39], v[232:235], a[20:23], v[36:39]
ds_read_b64_tr_b16 v[230:231], v251 offset:12800
s_mov_b32 s49, 0x160080
v_mfma_f32_16x16x32_bf16 v[40:43], v[232:235], a[24:27], v[40:43]
buffer_load_dwordx4 v242, s[12:15], s49 offen lds
v_mfma_f32_16x16x32_bf16 v[44:47], v[232:235], a[28:31], v[44:47]
buffer_load_dwordx4 v243, s[12:15], s49 offen offset:1024 lds
v_mfma_f32_16x16x32_bf16 v[48:51], v[236:239], a[16:19], v[48:51]
ds_read_b64_tr_b16 v[232:233], v254 offset:12288
v_mfma_f32_16x16x32_bf16 v[52:55], v[236:239], a[20:23], v[52:55]
ds_read_b64_tr_b16 v[234:235], v254 offset:12800
v_mfma_f32_16x16x32_bf16 v[56:59], v[236:239], a[24:27], v[56:59]
v_permlane16_swap_b32 v192, v194
v_mfma_f32_16x16x32_bf16 v[60:63], v[236:239], a[28:31], v[60:63]
v_permlane16_swap_b32 v193, v195
s_waitcnt lgkmcnt(4)
v_mfma_f32_16x16x32_bf16 v[0:3], v[224:227], a[32:35], v[0:3]
ds_read_b64_tr_b16 v[236:237], v255 offset:12288
v_mul_f32 v136, s58, v136
v_mfma_f32_16x16x32_bf16 v[4:7], v[224:227], a[36:39], v[4:7]
ds_read_b64_tr_b16 v[238:239], v255 offset:12800
v_mul_f32 v137, s58, v137
v_mfma_f32_16x16x32_bf16 v[8:11], v[224:227], a[40:43], v[8:11]
v_mul_f32 v138, s58, v138
v_mul_f32 v139, s58, v139
v_mfma_f32_16x16x32_bf16 v[12:15], v[224:227], a[44:47], v[12:15]
v_mul_f32 v140, s58, v140
v_mul_f32 v141, s58, v141
s_waitcnt vmcnt(8) lgkmcnt(4)
v_mfma_f32_16x16x32_bf16 v[16:19], v[228:231], a[32:35], v[16:19]
ds_read_b64_tr_b16 v[224:225], v249
s_add_u32 m0, s48, 0x3000
v_mfma_f32_16x16x32_bf16 v[20:23], v[228:231], a[36:39], v[20:23]
ds_read_b64_tr_b16 v[226:227], v249 offset:512
s_mov_b32 s49, 0x180080
v_mfma_f32_16x16x32_bf16 v[24:27], v[228:231], a[40:43], v[24:27]
s_waitcnt lgkmcnt(2)
buffer_load_dwordx4 v242, s[12:15], s49 offen lds
v_mul_f32 v142, s58, v142
v_mfma_f32_16x16x32_bf16 v[28:31], v[228:231], a[44:47], v[28:31]
buffer_load_dwordx4 v243, s[12:15], s49 offen offset:1024 lds
v_mul_f32 v143, s58, v143
v_mfma_f32_16x16x32_bf16 v[32:35], v[232:235], a[32:35], v[32:35]
ds_read_b64_tr_b16 v[228:229], v251
s_add_u32 m0, s48, 0x3800
v_mfma_f32_16x16x32_bf16 v[36:39], v[232:235], a[36:39], v[36:39]
ds_read_b64_tr_b16 v[230:231], v251 offset:512
s_mov_b32 s49, 0x1a0080
v_mfma_f32_16x16x32_bf16 v[40:43], v[232:235], a[40:43], v[40:43]
buffer_load_dwordx4 v242, s[12:15], s49 offen lds
v_cvt_pk_bf16_f32 v196, v136, v137
v_mfma_f32_16x16x32_bf16 v[44:47], v[232:235], a[44:47], v[44:47]
buffer_load_dwordx4 v243, s[12:15], s49 offen offset:1024 lds
v_cvt_pk_bf16_f32 v197, v138, v139
v_mfma_f32_16x16x32_bf16 v[48:51], v[236:239], a[32:35], v[48:51]
ds_read_b64_tr_b16 v[232:233], v254
v_cvt_pk_bf16_f32 v198, v140, v141
v_mfma_f32_16x16x32_bf16 v[52:55], v[236:239], a[36:39], v[52:55]
ds_read_b64_tr_b16 v[234:235], v254 offset:512
v_cvt_pk_bf16_f32 v199, v142, v143
v_mfma_f32_16x16x32_bf16 v[56:59], v[236:239], a[40:43], v[56:59]
v_permlane16_swap_b32 v196, v198
v_mfma_f32_16x16x32_bf16 v[60:63], v[236:239], a[44:47], v[60:63]
v_permlane16_swap_b32 v197, v199
s_waitcnt lgkmcnt(4)
v_mfma_f32_16x16x32_bf16 v[0:3], v[224:227], a[48:51], v[0:3]
ds_read_b64_tr_b16 v[236:237], v255
v_mul_f32 v144, s58, v144
v_mfma_f32_16x16x32_bf16 v[4:7], v[224:227], a[52:55], v[4:7]
ds_read_b64_tr_b16 v[238:239], v255 offset:512
v_mul_f32 v145, s58, v145
v_mfma_f32_16x16x32_bf16 v[8:11], v[224:227], a[56:59], v[8:11]
v_mul_f32 v146, s58, v146
v_mul_f32 v147, s58, v147
v_mfma_f32_16x16x32_bf16 v[12:15], v[224:227], a[60:63], v[12:15]
v_mul_f32 v148, s58, v148
v_mul_f32 v149, s58, v149
s_waitcnt vmcnt(8) lgkmcnt(4)
v_mfma_f32_16x16x32_bf16 v[16:19], v[228:231], a[48:51], v[16:19]
ds_read_b64_tr_b16 v[224:225], v249 offset:4096
s_add_u32 m0, s48, 0
v_mfma_f32_16x16x32_bf16 v[20:23], v[228:231], a[52:55], v[20:23]
ds_read_b64_tr_b16 v[226:227], v249 offset:4608
s_mov_b32 s49, 0x1c0080
v_mfma_f32_16x16x32_bf16 v[24:27], v[228:231], a[56:59], v[24:27]
s_waitcnt lgkmcnt(2)
buffer_load_dwordx4 v242, s[12:15], s49 offen lds
v_mul_f32 v150, s58, v150
v_mfma_f32_16x16x32_bf16 v[28:31], v[228:231], a[60:63], v[28:31]
buffer_load_dwordx4 v243, s[12:15], s49 offen offset:1024 lds
v_mul_f32 v151, s58, v151
v_mfma_f32_16x16x32_bf16 v[32:35], v[232:235], a[48:51], v[32:35]
ds_read_b64_tr_b16 v[228:229], v251 offset:4096
s_add_u32 m0, s48, 0x800
v_mfma_f32_16x16x32_bf16 v[36:39], v[232:235], a[52:55], v[36:39]
ds_read_b64_tr_b16 v[230:231], v251 offset:4608
s_mov_b32 s49, 0x1e0080
v_mfma_f32_16x16x32_bf16 v[40:43], v[232:235], a[56:59], v[40:43]
buffer_load_dwordx4 v242, s[12:15], s49 offen lds
v_cvt_pk_bf16_f32 v200, v144, v145
v_mfma_f32_16x16x32_bf16 v[44:47], v[232:235], a[60:63], v[44:47]
buffer_load_dwordx4 v243, s[12:15], s49 offen offset:1024 lds
v_cvt_pk_bf16_f32 v201, v146, v147
v_mfma_f32_16x16x32_bf16 v[48:51], v[236:239], a[48:51], v[48:51]
ds_read_b64_tr_b16 v[232:233], v254 offset:4096
v_cvt_pk_bf16_f32 v202, v148, v149
v_mfma_f32_16x16x32_bf16 v[52:55], v[236:239], a[52:55], v[52:55]
ds_read_b64_tr_b16 v[234:235], v254 offset:4608
v_cvt_pk_bf16_f32 v203, v150, v151
v_mfma_f32_16x16x32_bf16 v[56:59], v[236:239], a[56:59], v[56:59]
v_permlane16_swap_b32 v200, v202
v_mfma_f32_16x16x32_bf16 v[60:63], v[236:239], a[60:63], v[60:63]
v_permlane16_swap_b32 v201, v203
s_waitcnt lgkmcnt(4)
v_mfma_f32_16x16x32_bf16 v[0:3], v[224:227], a[64:67], v[0:3]
ds_read_b64_tr_b16 v[236:237], v255 offset:4096
v_mul_f32 v152, s58, v152
v_mfma_f32_16x16x32_bf16 v[4:7], v[224:227], a[68:71], v[4:7]
ds_read_b64_tr_b16 v[238:239], v255 offset:4608
v_mul_f32 v153, s58, v153
v_mfma_f32_16x16x32_bf16 v[8:11], v[224:227], a[72:75], v[8:11]
v_mul_f32 v154, s58, v154
v_mul_f32 v155, s58, v155
v_mfma_f32_16x16x32_bf16 v[12:15], v[224:227], a[76:79], v[12:15]
v_mul_f32 v156, s58, v156
v_mul_f32 v157, s58, v157
s_waitcnt vmcnt(8) lgkmcnt(4)
v_mfma_f32_16x16x32_bf16 v[16:19], v[228:231], a[64:67], v[16:19]
ds_read_b64_tr_b16 v[224:225], v249 offset:8192
s_add_u32 m0, s48, 0x1000
v_mfma_f32_16x16x32_bf16 v[20:23], v[228:231], a[68:71], v[20:23]
ds_read_b64_tr_b16 v[226:227], v249 offset:8704
s_mov_b32 s49, 0x200080
v_mfma_f32_16x16x32_bf16 v[24:27], v[228:231], a[72:75], v[24:27]
s_waitcnt lgkmcnt(2)
buffer_load_dwordx4 v242, s[12:15], s49 offen lds
v_mul_f32 v158, s58, v158
v_mfma_f32_16x16x32_bf16 v[28:31], v[228:231], a[76:79], v[28:31]
buffer_load_dwordx4 v243, s[12:15], s49 offen offset:1024 lds
v_mul_f32 v159, s58, v159
v_mfma_f32_16x16x32_bf16 v[32:35], v[232:235], a[64:67], v[32:35]
ds_read_b64_tr_b16 v[228:229], v251 offset:8192
s_add_u32 m0, s48, 0x1800
v_mfma_f32_16x16x32_bf16 v[36:39], v[232:235], a[68:71], v[36:39]
ds_read_b64_tr_b16 v[230:231], v251 offset:8704
s_mov_b32 s49, 0x220080
v_mfma_f32_16x16x32_bf16 v[40:43], v[232:235], a[72:75], v[40:43]
buffer_load_dwordx4 v242, s[12:15], s49 offen lds
v_cvt_pk_bf16_f32 v204, v152, v153
v_mfma_f32_16x16x32_bf16 v[44:47], v[232:235], a[76:79], v[44:47]
buffer_load_dwordx4 v243, s[12:15], s49 offen offset:1024 lds
v_cvt_pk_bf16_f32 v205, v154, v155
v_mfma_f32_16x16x32_bf16 v[48:51], v[236:239], a[64:67], v[48:51]
ds_read_b64_tr_b16 v[232:233], v254 offset:8192
v_cvt_pk_bf16_f32 v206, v156, v157
v_mfma_f32_16x16x32_bf16 v[52:55], v[236:239], a[68:71], v[52:55]
ds_read_b64_tr_b16 v[234:235], v254 offset:8704
v_cvt_pk_bf16_f32 v207, v158, v159
v_mfma_f32_16x16x32_bf16 v[56:59], v[236:239], a[72:75], v[56:59]
v_permlane16_swap_b32 v204, v206
v_mfma_f32_16x16x32_bf16 v[60:63], v[236:239], a[76:79], v[60:63]
v_permlane16_swap_b32 v205, v207
s_waitcnt lgkmcnt(4)
v_mfma_f32_16x16x32_bf16 v[0:3], v[224:227], a[80:83], v[0:3]
ds_read_b64_tr_b16 v[236:237], v255 offset:8192
v_mul_f32 v160, s58, v160
v_mfma_f32_16x16x32_bf16 v[4:7], v[224:227], a[84:87], v[4:7]
ds_read_b64_tr_b16 v[238:239], v255 offset:8704
v_mul_f32 v161, s58, v161
v_mfma_f32_16x16x32_bf16 v[8:11], v[224:227], a[88:91], v[8:11]
v_mul_f32 v162, s58, v162
v_mul_f32 v163, s58, v163
v_mfma_f32_16x16x32_bf16 v[12:15], v[224:227], a[92:95], v[12:15]
v_mul_f32 v164, s58, v164
v_mul_f32 v165, s58, v165
s_waitcnt vmcnt(8) lgkmcnt(4)
v_mfma_f32_16x16x32_bf16 v[16:19], v[228:231], a[80:83], v[16:19]
ds_read_b64_tr_b16 v[224:225], v249 offset:12288
s_add_u32 m0, s48, 0x2000
v_mfma_f32_16x16x32_bf16 v[20:23], v[228:231], a[84:87], v[20:23]
ds_read_b64_tr_b16 v[226:227], v249 offset:12800
s_mov_b32 s49, 0x240080
v_mfma_f32_16x16x32_bf16 v[24:27], v[228:231], a[88:91], v[24:27]
s_waitcnt lgkmcnt(2)
buffer_load_dwordx4 v242, s[12:15], s49 offen lds
v_mul_f32 v166, s58, v166
v_mfma_f32_16x16x32_bf16 v[28:31], v[228:231], a[92:95], v[28:31]
buffer_load_dwordx4 v243, s[12:15], s49 offen offset:1024 lds
v_mul_f32 v167, s58, v167
v_mfma_f32_16x16x32_bf16 v[32:35], v[232:235], a[80:83], v[32:35]
ds_read_b64_tr_b16 v[228:229], v251 offset:12288
s_add_u32 m0, s48, 0x2800
v_mfma_f32_16x16x32_bf16 v[36:39], v[232:235], a[84:87], v[36:39]
ds_read_b64_tr_b16 v[230:231], v251 offset:12800
s_mov_b32 s49, 0x260080
v_mfma_f32_16x16x32_bf16 v[40:43], v[232:235], a[88:91], v[40:43]
buffer_load_dwordx4 v242, s[12:15], s49 offen lds
v_cvt_pk_bf16_f32 v208, v160, v161
v_mfma_f32_16x16x32_bf16 v[44:47], v[232:235], a[92:95], v[44:47]
buffer_load_dwordx4 v243, s[12:15], s49 offen offset:1024 lds
v_cvt_pk_bf16_f32 v209, v162, v163
v_mfma_f32_16x16x32_bf16 v[48:51], v[236:239], a[80:83], v[48:51]
ds_read_b64_tr_b16 v[232:233], v254 offset:12288
v_cvt_pk_bf16_f32 v210, v164, v165
v_mfma_f32_16x16x32_bf16 v[52:55], v[236:239], a[84:87], v[52:55]
ds_read_b64_tr_b16 v[234:235], v254 offset:12800
v_cvt_pk_bf16_f32 v211, v166, v167
v_mfma_f32_16x16x32_bf16 v[56:59], v[236:239], a[88:91], v[56:59]
v_permlane16_swap_b32 v208, v210
v_mfma_f32_16x16x32_bf16 v[60:63], v[236:239], a[92:95], v[60:63]
v_permlane16_swap_b32 v209, v211
s_waitcnt lgkmcnt(4)
v_mfma_f32_16x16x32_bf16 v[0:3], v[224:227], a[96:99], v[0:3]
ds_read_b64_tr_b16 v[236:237], v255 offset:12288
v_mul_f32 v168, s58, v168
v_mfma_f32_16x16x32_bf16 v[4:7], v[224:227], a[100:103], v[4:7]
ds_read_b64_tr_b16 v[238:239], v255 offset:12800
v_mul_f32 v169, s58, v169
v_mfma_f32_16x16x32_bf16 v[8:11], v[224:227], a[104:107], v[8:11]
v_mul_f32 v170, s58, v170
v_mul_f32 v171, s58, v171
v_mfma_f32_16x16x32_bf16 v[12:15], v[224:227], a[108:111], v[12:15]
v_mul_f32 v172, s58, v172
v_mul_f32 v173, s58, v173
s_waitcnt vmcnt(8) lgkmcnt(4)
v_mfma_f32_16x16x32_bf16 v[16:19], v[228:231], a[96:99], v[16:19]
ds_read_b64_tr_b16 v[224:225], v249
s_add_u32 m0, s48, 0x3000
v_mfma_f32_16x16x32_bf16 v[20:23], v[228:231], a[100:103], v[20:23]
ds_read_b64_tr_b16 v[226:227], v249 offset:512
s_mov_b32 s49, 0x280080
v_mfma_f32_16x16x32_bf16 v[24:27], v[228:231], a[104:107], v[24:27]
s_waitcnt lgkmcnt(2)
buffer_load_dwordx4 v242, s[12:15], s49 offen lds
v_mul_f32 v174, s58, v174
v_mfma_f32_16x16x32_bf16 v[28:31], v[228:231], a[108:111], v[28:31]
buffer_load_dwordx4 v243, s[12:15], s49 offen offset:1024 lds
v_mul_f32 v175, s58, v175
v_mfma_f32_16x16x32_bf16 v[32:35], v[232:235], a[96:99], v[32:35]
ds_read_b64_tr_b16 v[228:229], v251
s_add_u32 m0, s48, 0x3800
v_mfma_f32_16x16x32_bf16 v[36:39], v[232:235], a[100:103], v[36:39]
ds_read_b64_tr_b16 v[230:231], v251 offset:512
s_mov_b32 s49, 0x2a0080
v_mfma_f32_16x16x32_bf16 v[40:43], v[232:235], a[104:107], v[40:43]
buffer_load_dwordx4 v242, s[12:15], s49 offen lds
v_cvt_pk_bf16_f32 v212, v168, v169
v_mfma_f32_16x16x32_bf16 v[44:47], v[232:235], a[108:111], v[44:47]
buffer_load_dwordx4 v243, s[12:15], s49 offen offset:1024 lds
v_cvt_pk_bf16_f32 v213, v170, v171
v_mfma_f32_16x16x32_bf16 v[48:51], v[236:239], a[96:99], v[48:51]
ds_read_b64_tr_b16 v[232:233], v254
v_cvt_pk_bf16_f32 v214, v172, v173
v_mfma_f32_16x16x32_bf16 v[52:55], v[236:239], a[100:103], v[52:55]
ds_read_b64_tr_b16 v[234:235], v254 offset:512
v_cvt_pk_bf16_f32 v215, v174, v175
v_mfma_f32_16x16x32_bf16 v[56:59], v[236:239], a[104:107], v[56:59]
v_permlane16_swap_b32 v212, v214
v_mfma_f32_16x16x32_bf16 v[60:63], v[236:239], a[108:111], v[60:63]
v_permlane16_swap_b32 v213, v215
s_waitcnt lgkmcnt(4)
v_mfma_f32_16x16x32_bf16 v[0:3], v[224:227], a[112:115], v[0:3]
ds_read_b64_tr_b16 v[236:237], v255
v_mul_f32 v176, s58, v176
v_mfma_f32_16x16x32_bf16 v[4:7], v[224:227], a[116:119], v[4:7]
ds_read_b64_tr_b16 v[238:239], v255 offset:512
v_mul_f32 v177, s58, v177
v_mfma_f32_16x16x32_bf16 v[8:11], v[224:227], a[120:123], v[8:11]
v_mul_f32 v178, s58, v178
v_mul_f32 v179, s58, v179
v_mfma_f32_16x16x32_bf16 v[12:15], v[224:227], a[124:127], v[12:15]
v_mul_f32 v180, s58, v180
v_mul_f32 v181, s58, v181
s_waitcnt vmcnt(8) lgkmcnt(4)
v_mfma_f32_16x16x32_bf16 v[16:19], v[228:231], a[112:115], v[16:19]
ds_read_b64_tr_b16 v[224:225], v249 offset:4096
s_add_u32 m0, s48, 0
v_mfma_f32_16x16x32_bf16 v[20:23], v[228:231], a[116:119], v[20:23]
ds_read_b64_tr_b16 v[226:227], v249 offset:4608
s_mov_b32 s49, 0x2c0080
v_mfma_f32_16x16x32_bf16 v[24:27], v[228:231], a[120:123], v[24:27]
s_waitcnt lgkmcnt(2)
buffer_load_dwordx4 v242, s[12:15], s49 offen lds
v_mul_f32 v182, s58, v182
v_mfma_f32_16x16x32_bf16 v[28:31], v[228:231], a[124:127], v[28:31]
buffer_load_dwordx4 v243, s[12:15], s49 offen offset:1024 lds
v_mul_f32 v183, s58, v183
v_mfma_f32_16x16x32_bf16 v[32:35], v[232:235], a[112:115], v[32:35]
ds_read_b64_tr_b16 v[228:229], v251 offset:4096
s_add_u32 m0, s48, 0x800
v_mfma_f32_16x16x32_bf16 v[36:39], v[232:235], a[116:119], v[36:39]
ds_read_b64_tr_b16 v[230:231], v251 offset:4608
s_mov_b32 s49, 0x2e0080
v_mfma_f32_16x16x32_bf16 v[40:43], v[232:235], a[120:123], v[40:43]
buffer_load_dwordx4 v242, s[12:15], s49 offen lds
v_cvt_pk_bf16_f32 v216, v176, v177
v_mfma_f32_16x16x32_bf16 v[44:47], v[232:235], a[124:127], v[44:47]
buffer_load_dwordx4 v243, s[12:15], s49 offen offset:1024 lds
v_cvt_pk_bf16_f32 v217, v178, v179
v_mfma_f32_16x16x32_bf16 v[48:51], v[236:239], a[112:115], v[48:51]
ds_read_b64_tr_b16 v[232:233], v254 offset:4096
v_cvt_pk_bf16_f32 v218, v180, v181
v_mfma_f32_16x16x32_bf16 v[52:55], v[236:239], a[116:119], v[52:55]
ds_read_b64_tr_b16 v[234:235], v254 offset:4608
v_cvt_pk_bf16_f32 v219, v182, v183
v_mfma_f32_16x16x32_bf16 v[56:59], v[236:239], a[120:123], v[56:59]
v_permlane16_swap_b32 v216, v218
v_mfma_f32_16x16x32_bf16 v[60:63], v[236:239], a[124:127], v[60:63]
v_permlane16_swap_b32 v217, v219
s_waitcnt lgkmcnt(4)
v_mfma_f32_16x16x32_bf16 v[0:3], v[224:227], a[128:131], v[0:3]
ds_read_b64_tr_b16 v[236:237], v255 offset:4096
v_mul_f32 v184, s58, v184
v_mfma_f32_16x16x32_bf16 v[4:7], v[224:227], a[132:135], v[4:7]
ds_read_b64_tr_b16 v[238:239], v255 offset:4608
v_mul_f32 v185, s58, v185
v_mfma_f32_16x16x32_bf16 v[8:11], v[224:227], a[136:139], v[8:11]
v_mul_f32 v186, s58, v186
v_mul_f32 v187, s58, v187
v_mfma_f32_16x16x32_bf16 v[12:15], v[224:227], a[140:143], v[12:15]
v_mul_f32 v188, s58, v188
v_mul_f32 v189, s58, v189
s_waitcnt vmcnt(8) lgkmcnt(4)
v_mfma_f32_16x16x32_bf16 v[16:19], v[228:231], a[128:131], v[16:19]
ds_read_b64_tr_b16 v[224:225], v249 offset:8192
s_add_u32 m0, s48, 0x1000
v_mfma_f32_16x16x32_bf16 v[20:23], v[228:231], a[132:135], v[20:23]
ds_read_b64_tr_b16 v[226:227], v249 offset:8704
s_mov_b32 s49, 0x300080
v_mfma_f32_16x16x32_bf16 v[24:27], v[228:231], a[136:139], v[24:27]
s_waitcnt lgkmcnt(2)
buffer_load_dwordx4 v242, s[12:15], s49 offen lds
v_mul_f32 v190, s58, v190
v_mfma_f32_16x16x32_bf16 v[28:31], v[228:231], a[140:143], v[28:31]
buffer_load_dwordx4 v243, s[12:15], s49 offen offset:1024 lds
v_mul_f32 v191, s58, v191
v_mfma_f32_16x16x32_bf16 v[32:35], v[232:235], a[128:131], v[32:35]
ds_read_b64_tr_b16 v[228:229], v251 offset:8192
s_add_u32 m0, s48, 0x1800
v_mfma_f32_16x16x32_bf16 v[36:39], v[232:235], a[132:135], v[36:39]
ds_read_b64_tr_b16 v[230:231], v251 offset:8704
s_mov_b32 s49, 0x320080
v_mfma_f32_16x16x32_bf16 v[40:43], v[232:235], a[136:139], v[40:43]
buffer_load_dwordx4 v242, s[12:15], s49 offen lds
v_cvt_pk_bf16_f32 v220, v184, v185
v_mfma_f32_16x16x32_bf16 v[44:47], v[232:235], a[140:143], v[44:47]
buffer_load_dwordx4 v243, s[12:15], s49 offen offset:1024 lds
v_cvt_pk_bf16_f32 v221, v186, v187
v_mfma_f32_16x16x32_bf16 v[48:51], v[236:239], a[128:131], v[48:51]
ds_read_b64_tr_b16 v[232:233], v254 offset:8192
v_cvt_pk_bf16_f32 v222, v188, v189
v_mfma_f32_16x16x32_bf16 v[52:55], v[236:239], a[132:135], v[52:55]
ds_read_b64_tr_b16 v[234:235], v254 offset:8704
v_cvt_pk_bf16_f32 v223, v190, v191
v_mfma_f32_16x16x32_bf16 v[56:59], v[236:239], a[136:139], v[56:59]
v_permlane16_swap_b32 v220, v222
v_mfma_f32_16x16x32_bf16 v[60:63], v[236:239], a[140:143], v[60:63]
v_permlane16_swap_b32 v221, v223
s_waitcnt lgkmcnt(4)
v_mfma_f32_16x16x32_bf16 v[0:3], v[224:227], a[144:147], v[0:3]
ds_read_b64_tr_b16 v[236:237], v255 offset:8192
v_mfma_f32_16x16x32_bf16 v[4:7], v[224:227], a[148:151], v[4:7]
ds_read_b64_tr_b16 v[238:239], v255 offset:8704
v_mfma_f32_16x16x32_bf16 v[8:11], v[224:227], a[152:155], v[8:11]
v_mfma_f32_16x16x32_bf16 v[12:15], v[224:227], a[156:159], v[12:15]
s_waitcnt vmcnt(8) lgkmcnt(4)
v_mfma_f32_16x16x32_bf16 v[16:19], v[228:231], a[144:147], v[16:19]
ds_read_b64_tr_b16 v[224:225], v249 offset:12288
s_add_u32 m0, s48, 0x2000
v_mfma_f32_16x16x32_bf16 v[20:23], v[228:231], a[148:151], v[20:23]
ds_read_b64_tr_b16 v[226:227], v249 offset:12800
s_mov_b32 s49, 0x340080
v_mfma_f32_16x16x32_bf16 v[24:27], v[228:231], a[152:155], v[24:27]
s_waitcnt lgkmcnt(2)
buffer_load_dwordx4 v242, s[12:15], s49 offen lds
v_mfma_f32_16x16x32_bf16 v[28:31], v[228:231], a[156:159], v[28:31]
buffer_load_dwordx4 v243, s[12:15], s49 offen offset:1024 lds
v_mfma_f32_16x16x32_bf16 v[32:35], v[232:235], a[144:147], v[32:35]
ds_read_b64_tr_b16 v[228:229], v251 offset:12288
s_add_u32 m0, s48, 0x2800
v_mfma_f32_16x16x32_bf16 v[36:39], v[232:235], a[148:151], v[36:39]
ds_read_b64_tr_b16 v[230:231], v251 offset:12800
s_mov_b32 s49, 0x360080
v_mfma_f32_16x16x32_bf16 v[40:43], v[232:235], a[152:155], v[40:43]
buffer_load_dwordx4 v242, s[12:15], s49 offen lds
v_mfma_f32_16x16x32_bf16 v[44:47], v[232:235], a[156:159], v[44:47]
buffer_load_dwordx4 v243, s[12:15], s49 offen offset:1024 lds
v_mfma_f32_16x16x32_bf16 v[48:51], v[236:239], a[144:147], v[48:51]
ds_read_b64_tr_b16 v[232:233], v254 offset:12288
v_mfma_f32_16x16x32_bf16 v[52:55], v[236:239], a[148:151], v[52:55]
ds_read_b64_tr_b16 v[234:235], v254 offset:12800
v_mfma_f32_16x16x32_bf16 v[56:59], v[236:239], a[152:155], v[56:59]
v_mfma_f32_16x16x32_bf16 v[60:63], v[236:239], a[156:159], v[60:63]
s_waitcnt lgkmcnt(4)
v_mfma_f32_16x16x32_bf16 v[0:3], v[224:227], a[160:163], v[0:3]
ds_read_b64_tr_b16 v[236:237], v255 offset:12288
v_mfma_f32_16x16x32_bf16 v[4:7], v[224:227], a[164:167], v[4:7]
ds_read_b64_tr_b16 v[238:239], v255 offset:12800
v_mfma_f32_16x16x32_bf16 v[8:11], v[224:227], a[168:171], v[8:11]
v_mfma_f32_16x16x32_bf16 v[12:15], v[224:227], a[172:175], v[12:15]
s_waitcnt vmcnt(8) lgkmcnt(4)
v_mfma_f32_16x16x32_bf16 v[16:19], v[228:231], a[160:163], v[16:19]
ds_read_b64_tr_b16 v[224:225], v249
s_add_u32 m0, s48, 0x3000
v_mfma_f32_16x16x32_bf16 v[20:23], v[228:231], a[164:167], v[20:23]
ds_read_b64_tr_b16 v[226:227], v249 offset:512
s_mov_b32 s49, 0x380080
v_mfma_f32_16x16x32_bf16 v[24:27], v[228:231], a[168:171], v[24:27]
s_waitcnt lgkmcnt(2)
buffer_load_dwordx4 v242, s[12:15], s49 offen lds
v_mfma_f32_16x16x32_bf16 v[28:31], v[228:231], a[172:175], v[28:31]
buffer_load_dwordx4 v243, s[12:15], s49 offen offset:1024 lds
v_mfma_f32_16x16x32_bf16 v[32:35], v[232:235], a[160:163], v[32:35]
ds_read_b64_tr_b16 v[228:229], v251
s_add_u32 m0, s48, 0x3800
v_mfma_f32_16x16x32_bf16 v[36:39], v[232:235], a[164:167], v[36:39]
ds_read_b64_tr_b16 v[230:231], v251 offset:512
s_mov_b32 s49, 0x3a0080
v_mfma_f32_16x16x32_bf16 v[40:43], v[232:235], a[168:171], v[40:43]
buffer_load_dwordx4 v242, s[12:15], s49 offen lds
v_mfma_f32_16x16x32_bf16 v[44:47], v[232:235], a[172:175], v[44:47]
buffer_load_dwordx4 v243, s[12:15], s49 offen offset:1024 lds
v_mfma_f32_16x16x32_bf16 v[48:51], v[236:239], a[160:163], v[48:51]
ds_read_b64_tr_b16 v[232:233], v254
v_mfma_f32_16x16x32_bf16 v[52:55], v[236:239], a[164:167], v[52:55]
ds_read_b64_tr_b16 v[234:235], v254 offset:512
v_mfma_f32_16x16x32_bf16 v[56:59], v[236:239], a[168:171], v[56:59]
v_mfma_f32_16x16x32_bf16 v[60:63], v[236:239], a[172:175], v[60:63]
s_waitcnt lgkmcnt(4)
v_mfma_f32_16x16x32_bf16 v[0:3], v[224:227], a[176:179], v[0:3]
ds_read_b64_tr_b16 v[236:237], v255
v_mfma_f32_16x16x32_bf16 v[4:7], v[224:227], a[180:183], v[4:7]
ds_read_b64_tr_b16 v[238:239], v255 offset:512
v_mfma_f32_16x16x32_bf16 v[8:11], v[224:227], a[184:187], v[8:11]
v_mfma_f32_16x16x32_bf16 v[12:15], v[224:227], a[188:191], v[12:15]
s_waitcnt vmcnt(8) lgkmcnt(4)
v_mfma_f32_16x16x32_bf16 v[16:19], v[228:231], a[176:179], v[16:19]
ds_read_b64_tr_b16 v[224:225], v249 offset:4096
s_add_u32 m0, s48, 0
v_mfma_f32_16x16x32_bf16 v[20:23], v[228:231], a[180:183], v[20:23]
ds_read_b64_tr_b16 v[226:227], v249 offset:4608
s_mov_b32 s49, 0x3c0080
v_mfma_f32_16x16x32_bf16 v[24:27], v[228:231], a[184:187], v[24:27]
s_waitcnt lgkmcnt(2)
buffer_load_dwordx4 v242, s[12:15], s49 offen lds
v_mfma_f32_16x16x32_bf16 v[28:31], v[228:231], a[188:191], v[28:31]
buffer_load_dwordx4 v243, s[12:15], s49 offen offset:1024 lds
v_mfma_f32_16x16x32_bf16 v[32:35], v[232:235], a[176:179], v[32:35]
ds_read_b64_tr_b16 v[228:229], v251 offset:4096
s_add_u32 m0, s48, 0x800
v_mfma_f32_16x16x32_bf16 v[36:39], v[232:235], a[180:183], v[36:39]
ds_read_b64_tr_b16 v[230:231], v251 offset:4608
s_mov_b32 s49, 0x3e0080
v_mfma_f32_16x16x32_bf16 v[40:43], v[232:235], a[184:187], v[40:43]
buffer_load_dwordx4 v242, s[12:15], s49 offen lds
v_mfma_f32_16x16x32_bf16 v[44:47], v[232:235], a[188:191], v[44:47]
buffer_load_dwordx4 v243, s[12:15], s49 offen offset:1024 lds
v_mfma_f32_16x16x32_bf16 v[48:51], v[236:239], a[176:179], v[48:51]
ds_read_b64_tr_b16 v[232:233], v254 offset:4096
v_mfma_f32_16x16x32_bf16 v[52:55], v[236:239], a[180:183], v[52:55]
ds_read_b64_tr_b16 v[234:235], v254 offset:4608
v_mfma_f32_16x16x32_bf16 v[56:59], v[236:239], a[184:187], v[56:59]
v_mfma_f32_16x16x32_bf16 v[60:63], v[236:239], a[188:191], v[60:63]
s_waitcnt lgkmcnt(4)
v_mfma_f32_16x16x32_bf16 v[0:3], v[224:227], a[192:195], v[0:3]
ds_read_b64_tr_b16 v[236:237], v255 offset:4096
v_mfma_f32_16x16x32_bf16 v[4:7], v[224:227], a[196:199], v[4:7]
ds_read_b64_tr_b16 v[238:239], v255 offset:4608
v_mfma_f32_16x16x32_bf16 v[8:11], v[224:227], a[200:203], v[8:11]
v_mfma_f32_16x16x32_bf16 v[12:15], v[224:227], a[204:207], v[12:15]
s_waitcnt vmcnt(8) lgkmcnt(4)
v_mfma_f32_16x16x32_bf16 v[16:19], v[228:231], a[192:195], v[16:19]
ds_read_b64_tr_b16 v[224:225], v249 offset:8192
s_add_u32 m0, s48, 0x1000
v_mfma_f32_16x16x32_bf16 v[20:23], v[228:231], a[196:199], v[20:23]
ds_read_b64_tr_b16 v[226:227], v249 offset:8704
s_add_u32 s49, s54, 0
v_mfma_f32_16x16x32_bf16 v[24:27], v[228:231], a[200:203], v[24:27]
s_waitcnt lgkmcnt(2)
buffer_load_dwordx4 v244, s[28:31], s49 offen lds
v_mfma_f32_16x16x32_bf16 v[28:31], v[228:231], a[204:207], v[28:31]
buffer_load_dwordx4 v245, s[28:31], s49 offen offset:1024 lds
v_mfma_f32_16x16x32_bf16 v[32:35], v[232:235], a[192:195], v[32:35]
ds_read_b64_tr_b16 v[228:229], v251 offset:8192
s_add_u32 m0, s48, 0x1800
v_mfma_f32_16x16x32_bf16 v[36:39], v[232:235], a[196:199], v[36:39]
ds_read_b64_tr_b16 v[230:231], v251 offset:8704
s_add_u32 s49, s54, 0x4000
v_mfma_f32_16x16x32_bf16 v[40:43], v[232:235], a[200:203], v[40:43]
buffer_load_dwordx4 v244, s[28:31], s49 offen lds
v_mfma_f32_16x16x32_bf16 v[44:47], v[232:235], a[204:207], v[44:47]
buffer_load_dwordx4 v245, s[28:31], s49 offen offset:1024 lds
v_mfma_f32_16x16x32_bf16 v[48:51], v[236:239], a[192:195], v[48:51]
ds_read_b64_tr_b16 v[232:233], v254 offset:8192
v_mfma_f32_16x16x32_bf16 v[52:55], v[236:239], a[196:199], v[52:55]
ds_read_b64_tr_b16 v[234:235], v254 offset:8704
v_mfma_f32_16x16x32_bf16 v[56:59], v[236:239], a[200:203], v[56:59]
v_mfma_f32_16x16x32_bf16 v[60:63], v[236:239], a[204:207], v[60:63]
s_waitcnt lgkmcnt(4)
v_mfma_f32_16x16x32_bf16 v[0:3], v[224:227], a[208:211], v[0:3]
ds_read_b64_tr_b16 v[236:237], v255 offset:8192
v_mfma_f32_16x16x32_bf16 v[4:7], v[224:227], a[212:215], v[4:7]
ds_read_b64_tr_b16 v[238:239], v255 offset:8704
v_mfma_f32_16x16x32_bf16 v[8:11], v[224:227], a[216:219], v[8:11]
v_mfma_f32_16x16x32_bf16 v[12:15], v[224:227], a[220:223], v[12:15]
s_waitcnt vmcnt(8) lgkmcnt(4)
v_mfma_f32_16x16x32_bf16 v[16:19], v[228:231], a[208:211], v[16:19]
ds_read_b64_tr_b16 v[224:225], v249 offset:12288
s_add_u32 m0, s48, 0x2000
v_mfma_f32_16x16x32_bf16 v[20:23], v[228:231], a[212:215], v[20:23]
ds_read_b64_tr_b16 v[226:227], v249 offset:12800
s_add_u32 s49, s54, 0x8000
v_mfma_f32_16x16x32_bf16 v[24:27], v[228:231], a[216:219], v[24:27]
s_waitcnt lgkmcnt(2)
buffer_load_dwordx4 v244, s[28:31], s49 offen lds
v_mfma_f32_16x16x32_bf16 v[28:31], v[228:231], a[220:223], v[28:31]
buffer_load_dwordx4 v245, s[28:31], s49 offen offset:1024 lds
v_mfma_f32_16x16x32_bf16 v[32:35], v[232:235], a[208:211], v[32:35]
ds_read_b64_tr_b16 v[228:229], v251 offset:12288
s_add_u32 m0, s48, 0x2800
v_mfma_f32_16x16x32_bf16 v[36:39], v[232:235], a[212:215], v[36:39]
ds_read_b64_tr_b16 v[230:231], v251 offset:12800
s_add_u32 s49, s54, 0xc000
v_mfma_f32_16x16x32_bf16 v[40:43], v[232:235], a[216:219], v[40:43]
buffer_load_dwordx4 v244, s[28:31], s49 offen lds
v_mfma_f32_16x16x32_bf16 v[44:47], v[232:235], a[220:223], v[44:47]
buffer_load_dwordx4 v245, s[28:31], s49 offen offset:1024 lds
v_mfma_f32_16x16x32_bf16 v[48:51], v[236:239], a[208:211], v[48:51]
ds_read_b64_tr_b16 v[232:233], v254 offset:12288
v_mfma_f32_16x16x32_bf16 v[52:55], v[236:239], a[212:215], v[52:55]
ds_read_b64_tr_b16 v[234:235], v254 offset:12800
v_mfma_f32_16x16x32_bf16 v[56:59], v[236:239], a[216:219], v[56:59]
v_mfma_f32_16x16x32_bf16 v[60:63], v[236:239], a[220:223], v[60:63]
s_waitcnt lgkmcnt(4)
v_mfma_f32_16x16x32_bf16 v[0:3], v[224:227], a[224:227], v[0:3]
ds_read_b64_tr_b16 v[236:237], v255 offset:12288
v_mfma_f32_16x16x32_bf16 v[4:7], v[224:227], a[228:231], v[4:7]
ds_read_b64_tr_b16 v[238:239], v255 offset:12800
v_mfma_f32_16x16x32_bf16 v[8:11], v[224:227], a[232:235], v[8:11]
v_mfma_f32_16x16x32_bf16 v[12:15], v[224:227], a[236:239], v[12:15]
s_waitcnt vmcnt(8) lgkmcnt(4)
v_mfma_f32_16x16x32_bf16 v[16:19], v[228:231], a[224:227], v[16:19]
ds_read_b64_tr_b16 v[224:225], v249
s_add_u32 m0, s48, 0x3000
v_mfma_f32_16x16x32_bf16 v[20:23], v[228:231], a[228:231], v[20:23]
ds_read_b64_tr_b16 v[226:227], v249 offset:512
s_add_u32 s49, s54, 0x10000
v_mfma_f32_16x16x32_bf16 v[24:27], v[228:231], a[232:235], v[24:27]
s_waitcnt lgkmcnt(2)
buffer_load_dwordx4 v244, s[28:31], s49 offen lds
v_mfma_f32_16x16x32_bf16 v[28:31], v[228:231], a[236:239], v[28:31]
buffer_load_dwordx4 v245, s[28:31], s49 offen offset:1024 lds
v_mfma_f32_16x16x32_bf16 v[32:35], v[232:235], a[224:227], v[32:35]
ds_read_b64_tr_b16 v[228:229], v251
s_add_u32 m0, s48, 0x3800
v_mfma_f32_16x16x32_bf16 v[36:39], v[232:235], a[228:231], v[36:39]
ds_read_b64_tr_b16 v[230:231], v251 offset:512
s_add_u32 s49, s54, 0x14000
v_mfma_f32_16x16x32_bf16 v[40:43], v[232:235], a[232:235], v[40:43]
buffer_load_dwordx4 v244, s[28:31], s49 offen lds
v_mfma_f32_16x16x32_bf16 v[44:47], v[232:235], a[236:239], v[44:47]
buffer_load_dwordx4 v245, s[28:31], s49 offen offset:1024 lds
v_mfma_f32_16x16x32_bf16 v[48:51], v[236:239], a[224:227], v[48:51]
ds_read_b64_tr_b16 v[232:233], v254
v_mfma_f32_16x16x32_bf16 v[52:55], v[236:239], a[228:231], v[52:55]
ds_read_b64_tr_b16 v[234:235], v254 offset:512
v_mfma_f32_16x16x32_bf16 v[56:59], v[236:239], a[232:235], v[56:59]
v_mfma_f32_16x16x32_bf16 v[60:63], v[236:239], a[236:239], v[60:63]
s_waitcnt lgkmcnt(4)
v_mfma_f32_16x16x32_bf16 v[0:3], v[224:227], a[240:243], v[0:3]
ds_read_b64_tr_b16 v[236:237], v255
v_mfma_f32_16x16x32_bf16 v[4:7], v[224:227], a[244:247], v[4:7]
ds_read_b64_tr_b16 v[238:239], v255 offset:512
v_mfma_f32_16x16x32_bf16 v[8:11], v[224:227], a[248:251], v[8:11]
v_mfma_f32_16x16x32_bf16 v[12:15], v[224:227], a[252:255], v[12:15]
s_waitcnt lgkmcnt(4)
v_mfma_f32_16x16x32_bf16 v[16:19], v[228:231], a[240:243], v[16:19]
s_add_u32 m0, s48, 0
v_mfma_f32_16x16x32_bf16 v[20:23], v[228:231], a[244:247], v[20:23]
s_add_u32 s49, s54, 0x18000
v_mfma_f32_16x16x32_bf16 v[24:27], v[228:231], a[248:251], v[24:27]
s_waitcnt lgkmcnt(0)
buffer_load_dwordx4 v244, s[28:31], s49 offen lds
v_mfma_f32_16x16x32_bf16 v[28:31], v[228:231], a[252:255], v[28:31]
buffer_load_dwordx4 v245, s[28:31], s49 offen offset:1024 lds
v_mfma_f32_16x16x32_bf16 v[32:35], v[232:235], a[240:243], v[32:35]
s_waitcnt vmcnt(12)
ds_read_b64_tr_b16 v[224:225], v246 offset:4096
s_add_u32 m0, s48, 0x800
v_mfma_f32_16x16x32_bf16 v[36:39], v[232:235], a[244:247], v[36:39]
ds_read_b64_tr_b16 v[226:227], v246 offset:4608
s_add_u32 s49, s54, 0x1c000
v_mfma_f32_16x16x32_bf16 v[40:43], v[232:235], a[248:251], v[40:43]
ds_read_b64_tr_b16 v[228:229], v247 offset:4096
buffer_load_dwordx4 v244, s[28:31], s49 offen lds
v_mfma_f32_16x16x32_bf16 v[44:47], v[232:235], a[252:255], v[44:47]
ds_read_b64_tr_b16 v[230:231], v247 offset:4608
buffer_load_dwordx4 v245, s[28:31], s49 offen offset:1024 lds
v_mfma_f32_16x16x32_bf16 v[48:51], v[236:239], a[240:243], v[48:51]
v_mfma_f32_16x16x32_bf16 v[52:55], v[236:239], a[244:247], v[52:55]
v_mfma_f32_16x16x32_bf16 v[56:59], v[236:239], a[248:251], v[56:59]
v_mfma_f32_16x16x32_bf16 v[60:63], v[236:239], a[252:255], v[60:63]
ds_read_b128 a[192:195], v248
ds_read_b128 a[196:199], v248 offset:1024
s_waitcnt vmcnt(12) lgkmcnt(1)
v_mfma_f32_32x32x16_bf16 v[64:79], v[224:227], a[192:195], 0
ds_read_b64_tr_b16 v[232:233], v246 offset:6144
ds_read_b64_tr_b16 v[234:235], v246 offset:6656
ds_read_b128 a[200:203], v248 offset:2048
s_waitcnt lgkmcnt(3)
v_mfma_f32_32x32x16_bf16 v[80:95], v[224:227], a[196:199], 0
ds_read_b128 a[204:207], v248 offset:3072
ds_read_b64_tr_b16 v[236:237], v247 offset:6144
ds_read_b64_tr_b16 v[238:239], v247 offset:6656
s_add_u32 m0, s48, 0x1000
s_add_u32 s49, s54, 0x20000
v_mfma_f32_32x32x16_bf16 v[96:111], v[228:231], a[192:195], 0
buffer_load_dwordx4 v244, s[28:31], s49 offen lds
v_mfma_f32_32x32x16_bf16 v[112:127], v[228:231], a[196:199], 0
buffer_load_dwordx4 v245, s[28:31], s49 offen offset:1024 lds
s_waitcnt vmcnt(12) lgkmcnt(3)
v_mfma_f32_32x32x16_bf16 v[64:79], v[232:235], a[200:203], v[64:79]
ds_read_b64_tr_b16 v[224:225], v246 offset:8192
ds_read_b64_tr_b16 v[226:227], v246 offset:8704
ds_read_b128 a[192:195], v248 offset:4096
v_mul_f32 v0, s58, v0
v_mul_f32 v1, s58, v1
v_mul_f32 v2, s58, v2
v_mul_f32 v3, s58, v3
s_waitcnt lgkmcnt(5)
v_mfma_f32_32x32x16_bf16 v[80:95], v[232:235], a[204:207], v[80:95]
ds_read_b128 a[196:199], v248 offset:5120
ds_read_b64_tr_b16 v[228:229], v247 offset:8192
ds_read_b64_tr_b16 v[230:231], v247 offset:8704
s_add_u32 m0, s48, 0x1800
s_add_u32 s49, s54, 0x24000
v_mul_f32 v4, s58, v4
v_mul_f32 v5, s58, v5
v_mul_f32 v6, s58, v6
v_mul_f32 v7, s58, v7
s_waitcnt lgkmcnt(6)
v_mfma_f32_32x32x16_bf16 v[96:111], v[236:239], a[200:203], v[96:111]
buffer_load_dwordx4 v244, s[28:31], s49 offen lds
v_cvt_pk_bf16_f32 v0, v0, v1
v_cvt_pk_bf16_f32 v1, v2, v3
v_cvt_pk_bf16_f32 v2, v4, v5
v_cvt_pk_bf16_f32 v3, v6, v7
v_mfma_f32_32x32x16_bf16 v[112:127], v[236:239], a[204:207], v[112:127]
buffer_load_dwordx4 v245, s[28:31], s49 offen offset:1024 lds
v_permlane16_swap_b32 v0, v2
v_permlane16_swap_b32 v1, v3
v_mul_f32 v8, s58, v8
v_mul_f32 v9, s58, v9
s_waitcnt vmcnt(12) lgkmcnt(3)
v_mfma_f32_32x32x16_bf16 v[64:79], v[224:227], a[192:195], v[64:79]
ds_read_b64_tr_b16 v[232:233], v246 offset:10240
ds_read_b64_tr_b16 v[234:235], v246 offset:10752
ds_read_b128 a[200:203], v248 offset:6144
s_lshl_b32 s6, s101, 14
s_add_u32 s6, s6, s55
v_mul_f32 v10, s58, v10
v_mul_f32 v11, s58, v11
v_mul_f32 v12, s58, v12
v_mul_f32 v13, s58, v13
s_waitcnt lgkmcnt(5)
v_mfma_f32_32x32x16_bf16 v[80:95], v[224:227], a[196:199], v[80:95]
ds_read_b128 a[204:207], v248 offset:7168
ds_read_b64_tr_b16 v[236:237], v247 offset:10240
ds_read_b64_tr_b16 v[238:239], v247 offset:10752
s_add_u32 m0, s48, 0x2000
s_add_u32 s49, s54, 0x28000
v_mul_f32 v14, s58, v14
v_mul_f32 v15, s58, v15
v_cvt_pk_bf16_f32 v4, v8, v9
v_cvt_pk_bf16_f32 v5, v10, v11
s_waitcnt lgkmcnt(6)
v_mfma_f32_32x32x16_bf16 v[96:111], v[228:231], a[192:195], v[96:111]
buffer_load_dwordx4 v244, s[28:31], s49 offen lds
buffer_load_dword v190, v244, s[16:19], s6 offen
v_cvt_pk_bf16_f32 v6, v12, v13
v_cvt_pk_bf16_f32 v7, v14, v15
s_nop 0
v_permlane16_swap_b32 v4, v6
v_permlane16_swap_b32 v5, v7
v_mfma_f32_32x32x16_bf16 v[112:127], v[228:231], a[196:199], v[112:127]
buffer_load_dwordx4 v245, s[28:31], s49 offen offset:1024 lds
buffer_load_dword v191, v245, s[16:19], s6 offen offset:1024
v_mul_f32 v16, s58, v16
v_mul_f32 v17, s58, v17
v_mul_f32 v18, s58, v18
v_mul_f32 v19, s58, v19
s_waitcnt vmcnt(14) lgkmcnt(3)
v_mfma_f32_32x32x16_bf16 v[64:79], v[232:235], a[200:203], v[64:79]
ds_read_b64_tr_b16 v[224:225], v246 offset:12288
ds_read_b64_tr_b16 v[226:227], v246 offset:12800
ds_read_b128 a[192:195], v248 offset:8192
v_mul_f32 v20, s58, v20
v_mul_f32 v21, s58, v21
v_mul_f32 v22, s58, v22
v_mul_f32 v23, s58, v23
s_waitcnt lgkmcnt(5)
v_mfma_f32_32x32x16_bf16 v[80:95], v[232:235], a[204:207], v[80:95]
ds_read_b128 a[196:199], v248 offset:9216
ds_read_b64_tr_b16 v[228:229], v247 offset:12288
ds_read_b64_tr_b16 v[230:231], v247 offset:12800
s_add_u32 m0, s48, 0x2800
s_add_u32 s49, s54, 0x2c000
v_cvt_pk_bf16_f32 v8, v16, v17
v_cvt_pk_bf16_f32 v9, v18, v19
v_cvt_pk_bf16_f32 v10, v20, v21
v_cvt_pk_bf16_f32 v11, v22, v23
s_waitcnt lgkmcnt(6)
v_mfma_f32_32x32x16_bf16 v[96:111], v[236:239], a[200:203], v[96:111]
buffer_load_dwordx4 v244, s[28:31], s49 offen lds
v_permlane16_swap_b32 v8, v10
v_permlane16_swap_b32 v9, v11
v_mul_f32 v24, s58, v24
v_mul_f32 v25, s58, v25
v_mfma_f32_32x32x16_bf16 v[112:127], v[236:239], a[204:207], v[112:127]
buffer_load_dwordx4 v245, s[28:31], s49 offen offset:1024 lds
v_mul_f32 v26, s58, v26
v_mul_f32 v27, s58, v27
v_mul_f32 v28, s58, v28
v_mul_f32 v29, s58, v29
s_waitcnt vmcnt(14) lgkmcnt(3)
v_mfma_f32_32x32x16_bf16 v[64:79], v[224:227], a[192:195], v[64:79]
ds_read_b64_tr_b16 v[232:233], v246 offset:14336
ds_read_b64_tr_b16 v[234:235], v246 offset:14848
ds_read_b128 a[200:203], v248 offset:10240
v_mul_f32 v30, s58, v30
v_mul_f32 v31, s58, v31
v_cvt_pk_bf16_f32 v12, v24, v25
v_cvt_pk_bf16_f32 v13, v26, v27
s_waitcnt lgkmcnt(5)
v_mfma_f32_32x32x16_bf16 v[80:95], v[224:227], a[196:199], v[80:95]
ds_read_b128 a[204:207], v248 offset:11264
ds_read_b64_tr_b16 v[236:237], v247 offset:14336
ds_read_b64_tr_b16 v[238:239], v247 offset:14848
s_add_u32 m0, s48, 0x3000
s_add_u32 s49, s54, 0x30000
v_cvt_pk_bf16_f32 v14, v28, v29
v_cvt_pk_bf16_f32 v15, v30, v31
s_nop 0
v_permlane16_swap_b32 v12, v14
v_permlane16_swap_b32 v13, v15
s_waitcnt lgkmcnt(6)
v_mfma_f32_32x32x16_bf16 v[96:111], v[228:231], a[192:195], v[96:111]
buffer_load_dwordx4 v244, s[28:31], s49 offen lds
v_mul_f32 v32, s58, v32
v_mul_f32 v33, s58, v33
v_mul_f32 v34, s58, v34
v_mul_f32 v35, s58, v35
v_mfma_f32_32x32x16_bf16 v[112:127], v[228:231], a[196:199], v[112:127]
buffer_load_dwordx4 v245, s[28:31], s49 offen offset:1024 lds
v_mul_f32 v36, s58, v36
v_mul_f32 v37, s58, v37
v_mul_f32 v38, s58, v38
v_mul_f32 v39, s58, v39
s_waitcnt vmcnt(14) lgkmcnt(3)
v_mfma_f32_32x32x16_bf16 v[64:79], v[232:235], a[200:203], v[64:79]
ds_read_b64_tr_b16 v[224:225], v246
ds_read_b64_tr_b16 v[226:227], v246 offset:512
ds_read_b128 a[192:195], v248 offset:12288
v_cvt_pk_bf16_f32 v16, v32, v33
v_cvt_pk_bf16_f32 v17, v34, v35
v_cvt_pk_bf16_f32 v18, v36, v37
v_cvt_pk_bf16_f32 v19, v38, v39
s_waitcnt lgkmcnt(5)
v_mfma_f32_32x32x16_bf16 v[80:95], v[232:235], a[204:207], v[80:95]
ds_read_b128 a[196:199], v248 offset:13312
ds_read_b64_tr_b16 v[228:229], v247
ds_read_b64_tr_b16 v[230:231], v247 offset:512
s_add_u32 m0, s48, 0x3800
s_add_u32 s49, s54, 0x34000
v_permlane16_swap_b32 v16, v18
v_permlane16_swap_b32 v17, v19
v_mul_f32 v40, s58, v40
v_mul_f32 v41, s58, v41
s_waitcnt lgkmcnt(6)
v_mfma_f32_32x32x16_bf16 v[96:111], v[236:239], a[200:203], v[96:111]
buffer_load_dwordx4 v244, s[28:31], s49 offen lds
v_mul_f32 v42, s58, v42
v_mul_f32 v43, s58, v43
v_mul_f32 v44, s58, v44
v_mul_f32 v45, s58, v45
v_mfma_f32_32x32x16_bf16 v[112:127], v[236:239], a[204:207], v[112:127]
buffer_load_dwordx4 v245, s[28:31], s49 offen offset:1024 lds
v_mul_f32 v46, s58, v46
v_mul_f32 v47, s58, v47
v_cvt_pk_bf16_f32 v20, v40, v41
v_cvt_pk_bf16_f32 v21, v42, v43
s_waitcnt vmcnt(14) lgkmcnt(3)
v_mfma_f32_32x32x16_bf16 v[64:79], v[224:227], a[192:195], v[64:79]
ds_read_b64_tr_b16 v[232:233], v246 offset:2048
ds_read_b64_tr_b16 v[234:235], v246 offset:2560
ds_read_b128 a[200:203], v248 offset:14336
v_cvt_pk_bf16_f32 v22, v44, v45
v_cvt_pk_bf16_f32 v23, v46, v47
s_nop 0
v_permlane16_swap_b32 v20, v22
v_permlane16_swap_b32 v21, v23
s_waitcnt lgkmcnt(5)
v_mfma_f32_32x32x16_bf16 v[80:95], v[224:227], a[196:199], v[80:95]
ds_read_b128 a[204:207], v248 offset:15360
ds_read_b64_tr_b16 v[236:237], v247 offset:2048
ds_read_b64_tr_b16 v[238:239], v247 offset:2560
s_add_u32 m0, s48, 0
s_add_u32 s49, s54, 0x80
v_mul_f32 v48, s58, v48
v_mul_f32 v49, s58, v49
v_mul_f32 v50, s58, v50
v_mul_f32 v51, s58, v51
s_waitcnt lgkmcnt(6)
v_mfma_f32_32x32x16_bf16 v[96:111], v[228:231], a[192:195], v[96:111]
buffer_load_dwordx4 v244, s[28:31], s49 offen lds
v_mul_f32 v52, s58, v52
v_mul_f32 v53, s58, v53
v_mul_f32 v54, s58, v54
v_mul_f32 v55, s58, v55
v_mfma_f32_32x32x16_bf16 v[112:127], v[228:231], a[196:199], v[112:127]
buffer_load_dwordx4 v245, s[28:31], s49 offen offset:1024 lds
v_cvt_pk_bf16_f32 v24, v48, v49
v_cvt_pk_bf16_f32 v25, v50, v51
v_cvt_pk_bf16_f32 v26, v52, v53
v_cvt_pk_bf16_f32 v27, v54, v55
s_waitcnt vmcnt(14) lgkmcnt(3)
v_mfma_f32_32x32x16_bf16 v[64:79], v[232:235], a[200:203], v[64:79]
ds_read_b64_tr_b16 v[224:225], v246 offset:4096
ds_read_b64_tr_b16 v[226:227], v246 offset:4608
ds_read_b128 a[192:195], v248 offset:16384
v_permlane16_swap_b32 v24, v26
v_permlane16_swap_b32 v25, v27
v_mul_f32 v56, s58, v56
v_mul_f32 v57, s58, v57
s_waitcnt lgkmcnt(5)
v_mfma_f32_32x32x16_bf16 v[80:95], v[232:235], a[204:207], v[80:95]
ds_read_b128 a[196:199], v248 offset:17408
ds_read_b64_tr_b16 v[228:229], v247 offset:4096
ds_read_b64_tr_b16 v[230:231], v247 offset:4608
s_add_u32 m0, s48, 0x800
s_add_u32 s49, s54, 0x4080
v_mul_f32 v58, s58, v58
v_mul_f32 v59, s58, v59
v_mul_f32 v60, s58, v60
v_mul_f32 v61, s58, v61
s_waitcnt lgkmcnt(6)
v_mfma_f32_32x32x16_bf16 v[96:111], v[236:239], a[200:203], v[96:111]
buffer_load_dwordx4 v244, s[28:31], s49 offen lds
v_mul_f32 v62, s58, v62
v_mul_f32 v63, s58, v63
v_cvt_pk_bf16_f32 v28, v56, v57
v_cvt_pk_bf16_f32 v29, v58, v59
v_mfma_f32_32x32x16_bf16 v[112:127], v[236:239], a[204:207], v[112:127]
buffer_load_dwordx4 v245, s[28:31], s49 offen offset:1024 lds
v_cvt_pk_bf16_f32 v30, v60, v61
v_cvt_pk_bf16_f32 v31, v62, v63
s_nop 0
v_permlane16_swap_b32 v28, v30
v_permlane16_swap_b32 v29, v31
s_waitcnt vmcnt(14) lgkmcnt(3)
v_mfma_f32_32x32x16_bf16 v[64:79], v[224:227], a[192:195], v[64:79]
ds_read_b64_tr_b16 v[232:233], v246 offset:6144
ds_read_b64_tr_b16 v[234:235], v246 offset:6656
ds_read_b128 a[200:203], v248 offset:18432
v_lshrrev_b32 v44, 4, v248
s_mul_i32 s62, s3, 0x80000
s_add_u32 s62, s62, 0x60000
s_lshl_b32 s63, s5, 11
s_add_u32 s62, s62, s63
v_lshrrev_b32 v45, 4, v44
v_and_b32 v46, 15, v44
v_xor_b32 v46, v46, v45
s_waitcnt lgkmcnt(5)
v_mfma_f32_32x32x16_bf16 v[80:95], v[224:227], a[196:199], v[80:95]
ds_read_b128 a[204:207], v248 offset:19456
ds_read_b64_tr_b16 v[236:237], v247 offset:6144
ds_read_b64_tr_b16 v[238:239], v247 offset:6656
s_add_u32 m0, s48, 0x1000
s_add_u32 s49, s54, 0x8080
v_lshlrev_b32 v46, 4, v46
v_lshlrev_b32 v47, 8, v45
v_add3_u32 v38, v46, v47, s62
v_add_u32 v39, 0x400, v38
s_waitcnt lgkmcnt(6)
v_mfma_f32_32x32x16_bf16 v[96:111], v[228:231], a[192:195], v[96:111]
buffer_load_dwordx4 v244, s[28:31], s49 offen lds
v_subrev_u32 v39, 0x440, v39
v_bfe_u32 v46, v44, 2, 2
v_xor_b32 v46, v46, v45
v_lshlrev_b32 v46, 6, v46
v_mfma_f32_32x32x16_bf16 v[112:127], v[228:231], a[196:199], v[112:127]
buffer_load_dwordx4 v245, s[28:31], s49 offen offset:1024 lds
v_add3_u32 v40, v46, v47, s62
v_and_b32 v46, 3, v44
v_lshlrev_b32 v46, 4, v46
v_add_u32 v40, v40, v46
s_waitcnt vmcnt(13) lgkmcnt(3)
v_mfma_f32_32x32x16_bf16 v[64:79], v[232:235], a[200:203], v[64:79]
ds_read_b64_tr_b16 v[224:225], v246 offset:8192
ds_read_b64_tr_b16 v[226:227], v246 offset:8704
ds_read_b128 a[192:195], v248 offset:20480
v_bfe_u32 v45, v44, 4, 1
v_lshlrev_b32 v45, 2, v45
v_bfe_u32 v46, v44, 2, 1
v_lshlrev_b32 v46, 1, v46
s_waitcnt lgkmcnt(5)
v_mfma_f32_32x32x16_bf16 v[80:95], v[232:235], a[204:207], v[80:95]
ds_read_b128 a[196:199], v248 offset:21504
ds_read_b64_tr_b16 v[228:229], v247 offset:8192
ds_read_b64_tr_b16 v[230:231], v247 offset:8704
s_add_u32 m0, s48, 0x1800
s_add_u32 s49, s54, 0xc080
v_add_u32 v45, v45, v46
v_bfe_u32 v46, v44, 3, 1
v_add_u32 v45, v45, v46
v_mul_u32_u24 v45, 0x440, v45
s_waitcnt lgkmcnt(6)
v_mfma_f32_32x32x16_bf16 v[96:111], v[236:239], a[200:203], v[96:111]
buffer_load_dwordx4 v244, s[28:31], s49 offen lds
v_and_b32 v46, 3, v44
v_lshlrev_b32 v47, 8, v46
v_add_u32 v45, v45, v47
v_lshrrev_b32 v47, 5, v44
v_mfma_f32_32x32x16_bf16 v[112:127], v[236:239], a[204:207], v[112:127]
buffer_load_dwordx4 v245, s[28:31], s49 offen offset:1024 lds
v_xor_b32 v47, v47, v46
v_lshlrev_b32 v47, 4, v47
v_add_u32 v32, v45, v47
v_add_u32 v32, 0x7000, v32
s_waitcnt vmcnt(12) lgkmcnt(3)
v_mfma_f32_32x32x16_bf16 v[64:79], v[224:227], a[192:195], v[64:79]
ds_read_b64_tr_b16 v[232:233], v246 offset:10240
ds_read_b64_tr_b16 v[234:235], v246 offset:10752
ds_read_b128 a[200:203], v248 offset:22528
v_xor_b32 v47, 32, v47
v_add_u32 v33, v45, v47
v_add_u32 v33, 0x7000, v33
v_lshrrev_b32 v45, 5, v44
s_waitcnt lgkmcnt(5)
v_mfma_f32_32x32x16_bf16 v[80:95], v[224:227], a[196:199], v[80:95]
ds_read_b128 a[204:207], v248 offset:23552
ds_read_b64_tr_b16 v[236:237], v247 offset:10240
ds_read_b64_tr_b16 v[238:239], v247 offset:10752
s_add_u32 m0, s48, 0x2000
s_add_u32 s49, s54, 0x10080
v_lshlrev_b32 v45, 3, v45
v_bfe_u32 v46, v44, 2, 2
v_add_u32 v45, v45, v46
v_lshlrev_b32 v45, 8, v45
s_waitcnt lgkmcnt(6)
v_mfma_f32_32x32x16_bf16 v[96:111], v[228:231], a[192:195], v[96:111]
buffer_load_dwordx4 v244, s[28:31], s49 offen lds
v_bfe_u32 v47, v44, 4, 1
v_lshlrev_b32 v47, 5, v47
v_add_u32 v45, v45, v47
v_and_b32 v47, 1, v44
v_mfma_f32_32x32x16_bf16 v[112:127], v[228:231], a[196:199], v[112:127]
buffer_load_dwordx4 v245, s[28:31], s49 offen offset:1024 lds
v_lshlrev_b32 v47, 4, v47
v_add_u32 v45, v45, v47
v_bfe_u32 v47, v44, 1, 1
v_lshlrev_b32 v47, 3, v47
s_waitcnt vmcnt(12) lgkmcnt(3)
v_mfma_f32_32x32x16_bf16 v[64:79], v[232:235], a[200:203], v[64:79]
ds_read_b64_tr_b16 v[224:225], v246 offset:12288
ds_read_b64_tr_b16 v[226:227], v246 offset:12800
ds_read_b128 a[192:195], v248 offset:24576
v_add_u32 v45, v45, v47
v_add_u32 v45, 0xd600, v45
v_lshlrev_b32 v46, 6, v46
v_xor_b32 v47, 0, v46
s_waitcnt lgkmcnt(5)
v_mfma_f32_32x32x16_bf16 v[80:95], v[232:235], a[204:207], v[80:95]
ds_read_b128 a[196:199], v248 offset:25600
ds_read_b64_tr_b16 v[228:229], v247 offset:12288
ds_read_b64_tr_b16 v[230:231], v247 offset:12800
s_add_u32 m0, s48, 0x2800
s_add_u32 s49, s54, 0x14080
v_add_u32 v34, v45, v47
v_xor_b32 v47, 64, v46
v_add_u32 v35, v45, v47
v_xor_b32 v47, 0x80, v46
s_waitcnt lgkmcnt(6)
v_mfma_f32_32x32x16_bf16 v[96:111], v[236:239], a[200:203], v[96:111]
buffer_load_dwordx4 v244, s[28:31], s49 offen lds
v_add_u32 v36, v45, v47
v_xor_b32 v47, 0xc0, v46
v_add_u32 v37, v45, v47
v_mov_b32 v41, 0xff800000
v_mfma_f32_32x32x16_bf16 v[112:127], v[236:239], a[204:207], v[112:127]
buffer_load_dwordx4 v245, s[28:31], s49 offen offset:1024 lds
v_mov_b32 v42, 0xff800000
s_sub_u32 s62, s96, s48
v_add_u32 v240, s62, v246
v_add_u32 v241, s62, v247
s_add_u32 s62, s5, 0
s_and_b32 s62, s62, 3
s_lshl_b32 s24, s62, 14
s_add_u32 s24, s24, 0x7000
s_lshl_b32 s62, s62, 17
s_add_u32 s20, s62, s55
s_add_u32 s62, s5, 1
s_and_b32 s62, s62, 3
s_lshl_b32 s25, s62, 14
s_add_u32 s25, s25, 0x7000
s_lshl_b32 s62, s62, 17
s_add_u32 s21, s62, s55
s_add_u32 s62, s5, 2
s_and_b32 s62, s62, 3
s_lshl_b32 s26, s62, 14
s_add_u32 s26, s26, 0x7000
s_lshl_b32 s62, s62, 17
s_add_u32 s22, s62, s55
s_add_u32 s62, s5, 3
s_and_b32 s62, s62, 3
s_lshl_b32 s27, s62, 14
s_add_u32 s27, s27, 0x7000
s_lshl_b32 s62, s62, 17
s_add_u32 s23, s62, s55
s_waitcnt vmcnt(12) lgkmcnt(3)
v_mfma_f32_32x32x16_bf16 v[64:79], v[224:227], a[192:195], v[64:79]
ds_read_b64_tr_b16 v[232:233], v246 offset:14336
ds_read_b64_tr_b16 v[234:235], v246 offset:14848
ds_read_b128 a[200:203], v248 offset:26624
s_waitcnt lgkmcnt(5)
v_mfma_f32_32x32x16_bf16 v[80:95], v[224:227], a[196:199], v[80:95]
ds_read_b128 a[204:207], v248 offset:27648
ds_read_b64_tr_b16 v[236:237], v247 offset:14336
ds_read_b64_tr_b16 v[238:239], v247 offset:14848
s_add_u32 m0, s48, 0x3000
s_add_u32 s49, s54, 0x18080
s_waitcnt lgkmcnt(6)
v_mfma_f32_32x32x16_bf16 v[96:111], v[228:231], a[192:195], v[96:111]
buffer_load_dwordx4 v244, s[28:31], s49 offen lds
v_mfma_f32_32x32x16_bf16 v[112:127], v[228:231], a[196:199], v[112:127]
buffer_load_dwordx4 v245, s[28:31], s49 offen offset:1024 lds
s_waitcnt vmcnt(12) lgkmcnt(3)
v_mfma_f32_32x32x16_bf16 v[64:79], v[232:235], a[200:203], v[64:79]
ds_read_b64_tr_b16 v[224:225], v246
ds_read_b64_tr_b16 v[226:227], v246 offset:512
s_waitcnt lgkmcnt(4)
v_mfma_f32_32x32x16_bf16 v[80:95], v[232:235], a[204:207], v[80:95]
ds_read_b64_tr_b16 v[228:229], v247
ds_read_b64_tr_b16 v[230:231], v247 offset:512
s_add_u32 m0, s48, 0x3800
s_add_u32 s49, s54, 0x1c080
s_waitcnt lgkmcnt(4)
v_mfma_f32_32x32x16_bf16 v[96:111], v[236:239], a[200:203], v[96:111]
buffer_load_dwordx4 v244, s[28:31], s49 offen lds
v_mfma_f32_32x32x16_bf16 v[112:127], v[236:239], a[204:207], v[112:127]
buffer_load_dwordx4 v245, s[28:31], s49 offen offset:1024 lds
ds_read_b128 a[192:195], v248
ds_read_b128 a[196:199], v248 offset:1024
s_barrier
s_waitcnt vmcnt(12) lgkmcnt(1)
v_mfma_f32_32x32x16_bf16 v[128:143], v[224:227], a[192:195], 0
ds_read_b64_tr_b16 v[232:233], v246 offset:2048
ds_read_b64_tr_b16 v[234:235], v246 offset:2560
ds_read_b128 a[200:203], v248 offset:2048
s_add_u32 m0, s52, 0
s_mov_b32 s50, 0
s_waitcnt lgkmcnt(3)
v_mfma_f32_32x32x16_bf16 v[144:159], v[224:227], a[196:199], 0
ds_read_b128 a[204:207], v248 offset:3072
ds_read_b64_tr_b16 v[236:237], v247 offset:2048
ds_read_b64_tr_b16 v[238:239], v247 offset:2560
buffer_load_dwordx4 v38, s[32:35], s50 offen lds
buffer_load_dwordx4 v39, s[32:35], s50 offen offset:1088 lds
s_add_u32 m0, s48, 0
s_add_u32 s49, s54, 0x20080
v_mfma_f32_32x32x16_bf16 v[160:175], v[228:231], a[192:195], 0
buffer_load_dwordx4 v244, s[28:31], s49 offen lds
v_mfma_f32_32x32x16_bf16 v[176:191], v[228:231], a[196:199], 0
buffer_load_dwordx4 v245, s[28:31], s49 offen offset:1024 lds
s_waitcnt vmcnt(14) lgkmcnt(3)
v_mfma_f32_32x32x16_bf16 v[128:143], v[232:235], a[200:203], v[128:143]
ds_read_b64_tr_b16 v[224:225], v246 offset:4096
ds_read_b64_tr_b16 v[226:227], v246 offset:4608
ds_read_b128 a[192:195], v248 offset:4096
s_add_u32 m0, s53, 0
s_mov_b32 s51, 0
v_cvt_pk_bf16_f32 v64, v64, v65
v_cvt_pk_bf16_f32 v65, v66, v67
v_cvt_pk_bf16_f32 v66, v68, v69
v_cvt_pk_bf16_f32 v67, v70, v71
s_waitcnt lgkmcnt(5)
v_mfma_f32_32x32x16_bf16 v[144:159], v[232:235], a[204:207], v[144:159]
ds_read_b128 a[196:199], v248 offset:5120
ds_read_b64_tr_b16 v[228:229], v247 offset:4096
ds_read_b64_tr_b16 v[230:231], v247 offset:4608
buffer_load_dwordx4 v40, s[36:39], s51 offen lds
buffer_load_dwordx4 v40, s[36:39], s51 offen offset:1024 lds
s_add_u32 m0, s48, 0x800
s_add_u32 s49, s54, 0x24080
v_accvgpr_write_b32 a208, v64
v_accvgpr_write_b32 a209, v65
v_accvgpr_write_b32 a210, v66
v_accvgpr_write_b32 a211, v67
s_waitcnt lgkmcnt(6)
v_mfma_f32_32x32x16_bf16 v[160:175], v[236:239], a[200:203], v[160:175]
buffer_load_dwordx4 v244, s[28:31], s49 offen lds
v_cvt_pk_bf16_f32 v72, v72, v73
v_cvt_pk_bf16_f32 v73, v74, v75
v_cvt_pk_bf16_f32 v74, v76, v77
v_cvt_pk_bf16_f32 v75, v78, v79
v_mfma_f32_32x32x16_bf16 v[176:191], v[236:239], a[204:207], v[176:191]
buffer_load_dwordx4 v245, s[28:31], s49 offen offset:1024 lds
v_accvgpr_write_b32 a216, v72
v_accvgpr_write_b32 a217, v73
v_accvgpr_write_b32 a218, v74
v_accvgpr_write_b32 a219, v75
s_waitcnt vmcnt(16) lgkmcnt(3)
v_mfma_f32_32x32x16_bf16 v[128:143], v[224:227], a[192:195], v[128:143]
ds_read_b64_tr_b16 v[232:233], v246 offset:6144
ds_read_b64_tr_b16 v[234:235], v246 offset:6656
ds_read_b128 a[200:203], v248 offset:6144
s_add_u32 m0, s52, 0x2200
s_mov_b32 s50, 0x2000
v_cvt_pk_bf16_f32 v80, v80, v81
v_cvt_pk_bf16_f32 v81, v82, v83
v_cvt_pk_bf16_f32 v82, v84, v85
v_cvt_pk_bf16_f32 v83, v86, v87
s_waitcnt lgkmcnt(5)
v_mfma_f32_32x32x16_bf16 v[144:159], v[224:227], a[196:199], v[144:159]
ds_read_b128 a[204:207], v248 offset:7168
ds_read_b64_tr_b16 v[236:237], v247 offset:6144
ds_read_b64_tr_b16 v[238:239], v247 offset:6656
buffer_load_dwordx4 v38, s[32:35], s50 offen lds
buffer_load_dwordx4 v39, s[32:35], s50 offen offset:1088 lds
s_add_u32 m0, s48, 0x1000
s_add_u32 s49, s54, 0x28080
v_accvgpr_write_b32 a212, v80
v_accvgpr_write_b32 a213, v81
v_accvgpr_write_b32 a214, v82
v_accvgpr_write_b32 a215, v83
s_waitcnt lgkmcnt(6)
v_mfma_f32_32x32x16_bf16 v[160:175], v[228:231], a[192:195], v[160:175]
buffer_load_dwordx4 v244, s[28:31], s49 offen lds
v_cvt_pk_bf16_f32 v88, v88, v89
v_cvt_pk_bf16_f32 v89, v90, v91
v_cvt_pk_bf16_f32 v90, v92, v93
v_cvt_pk_bf16_f32 v91, v94, v95
v_mfma_f32_32x32x16_bf16 v[176:191], v[228:231], a[196:199], v[176:191]
buffer_load_dwordx4 v245, s[28:31], s49 offen offset:1024 lds
v_accvgpr_write_b32 a220, v88
v_accvgpr_write_b32 a221, v89
v_accvgpr_write_b32 a222, v90
v_accvgpr_write_b32 a223, v91
s_waitcnt vmcnt(18) lgkmcnt(3)
v_mfma_f32_32x32x16_bf16 v[128:143], v[232:235], a[200:203], v[128:143]
ds_read_b64_tr_b16 v[224:225], v246 offset:8192
ds_read_b64_tr_b16 v[226:227], v246 offset:8704
ds_read_b128 a[192:195], v248 offset:8192
s_add_u32 m0, s53, 0x2000
s_mov_b32 s51, 0x2000
v_cvt_pk_bf16_f32 v96, v96, v97
v_cvt_pk_bf16_f32 v97, v98, v99
v_cvt_pk_bf16_f32 v98, v100, v101
v_cvt_pk_bf16_f32 v99, v102, v103
s_waitcnt lgkmcnt(5)
v_mfma_f32_32x32x16_bf16 v[144:159], v[232:235], a[204:207], v[144:159]
ds_read_b128 a[196:199], v248 offset:9216
ds_read_b64_tr_b16 v[228:229], v247 offset:8192
ds_read_b64_tr_b16 v[230:231], v247 offset:8704
buffer_load_dwordx4 v40, s[36:39], s51 offen lds
buffer_load_dwordx4 v40, s[36:39], s51 offen offset:1024 lds
s_add_u32 m0, s48, 0x1800
s_add_u32 s49, s54, 0x2c080
v_accvgpr_write_b32 a224, v96
v_accvgpr_write_b32 a225, v97
v_accvgpr_write_b32 a226, v98
v_accvgpr_write_b32 a227, v99
s_waitcnt lgkmcnt(6)
v_mfma_f32_32x32x16_bf16 v[160:175], v[236:239], a[200:203], v[160:175]
buffer_load_dwordx4 v244, s[28:31], s49 offen lds
v_cvt_pk_bf16_f32 v104, v104, v105
v_cvt_pk_bf16_f32 v105, v106, v107
v_cvt_pk_bf16_f32 v106, v108, v109
v_cvt_pk_bf16_f32 v107, v110, v111
v_mfma_f32_32x32x16_bf16 v[176:191], v[236:239], a[204:207], v[176:191]
buffer_load_dwordx4 v245, s[28:31], s49 offen offset:1024 lds
v_accvgpr_write_b32 a232, v104
v_accvgpr_write_b32 a233, v105
v_accvgpr_write_b32 a234, v106
v_accvgpr_write_b32 a235, v107
s_waitcnt vmcnt(20) lgkmcnt(3)
v_mfma_f32_32x32x16_bf16 v[128:143], v[224:227], a[192:195], v[128:143]
ds_read_b64_tr_b16 v[232:233], v246 offset:10240
ds_read_b64_tr_b16 v[234:235], v246 offset:10752
ds_read_b128 a[200:203], v248 offset:10240
s_add_u32 m0, s52, 0x4400
s_mov_b32 s50, 0x4000
v_cvt_pk_bf16_f32 v112, v112, v113
v_cvt_pk_bf16_f32 v113, v114, v115
v_cvt_pk_bf16_f32 v114, v116, v117
v_cvt_pk_bf16_f32 v115, v118, v119
s_waitcnt lgkmcnt(5)
v_mfma_f32_32x32x16_bf16 v[144:159], v[224:227], a[196:199], v[144:159]
ds_read_b128 a[204:207], v248 offset:11264
ds_read_b64_tr_b16 v[236:237], v247 offset:10240
ds_read_b64_tr_b16 v[238:239], v247 offset:10752
buffer_load_dwordx4 v38, s[32:35], s50 offen lds
buffer_load_dwordx4 v39, s[32:35], s50 offen offset:1088 lds
s_add_u32 m0, s48, 0x2000
s_add_u32 s49, s54, 0x30080
v_accvgpr_write_b32 a228, v112
v_accvgpr_write_b32 a229, v113
v_accvgpr_write_b32 a230, v114
v_accvgpr_write_b32 a231, v115
s_waitcnt lgkmcnt(6)
v_mfma_f32_32x32x16_bf16 v[160:175], v[228:231], a[192:195], v[160:175]
buffer_load_dwordx4 v244, s[28:31], s49 offen lds
v_cvt_pk_bf16_f32 v120, v120, v121
v_cvt_pk_bf16_f32 v121, v122, v123
v_cvt_pk_bf16_f32 v122, v124, v125
v_cvt_pk_bf16_f32 v123, v126, v127
v_mfma_f32_32x32x16_bf16 v[176:191], v[228:231], a[196:199], v[176:191]
buffer_load_dwordx4 v245, s[28:31], s49 offen offset:1024 lds
v_accvgpr_write_b32 a236, v120
v_accvgpr_write_b32 a237, v121
v_accvgpr_write_b32 a238, v122
v_accvgpr_write_b32 a239, v123
s_waitcnt vmcnt(22) lgkmcnt(3)
v_mfma_f32_32x32x16_bf16 v[128:143], v[232:235], a[200:203], v[128:143]
ds_read_b64_tr_b16 v[224:225], v246 offset:12288
ds_read_b64_tr_b16 v[226:227], v246 offset:12800
ds_read_b128 a[192:195], v248 offset:12288
s_lshl_b32 s62, s3, 1
s_lshr_b32 s63, s5, 1
s_add_u32 s62, s62, s63
s_lshr_b32 s63, s62, 2
s_lshl_b32 s63, s63, 3
s_and_b32 s62, s62, 3
s_add_u32 s6, s62, s63
s_lshl_b32 s97, s4, 19
s_lshl_b32 s62, s6, 11
s_add_u32 s97, s97, s62
s_and_b32 s63, s5, 1
s_lshl_b32 s62, s63, 10
s_add_u32 s97, s97, s62
s_lshl_b32 s62, s4, 16
s_lshl_b32 s63, s63, 15
s_add_u32 s62, s62, s63
s_lshl_b32 s63, s6, 5
s_add_u32 s62, s62, s63
v_bfe_u32 v56, v248, 4, 5
v_lshlrev_b32 v56, 10, v56
v_lshrrev_b32 v57, 9, v248
v_lshlrev_b32 v57, 4, v57
s_waitcnt lgkmcnt(5)
v_mfma_f32_32x32x16_bf16 v[144:159], v[232:235], a[204:207], v[144:159]
ds_read_b128 a[196:199], v248 offset:13312
ds_read_b64_tr_b16 v[228:229], v247 offset:12288
ds_read_b64_tr_b16 v[230:231], v247 offset:12800
s_add_u32 m0, s48, 0x2800
s_add_u32 s49, s54, 0x34080
v_add3_u32 v56, v56, v57, s62
s_lshl_b32 s62, s4, 3
v_mov_b32 v53, s62
s_lshl_b32 s62, s4, 12
s_add_u32 s62, s62, 0x3000000
v_bfe_u32 v55, v248, 4, 3
v_lshlrev_b32 v55, 7, v55
s_waitcnt lgkmcnt(6)
v_mfma_f32_32x32x16_bf16 v[160:175], v[236:239], a[200:203], v[160:175]
buffer_load_dwordx4 v244, s[28:31], s49 offen lds
v_add_u32 v55, s62, v55
s_lshl_b32 s62, s4, 12
s_lshl_b32 s63, s3, 7
s_add_u32 s62, s62, s63
s_add_u32 s62, s62, 0x3000000
v_lshrrev_b32 v58, 4, v248
s_cmp_eq_u32 s5, 0
s_cselect_b32 s7, s62, 0x7ff00000
v_mov_b32 v252, 0x7ff00000
v_cmp_eq_u32 vcc, 0, v58
v_mov_b32 v59, s7
s_nop 0
v_cndmask_b32 v252, v252, v59, vcc
v_mfma_f32_32x32x16_bf16 v[176:191], v[236:239], a[204:207], v[176:191]
buffer_load_dwordx4 v245, s[28:31], s49 offen offset:1024 lds
v_mov_b32 v60, 1
v_and_b32 v58, 7, v58
v_mov_b32 v61, 0
v_cmp_eq_u32 vcc, s3, v58
s_nop 1
v_cndmask_b32 v61, v61, v60, vcc
s_waitcnt vmcnt(22) lgkmcnt(3)
v_mfma_f32_32x32x16_bf16 v[128:143], v[224:227], a[192:195], v[128:143]
ds_read_b64_tr_b16 v[232:233], v246 offset:14336
ds_read_b64_tr_b16 v[234:235], v246 offset:14848
ds_read_b128 a[200:203], v248 offset:14336
s_waitcnt lgkmcnt(5)
v_mfma_f32_32x32x16_bf16 v[144:159], v[224:227], a[196:199], v[144:159]
ds_read_b128 a[204:207], v248 offset:15360
ds_read_b64_tr_b16 v[236:237], v247 offset:14336
ds_read_b64_tr_b16 v[238:239], v247 offset:14848
s_add_u32 m0, s48, 0x3000
s_add_u32 s49, s20, 0
s_waitcnt lgkmcnt(6)
v_mfma_f32_32x32x16_bf16 v[160:175], v[228:231], a[192:195], v[160:175]
buffer_load_dwordx4 v244, s[16:19], s49 offen lds
v_mfma_f32_32x32x16_bf16 v[176:191], v[228:231], a[196:199], v[176:191]
buffer_load_dwordx4 v245, s[16:19], s49 offen offset:1024 lds
s_waitcnt vmcnt(20) lgkmcnt(3)
v_mfma_f32_32x32x16_bf16 v[128:143], v[232:235], a[200:203], v[128:143]
ds_read_b64_tr_b16 v[224:225], v246
ds_read_b64_tr_b16 v[226:227], v246 offset:512
ds_read_b128 a[192:195], v248 offset:16384
s_waitcnt lgkmcnt(5)
v_mfma_f32_32x32x16_bf16 v[144:159], v[232:235], a[204:207], v[144:159]
ds_read_b128 a[196:199], v248 offset:17408
ds_read_b64_tr_b16 v[228:229], v247
ds_read_b64_tr_b16 v[230:231], v247 offset:512
s_add_u32 m0, s48, 0x3800
s_add_u32 s49, s20, 0x80
s_waitcnt lgkmcnt(6)
v_mfma_f32_32x32x16_bf16 v[160:175], v[236:239], a[200:203], v[160:175]
buffer_load_dwordx4 v244, s[16:19], s49 offen lds
v_mfma_f32_32x32x16_bf16 v[176:191], v[236:239], a[204:207], v[176:191]
buffer_load_dwordx4 v245, s[16:19], s49 offen offset:1024 lds
s_waitcnt vmcnt(18) lgkmcnt(3)
v_mfma_f32_32x32x16_bf16 v[128:143], v[224:227], a[192:195], v[128:143]
ds_read_b64_tr_b16 v[232:233], v246 offset:2048
ds_read_b64_tr_b16 v[234:235], v246 offset:2560
ds_read_b128 a[200:203], v248 offset:18432
s_waitcnt lgkmcnt(5)
v_mfma_f32_32x32x16_bf16 v[144:159], v[224:227], a[196:199], v[144:159]
ds_read_b128 a[204:207], v248 offset:19456
ds_read_b64_tr_b16 v[236:237], v247 offset:2048
ds_read_b64_tr_b16 v[238:239], v247 offset:2560
s_add_u32 m0, s48, 0
s_add_u32 s49, s20, 0x4000
s_waitcnt lgkmcnt(6)
v_mfma_f32_32x32x16_bf16 v[160:175], v[228:231], a[192:195], v[160:175]
buffer_load_dwordx4 v244, s[16:19], s49 offen lds
v_mfma_f32_32x32x16_bf16 v[176:191], v[228:231], a[196:199], v[176:191]
buffer_load_dwordx4 v245, s[16:19], s49 offen offset:1024 lds
s_waitcnt vmcnt(16) lgkmcnt(3)
v_mfma_f32_32x32x16_bf16 v[128:143], v[232:235], a[200:203], v[128:143]
ds_read_b64_tr_b16 v[224:225], v246 offset:4096
ds_read_b64_tr_b16 v[226:227], v246 offset:4608
ds_read_b128 a[192:195], v248 offset:20480
s_waitcnt lgkmcnt(5)
v_mfma_f32_32x32x16_bf16 v[144:159], v[232:235], a[204:207], v[144:159]
ds_read_b128 a[196:199], v248 offset:21504
ds_read_b64_tr_b16 v[228:229], v247 offset:4096
ds_read_b64_tr_b16 v[230:231], v247 offset:4608
s_add_u32 m0, s48, 0x800
s_add_u32 s49, s20, 0x4080
s_waitcnt lgkmcnt(6)
v_mfma_f32_32x32x16_bf16 v[160:175], v[236:239], a[200:203], v[160:175]
buffer_load_dwordx4 v244, s[16:19], s49 offen lds
s_barrier
v_mfma_f32_32x32x16_bf16 v[176:191], v[236:239], a[204:207], v[176:191]
buffer_load_dwordx4 v245, s[16:19], s49 offen offset:1024 lds
s_waitcnt vmcnt(14) lgkmcnt(3)
v_mfma_f32_32x32x16_bf16 v[128:143], v[224:227], a[192:195], v[128:143]
ds_read_b64_tr_b16 v[232:233], v246 offset:6144
ds_read_b64_tr_b16 v[234:235], v246 offset:6656
ds_read_b128 a[200:203], v248 offset:22528
s_waitcnt lgkmcnt(5)
v_mfma_f32_32x32x16_bf16 v[144:159], v[224:227], a[196:199], v[144:159]
ds_read_b128 a[204:207], v248 offset:23552
ds_read_b64_tr_b16 v[236:237], v247 offset:6144
ds_read_b64_tr_b16 v[238:239], v247 offset:6656
s_add_u32 m0, s48, 0x1000
s_add_u32 s49, s20, 0x8000
s_waitcnt lgkmcnt(6)
v_mfma_f32_32x32x16_bf16 v[160:175], v[228:231], a[192:195], v[160:175]
buffer_load_dwordx4 v244, s[16:19], s49 offen lds
ds_read_b128 a[128:131], v32
ds_read_b128 a[132:135], v33
v_mfma_f32_32x32x16_bf16 v[176:191], v[228:231], a[196:199], v[176:191]
buffer_load_dwordx4 v245, s[16:19], s49 offen offset:1024 lds
s_waitcnt vmcnt(12) lgkmcnt(5)
v_mfma_f32_32x32x16_bf16 v[128:143], v[232:235], a[200:203], v[128:143]
ds_read_b64_tr_b16 v[224:225], v246 offset:8192
ds_read_b64_tr_b16 v[226:227], v246 offset:8704
ds_read_b128 a[192:195], v248 offset:24576
s_waitcnt lgkmcnt(7)
v_mfma_f32_32x32x16_bf16 v[144:159], v[232:235], a[204:207], v[144:159]
ds_read_b128 a[196:199], v248 offset:25600
ds_read_b64_tr_b16 v[228:229], v247 offset:8192
ds_read_b64_tr_b16 v[230:231], v247 offset:8704
s_add_u32 m0, s48, 0x1800
s_add_u32 s49, s20, 0x8080
s_waitcnt lgkmcnt(8)
v_mfma_f32_32x32x16_bf16 v[160:175], v[236:239], a[200:203], v[160:175]
buffer_load_dwordx4 v244, s[16:19], s49 offen lds
ds_read_b128 a[136:139], v32 offset:64
ds_read_b128 a[140:143], v33 offset:64
v_mfma_f32_32x32x16_bf16 v[176:191], v[236:239], a[204:207], v[176:191]
buffer_load_dwordx4 v245, s[16:19], s49 offen offset:1024 lds
s_waitcnt vmcnt(12) lgkmcnt(5)
v_mfma_f32_32x32x16_bf16 v[128:143], v[224:227], a[192:195], v[128:143]
ds_read_b64_tr_b16 v[232:233], v246 offset:10240
ds_read_b64_tr_b16 v[234:235], v246 offset:10752
ds_read_b128 a[200:203], v248 offset:26624
s_waitcnt lgkmcnt(7)
v_mfma_f32_32x32x16_bf16 v[144:159], v[224:227], a[196:199], v[144:159]
ds_read_b128 a[204:207], v248 offset:27648
ds_read_b64_tr_b16 v[236:237], v247 offset:10240
ds_read_b64_tr_b16 v[238:239], v247 offset:10752
s_add_u32 m0, s48, 0x2000
s_add_u32 s49, s20, 0xc000
s_waitcnt lgkmcnt(8)
v_mfma_f32_32x32x16_bf16 v[160:175], v[228:231], a[192:195], v[160:175]
buffer_load_dwordx4 v244, s[16:19], s49 offen lds
ds_read_b128 a[144:147], v32 offset:128
ds_read_b128 a[148:151], v33 offset:128
v_mfma_f32_32x32x16_bf16 v[176:191], v[228:231], a[196:199], v[176:191]
buffer_load_dwordx4 v245, s[16:19], s49 offen offset:1024 lds
s_waitcnt lgkmcnt(5)
v_mfma_f32_32x32x16_bf16 v[128:143], v[232:235], a[200:203], v[128:143]
s_waitcnt lgkmcnt(4)
v_mfma_f32_32x32x16_bf16 v[144:159], v[232:235], a[204:207], v[144:159]
s_add_u32 m0, s48, 0x2800
s_add_u32 s49, s20, 0xc080
s_waitcnt lgkmcnt(2)
v_mfma_f32_32x32x16_bf16 v[160:175], v[236:239], a[200:203], v[160:175]
buffer_load_dwordx4 v244, s[16:19], s49 offen lds
ds_read_b128 a[152:155], v32 offset:192
ds_read_b128 a[156:159], v33 offset:192
v_mfma_f32_32x32x16_bf16 v[176:191], v[236:239], a[204:207], v[176:191]
buffer_load_dwordx4 v245, s[16:19], s49 offen offset:1024 lds
v_mfma_f32_32x32x16_bf16 v[64:79], a[128:131], v[192:195], 0
v_mfma_f32_32x32x16_bf16 v[80:95], a[128:131], v[196:199], 0
v_mfma_f32_32x32x16_bf16 v[64:79], a[132:135], v[200:203], v[64:79]
v_mfma_f32_32x32x16_bf16 v[80:95], a[132:135], v[204:207], v[80:95]
v_cvt_pk_bf16_f32 v128, v128, v129
v_cvt_pk_bf16_f32 v129, v130, v131
v_cvt_pk_bf16_f32 v130, v132, v133
v_cvt_pk_bf16_f32 v131, v134, v135
v_accvgpr_write_b32 a240, v128
v_mfma_f32_32x32x16_bf16 v[64:79], a[136:139], v[208:211], v[64:79]
v_accvgpr_write_b32 a241, v129
v_accvgpr_write_b32 a242, v130
v_accvgpr_write_b32 a243, v131
v_cvt_pk_bf16_f32 v136, v136, v137
v_cvt_pk_bf16_f32 v137, v138, v139
v_mfma_f32_32x32x16_bf16 v[80:95], a[136:139], v[212:215], v[80:95]
v_cvt_pk_bf16_f32 v138, v140, v141
v_cvt_pk_bf16_f32 v139, v142, v143
v_accvgpr_write_b32 a248, v136
v_accvgpr_write_b32 a249, v137
v_accvgpr_write_b32 a250, v138
v_mfma_f32_32x32x16_bf16 v[64:79], a[140:143], v[216:219], v[64:79]
v_accvgpr_write_b32 a251, v139
v_cvt_pk_bf16_f32 v144, v144, v145
v_cvt_pk_bf16_f32 v145, v146, v147
v_cvt_pk_bf16_f32 v146, v148, v149
v_cvt_pk_bf16_f32 v147, v150, v151
v_mfma_f32_32x32x16_bf16 v[80:95], a[140:143], v[220:223], v[80:95]
v_accvgpr_write_b32 a244, v144
v_accvgpr_write_b32 a245, v145
v_accvgpr_write_b32 a246, v146
v_accvgpr_write_b32 a247, v147
v_cvt_pk_bf16_f32 v152, v152, v153
s_waitcnt lgkmcnt(3)
v_mfma_f32_32x32x16_bf16 v[64:79], a[144:147], v[0:3], v[64:79]
v_cvt_pk_bf16_f32 v153, v154, v155
v_cvt_pk_bf16_f32 v154, v156, v157
v_cvt_pk_bf16_f32 v155, v158, v159
v_accvgpr_write_b32 a252, v152
v_accvgpr_write_b32 a253, v153
v_mfma_f32_32x32x16_bf16 v[80:95], a[144:147], v[4:7], v[80:95]
v_accvgpr_write_b32 a254, v154
v_accvgpr_write_b32 a255, v155
v_cvt_pk_bf16_f32 v160, v160, v161
v_cvt_pk_bf16_f32 v161, v162, v163
v_cvt_pk_bf16_f32 v162, v164, v165
s_waitcnt lgkmcnt(2)
v_mfma_f32_32x32x16_bf16 v[64:79], a[148:151], v[8:11], v[64:79]
v_cvt_pk_bf16_f32 v163, v166, v167
v_accvgpr_write_b32 a192, v160
v_accvgpr_write_b32 a193, v161
v_accvgpr_write_b32 a194, v162
v_accvgpr_write_b32 a195, v163
v_mfma_f32_32x32x16_bf16 v[80:95], a[148:151], v[12:15], v[80:95]
v_cvt_pk_bf16_f32 v168, v168, v169
v_cvt_pk_bf16_f32 v169, v170, v171
v_cvt_pk_bf16_f32 v170, v172, v173
v_cvt_pk_bf16_f32 v171, v174, v175
v_accvgpr_write_b32 a200, v168
s_waitcnt lgkmcnt(1)
v_mfma_f32_32x32x16_bf16 v[64:79], a[152:155], v[16:19], v[64:79]
v_accvgpr_write_b32 a201, v169
v_accvgpr_write_b32 a202, v170
v_accvgpr_write_b32 a203, v171
v_cvt_pk_bf16_f32 v176, v176, v177
v_cvt_pk_bf16_f32 v177, v178, v179
v_mfma_f32_32x32x16_bf16 v[80:95], a[152:155], v[20:23], v[80:95]
v_cvt_pk_bf16_f32 v178, v180, v181
v_cvt_pk_bf16_f32 v179, v182, v183
v_accvgpr_write_b32 a196, v176
v_accvgpr_write_b32 a197, v177
v_accvgpr_write_b32 a198, v178
s_waitcnt lgkmcnt(0)
v_mfma_f32_32x32x16_bf16 v[64:79], a[156:159], v[24:27], v[64:79]
v_accvgpr_write_b32 a199, v179
v_cvt_pk_bf16_f32 v184, v184, v185
v_cvt_pk_bf16_f32 v185, v186, v187
v_cvt_pk_bf16_f32 v186, v188, v189
v_cvt_pk_bf16_f32 v187, v190, v191
v_mfma_f32_32x32x16_bf16 v[80:95], a[156:159], v[28:31], v[80:95]
v_accvgpr_write_b32 a204, v184
v_accvgpr_write_b32 a205, v185
v_accvgpr_write_b32 a206, v186
v_accvgpr_write_b32 a207, v187
s_branch L_att_go
L_att:
v_mfma_f32_32x32x16_bf16 v[64:79], a[128:131], v[192:195], 0
s_nop 2
v_mfma_f32_32x32x16_bf16 v[80:95], a[128:131], v[196:199], 0
v_mfma_f32_32x32x16_bf16 v[64:79], a[132:135], v[200:203], v[64:79]
v_mfma_f32_32x32x16_bf16 v[80:95], a[132:135], v[204:207], v[80:95]
v_mfma_f32_32x32x16_bf16 v[64:79], a[136:139], v[208:211], v[64:79]
v_mfma_f32_32x32x16_bf16 v[80:95], a[136:139], v[212:215], v[80:95]
v_mfma_f32_32x32x16_bf16 v[64:79], a[140:143], v[216:219], v[64:79]
v_mfma_f32_32x32x16_bf16 v[80:95], a[140:143], v[220:223], v[80:95]
v_mfma_f32_32x32x16_bf16 v[64:79], a[144:147], v[0:3], v[64:79]
v_mfma_f32_32x32x16_bf16 v[80:95], a[144:147], v[4:7], v[80:95]
v_mfma_f32_32x32x16_bf16 v[64:79], a[148:151], v[8:11], v[64:79]
v_mfma_f32_32x32x16_bf16 v[80:95], a[148:151], v[12:15], v[80:95]
v_mfma_f32_32x32x16_bf16 v[64:79], a[152:155], v[16:19], v[64:79]
v_mfma_f32_32x32x16_bf16 v[80:95], a[152:155], v[20:23], v[80:95]
v_mfma_f32_32x32x16_bf16 v[64:79], a[156:159], v[24:27], v[64:79]
v_mfma_f32_32x32x16_bf16 v[80:95], a[156:159], v[28:31], v[80:95]
L_att_go:
s_nop 7
s_nop 1
v_max3_f32 v180, v64, v65, v66
v_max3_f32 v180, v180, v67, v68
v_max3_f32 v180, v180, v69, v70
v_max3_f32 v180, v180, v71, v72
v_max3_f32 v180, v180, v73, v74
v_max3_f32 v180, v180, v75, v76
v_max3_f32 v180, v180, v77, v78
v_max_f32 v180, v180, v79
v_max3_f32 v181, v80, v81, v82
v_max3_f32 v181, v181, v83, v84
v_max3_f32 v181, v181, v85, v86
v_max3_f32 v181, v181, v87, v88
v_max3_f32 v181, v181, v89, v90
v_max3_f32 v181, v181, v91, v92
v_max3_f32 v181, v181, v93, v94
v_max_f32 v181, v181, v95
v_mov_b32 v182, v180
v_mov_b32 v183, v181
s_nop 0
v_permlane32_swap_b32 v180, v182
v_permlane32_swap_b32 v181, v183
v_max3_f32 v180, v180, v182, v41
v_max3_f32 v181, v181, v183, v42
v_sub_f32 v144, 0, v180
v_sub_f32 v160, 0, v181
v_mov_b32 v145, v144
v_mov_b32 v161, v160
v_mov_b32 v146, v144
v_mov_b32 v162, v160
v_mov_b32 v147, v144
v_mov_b32 v163, v160
v_mov_b32 v148, v144
v_mov_b32 v164, v160
v_mov_b32 v149, v144
v_mov_b32 v165, v160
v_mov_b32 v150, v144
v_mov_b32 v166, v160
v_mov_b32 v151, v144
v_mov_b32 v167, v160
v_mov_b32 v152, v144
v_mov_b32 v168, v160
v_mov_b32 v153, v144
v_mov_b32 v169, v160
v_mov_b32 v154, v144
v_mov_b32 v170, v160
v_mov_b32 v155, v144
v_mov_b32 v171, v160
v_mov_b32 v156, v144
v_mov_b32 v172, v160
v_mov_b32 v157, v144
v_mov_b32 v173, v160
v_mov_b32 v158, v144
v_mov_b32 v174, v160
v_mov_b32 v159, v144
v_mov_b32 v175, v160
s_barrier
ds_read_b128 a[128:131], v32 offset:8704
ds_read_b128 a[132:135], v33 offset:8704
ds_read_b128 a[136:139], v32 offset:8768
ds_read_b128 a[140:143], v33 offset:8768
ds_read_b128 a[144:147], v32 offset:8832
ds_read_b128 a[148:151], v33 offset:8832
ds_read_b128 a[152:155], v32 offset:8896
ds_read_b128 a[156:159], v33 offset:8896
v_add_f32 v64, v64, v145
v_add_f32 v65, v65, v146
v_add_f32 v66, v66, v147
v_add_f32 v67, v67, v144
v_add_f32 v68, v68, v145
v_add_f32 v69, v69, v146
v_add_f32 v70, v70, v147
v_add_f32 v71, v71, v144
s_add_u32 s7, s56, 0
buffer_store_dwordx4 a[208:211], v248, s[40:43], s7 offen sc1
s_add_u32 s7, s56, 0
buffer_store_dwordx4 a[212:215], v248, s[40:43], s7 offen offset:1024 sc1
s_add_u32 m0, s52, 0
s_mov_b32 s50, 0x6000
buffer_load_dwordx4 v38, s[32:35], s50 offen lds
buffer_load_dwordx4 v39, s[32:35], s50 offen offset:1088 lds
s_add_u32 m0, s53, 0x4000
s_mov_b32 s51, 0x4000
buffer_load_dwordx4 v40, s[36:39], s51 offen lds
buffer_load_dwordx4 v40, s[36:39], s51 offen offset:1024 lds
s_waitcnt lgkmcnt(7)
v_mfma_f32_32x32x16_bf16 v[96:111], a[128:131], v[192:195], v[144:159]
ds_read_b64_tr_b16 a[160:161], v34
v_add_f32 v80, v80, v161
v_add_f32 v81, v81, v162
v_add_f32 v82, v82, v163
v_exp_f32 v64, v64
v_exp_f32 v65, v65
v_mov_b32 v177, v64
v_mfma_f32_32x32x16_bf16 v[112:127], a[128:131], v[196:199], v[160:175]
ds_read_b64_tr_b16 a[162:163], v34 offset:1024
v_add_f32 v83, v83, v160
v_add_f32 v84, v84, v161
v_add_f32 v85, v85, v162
v_exp_f32 v66, v66
v_mov_b32 v176, v65
v_exp_f32 v67, v67
v_add_f32 v177, v177, v66
s_waitcnt lgkmcnt(8)
v_mfma_f32_32x32x16_bf16 v[96:111], a[132:135], v[200:203], v[96:111]
ds_read_b64_tr_b16 a[164:165], v35
v_add_f32 v86, v86, v163
v_add_f32 v87, v87, v160
v_add_f32 v72, v72, v145
v_exp_f32 v68, v68
v_add_f32 v176, v176, v67
v_cvt_pk_bf16_f32 v128, v64, v65
v_exp_f32 v69, v69
v_add_f32 v177, v177, v68
v_mfma_f32_32x32x16_bf16 v[112:127], a[132:135], v[204:207], v[112:127]
ds_read_b64_tr_b16 a[166:167], v35 offset:1024
v_add_f32 v73, v73, v146
v_add_f32 v74, v74, v147
v_add_f32 v75, v75, v144
v_exp_f32 v70, v70
v_add_f32 v176, v176, v69
v_cvt_pk_bf16_f32 v129, v66, v67
v_exp_f32 v71, v71
v_add_f32 v177, v177, v70
s_waitcnt lgkmcnt(9)
v_mfma_f32_32x32x16_bf16 v[96:111], a[136:139], v[208:211], v[96:111]
ds_read_b64_tr_b16 a[168:169], v36
v_add_f32 v76, v76, v145
v_add_f32 v77, v77, v146
v_add_f32 v78, v78, v147
v_exp_f32 v80, v80
v_add_f32 v176, v176, v71
v_cvt_pk_bf16_f32 v130, v68, v69
v_exp_f32 v81, v81
v_mov_b32 v179, v80
v_mfma_f32_32x32x16_bf16 v[112:127], a[136:139], v[212:215], v[112:127]
ds_read_b64_tr_b16 a[170:171], v36 offset:1024
v_add_f32 v79, v79, v144
v_add_f32 v88, v88, v161
v_add_f32 v89, v89, v162
v_exp_f32 v82, v82
v_mov_b32 v178, v81
v_cvt_pk_bf16_f32 v131, v70, v71
v_exp_f32 v83, v83
v_add_f32 v179, v179, v82
s_waitcnt lgkmcnt(10)
v_mfma_f32_32x32x16_bf16 v[96:111], a[140:143], v[216:219], v[96:111]
ds_read_b64_tr_b16 a[172:173], v37
v_add_f32 v90, v90, v163
v_add_f32 v91, v91, v160
v_add_f32 v92, v92, v161
v_exp_f32 v84, v84
v_add_f32 v178, v178, v83
v_cvt_pk_bf16_f32 v132, v80, v81
v_exp_f32 v85, v85
v_add_f32 v179, v179, v84
v_mfma_f32_32x32x16_bf16 v[112:127], a[140:143], v[220:223], v[112:127]
ds_read_b64_tr_b16 a[174:175], v37 offset:1024
v_add_f32 v93, v93, v162
v_add_f32 v94, v94, v163
v_add_f32 v95, v95, v160
v_exp_f32 v86, v86
v_add_f32 v178, v178, v85
v_cvt_pk_bf16_f32 v133, v82, v83
v_exp_f32 v87, v87
v_add_f32 v179, v179, v86
s_waitcnt lgkmcnt(11)
v_mfma_f32_32x32x16_bf16 v[96:111], a[144:147], v[0:3], v[96:111]
ds_read_b64_tr_b16 a[176:177], v34 offset:4096
v_exp_f32 v72, v72
v_add_f32 v178, v178, v87
v_cvt_pk_bf16_f32 v134, v84, v85
v_exp_f32 v73, v73
v_add_f32 v177, v177, v72
v_mfma_f32_32x32x16_bf16 v[112:127], a[144:147], v[4:7], v[112:127]
ds_read_b64_tr_b16 a[178:179], v34 offset:5120
v_exp_f32 v74, v74
v_add_f32 v176, v176, v73
v_cvt_pk_bf16_f32 v135, v86, v87
v_exp_f32 v75, v75
v_add_f32 v177, v177, v74
s_waitcnt lgkmcnt(12)
v_mfma_f32_32x32x16_bf16 v[96:111], a[148:151], v[8:11], v[96:111]
ds_read_b64_tr_b16 a[180:181], v35 offset:4096
v_exp_f32 v76, v76
v_add_f32 v176, v176, v75
v_cvt_pk_bf16_f32 v136, v72, v73
v_exp_f32 v77, v77
v_add_f32 v177, v177, v76
v_mfma_f32_32x32x16_bf16 v[112:127], a[148:151], v[12:15], v[112:127]
ds_read_b64_tr_b16 a[182:183], v35 offset:5120
v_exp_f32 v78, v78
v_add_f32 v176, v176, v77
v_cvt_pk_bf16_f32 v137, v74, v75
v_exp_f32 v79, v79
v_add_f32 v177, v177, v78
s_waitcnt lgkmcnt(13)
v_mfma_f32_32x32x16_bf16 v[96:111], a[152:155], v[16:19], v[96:111]
ds_read_b64_tr_b16 a[184:185], v36 offset:4096
v_exp_f32 v88, v88
v_add_f32 v176, v176, v79
v_cvt_pk_bf16_f32 v138, v76, v77
v_exp_f32 v89, v89
v_add_f32 v179, v179, v88
v_mfma_f32_32x32x16_bf16 v[112:127], a[152:155], v[20:23], v[112:127]
ds_read_b64_tr_b16 a[186:187], v36 offset:5120
v_exp_f32 v90, v90
v_add_f32 v178, v178, v89
v_cvt_pk_bf16_f32 v139, v78, v79
v_exp_f32 v91, v91
v_add_f32 v179, v179, v90
s_waitcnt lgkmcnt(14)
v_mfma_f32_32x32x16_bf16 v[96:111], a[156:159], v[24:27], v[96:111]
ds_read_b64_tr_b16 a[188:189], v37 offset:4096
v_exp_f32 v92, v92
v_add_f32 v178, v178, v91
v_cvt_pk_bf16_f32 v140, v88, v89
v_exp_f32 v93, v93
v_add_f32 v179, v179, v92
v_mfma_f32_32x32x16_bf16 v[112:127], a[156:159], v[28:31], v[112:127]
ds_read_b64_tr_b16 a[190:191], v37 offset:5120
v_exp_f32 v94, v94
v_add_f32 v178, v178, v93
v_cvt_pk_bf16_f32 v141, v90, v91
v_exp_f32 v95, v95
v_add_f32 v179, v179, v94
v_add_f32 v178, v178, v95
v_cvt_pk_bf16_f32 v142, v92, v93
v_cvt_pk_bf16_f32 v143, v94, v95
s_waitcnt lgkmcnt(14)
v_mfma_f32_32x32x16_bf16 a[0:15], a[160:163], v[128:131], 0
s_barrier
v_exp_f32 v96, v96
s_waitcnt lgkmcnt(12)
v_mfma_f32_32x32x16_bf16 a[32:47], a[164:167], v[128:131], 0
ds_read_b128 a[128:131], v32 offset:17408
v_exp_f32 v97, v97
v_add_f32 v177, v177, v96
s_waitcnt lgkmcnt(11)
v_mfma_f32_32x32x16_bf16 a[64:79], a[168:171], v[128:131], 0
ds_read_b128 a[132:135], v33 offset:17408
v_exp_f32 v98, v98
v_add_f32 v176, v176, v97
s_waitcnt lgkmcnt(10)
v_mfma_f32_32x32x16_bf16 a[96:111], a[172:175], v[128:131], 0
ds_read_b128 a[136:139], v32 offset:17472
v_exp_f32 v99, v99
v_add_f32 v177, v177, v98
v_mfma_f32_32x32x16_bf16 a[16:31], a[160:163], v[132:135], 0
ds_read_b128 a[140:143], v33 offset:17472
v_exp_f32 v100, v100
v_add_f32 v176, v176, v99
v_cvt_pk_bf16_f32 v128, v96, v97
v_mfma_f32_32x32x16_bf16 a[48:63], a[164:167], v[132:135], 0
ds_read_b128 a[144:147], v32 offset:17536
v_exp_f32 v101, v101
v_add_f32 v177, v177, v100
v_mfma_f32_32x32x16_bf16 a[80:95], a[168:171], v[132:135], 0
ds_read_b128 a[148:151], v33 offset:17536
v_exp_f32 v102, v102
v_add_f32 v176, v176, v101
v_cvt_pk_bf16_f32 v129, v98, v99
v_mfma_f32_32x32x16_bf16 a[112:127], a[172:175], v[132:135], 0
ds_read_b128 a[152:155], v32 offset:17600
v_exp_f32 v103, v103
v_add_f32 v177, v177, v102
s_waitcnt lgkmcnt(13)
v_mfma_f32_32x32x16_bf16 a[0:15], a[176:179], v[136:139], a[0:15]
ds_read_b128 a[156:159], v33 offset:17600
v_exp_f32 v112, v112
v_add_f32 v176, v176, v103
v_cvt_pk_bf16_f32 v130, v100, v101
s_waitcnt lgkmcnt(12)
v_mfma_f32_32x32x16_bf16 a[32:47], a[180:183], v[136:139], a[32:47]
v_exp_f32 v113, v113
v_add_f32 v179, v179, v112
s_add_u32 m0, s52, 0x2200
s_mov_b32 s50, 0x8000
s_waitcnt lgkmcnt(10)
v_mfma_f32_32x32x16_bf16 a[64:79], a[184:187], v[136:139], a[64:79]
buffer_load_dwordx4 v38, s[32:35], s50 offen lds
v_exp_f32 v114, v114
v_add_f32 v178, v178, v113
v_cvt_pk_bf16_f32 v131, v102, v103
s_waitcnt lgkmcnt(8)
v_mfma_f32_32x32x16_bf16 a[96:111], a[188:191], v[136:139], a[96:111]
buffer_load_dwordx4 v39, s[32:35], s50 offen offset:1088 lds
v_exp_f32 v115, v115
v_add_f32 v179, v179, v114
v_mfma_f32_32x32x16_bf16 a[16:31], a[176:179], v[140:143], a[16:31]
v_exp_f32 v116, v116
v_add_f32 v178, v178, v115
v_cvt_pk_bf16_f32 v132, v112, v113
v_mfma_f32_32x32x16_bf16 a[48:63], a[180:183], v[140:143], a[48:63]
v_exp_f32 v117, v117
v_add_f32 v179, v179, v116
s_add_u32 m0, s53, 0x6000
s_mov_b32 s51, 0x6000
v_mfma_f32_32x32x16_bf16 a[80:95], a[184:187], v[140:143], a[80:95]
buffer_load_dwordx4 v40, s[36:39], s51 offen lds
v_exp_f32 v118, v118
v_add_f32 v178, v178, v117
v_cvt_pk_bf16_f32 v133, v114, v115
v_mfma_f32_32x32x16_bf16 a[112:127], a[188:191], v[140:143], a[112:127]
buffer_load_dwordx4 v40, s[36:39], s51 offen offset:1024 lds
v_exp_f32 v119, v119
v_add_f32 v179, v179, v118
s_waitcnt lgkmcnt(7)
v_mfma_f32_32x32x16_bf16 v[64:79], a[128:131], v[192:195], v[144:159]
ds_read_b64_tr_b16 a[160:161], v34 offset:8192
v_exp_f32 v104, v104
v_add_f32 v178, v178, v119
v_cvt_pk_bf16_f32 v134, v116, v117
v_mfma_f32_32x32x16_bf16 v[80:95], a[128:131], v[196:199], v[160:175]
ds_read_b64_tr_b16 a[162:163], v34 offset:9216
v_exp_f32 v105, v105
v_add_f32 v177, v177, v104
s_add_u32 s7, s56, 0
s_waitcnt lgkmcnt(8)
v_mfma_f32_32x32x16_bf16 v[64:79], a[132:135], v[200:203], v[64:79]
ds_read_b64_tr_b16 a[164:165], v35 offset:8192
buffer_store_dwordx4 a[216:219], v248, s[40:43], s7 offen offset:2048 sc1
v_exp_f32 v106, v106
v_add_f32 v176, v176, v105
v_cvt_pk_bf16_f32 v135, v118, v119
v_mfma_f32_32x32x16_bf16 v[80:95], a[132:135], v[204:207], v[80:95]
ds_read_b64_tr_b16 a[166:167], v35 offset:9216
v_exp_f32 v107, v107
v_add_f32 v177, v177, v106
s_waitcnt lgkmcnt(9)
v_mfma_f32_32x32x16_bf16 v[64:79], a[136:139], v[208:211], v[64:79]
ds_read_b64_tr_b16 a[168:169], v36 offset:8192
v_exp_f32 v108, v108
v_add_f32 v176, v176, v107
v_cvt_pk_bf16_f32 v136, v104, v105
v_mfma_f32_32x32x16_bf16 v[80:95], a[136:139], v[212:215], v[80:95]
ds_read_b64_tr_b16 a[170:171], v36 offset:9216
v_exp_f32 v109, v109
v_add_f32 v177, v177, v108
s_add_u32 s7, s56, 0
s_waitcnt lgkmcnt(10)
v_mfma_f32_32x32x16_bf16 v[64:79], a[140:143], v[216:219], v[64:79]
ds_read_b64_tr_b16 a[172:173], v37 offset:8192
buffer_store_dwordx4 a[220:223], v248, s[40:43], s7 offen offset:3072 sc1
v_exp_f32 v110, v110
v_add_f32 v176, v176, v109
v_cvt_pk_bf16_f32 v137, v106, v107
v_mfma_f32_32x32x16_bf16 v[80:95], a[140:143], v[220:223], v[80:95]
ds_read_b64_tr_b16 a[174:175], v37 offset:9216
v_exp_f32 v111, v111
v_add_f32 v177, v177, v110
s_waitcnt lgkmcnt(11)
v_mfma_f32_32x32x16_bf16 v[64:79], a[144:147], v[0:3], v[64:79]
ds_read_b64_tr_b16 a[176:177], v34 offset:12288
v_exp_f32 v120, v120
v_add_f32 v176, v176, v111
v_cvt_pk_bf16_f32 v138, v108, v109
s_lshl_b32 s6, s101, 14
s_add_u32 s6, s6, s55
s_add_u32 s6, s6, 0x80
v_mfma_f32_32x32x16_bf16 v[80:95], a[144:147], v[4:7], v[80:95]
ds_read_b64_tr_b16 a[178:179], v34 offset:13312
v_exp_f32 v121, v121
v_add_f32 v179, v179, v120
s_waitcnt lgkmcnt(12)
v_mfma_f32_32x32x16_bf16 v[64:79], a[148:151], v[8:11], v[64:79]
ds_read_b64_tr_b16 a[180:181], v35 offset:12288
buffer_load_dword v48, v244, s[16:19], s6 offen
v_exp_f32 v122, v122
v_add_f32 v178, v178, v121
v_cvt_pk_bf16_f32 v139, v110, v111
v_mfma_f32_32x32x16_bf16 v[80:95], a[148:151], v[12:15], v[80:95]
ds_read_b64_tr_b16 a[182:183], v35 offset:13312
buffer_load_dword v49, v245, s[16:19], s6 offen offset:1024
v_exp_f32 v123, v123
v_add_f32 v179, v179, v122
s_waitcnt lgkmcnt(13)
v_mfma_f32_32x32x16_bf16 v[64:79], a[152:155], v[16:19], v[64:79]
ds_read_b64_tr_b16 a[184:185], v36 offset:12288
v_exp_f32 v124, v124
v_add_f32 v178, v178, v123
v_cvt_pk_bf16_f32 v140, v120, v121
v_mfma_f32_32x32x16_bf16 v[80:95], a[152:155], v[20:23], v[80:95]
ds_read_b64_tr_b16 a[186:187], v36 offset:13312
v_exp_f32 v125, v125
v_add_f32 v179, v179, v124
s_waitcnt lgkmcnt(14)
v_mfma_f32_32x32x16_bf16 v[64:79], a[156:159], v[24:27], v[64:79]
ds_read_b64_tr_b16 a[188:189], v37 offset:12288
v_exp_f32 v126, v126
v_add_f32 v178, v178, v125
v_cvt_pk_bf16_f32 v141, v122, v123
v_mfma_f32_32x32x16_bf16 v[80:95], a[156:159], v[28:31], v[80:95]
ds_read_b64_tr_b16 a[190:191], v37 offset:13312
v_exp_f32 v127, v127
v_add_f32 v179, v179, v126
v_add_f32 v178, v178, v127
v_cvt_pk_bf16_f32 v142, v124, v125
v_cvt_pk_bf16_f32 v143, v126, v127
s_waitcnt lgkmcnt(14)
v_mfma_f32_32x32x16_bf16 a[0:15], a[160:163], v[128:131], a[0:15]
s_waitcnt vmcnt(8)
s_barrier
v_exp_f32 v64, v64
s_waitcnt lgkmcnt(12)
v_mfma_f32_32x32x16_bf16 a[32:47], a[164:167], v[128:131], a[32:47]
ds_read_b128 a[128:131], v32
v_exp_f32 v65, v65
v_add_f32 v177, v177, v64
s_waitcnt lgkmcnt(11)
v_mfma_f32_32x32x16_bf16 a[64:79], a[168:171], v[128:131], a[64:79]
ds_read_b128 a[132:135], v33
v_exp_f32 v66, v66
v_add_f32 v176, v176, v65
s_waitcnt lgkmcnt(10)
v_mfma_f32_32x32x16_bf16 a[96:111], a[172:175], v[128:131], a[96:111]
ds_read_b128 a[136:139], v32 offset:64
v_exp_f32 v67, v67
v_add_f32 v177, v177, v66
v_mfma_f32_32x32x16_bf16 a[16:31], a[160:163], v[132:135], a[16:31]
ds_read_b128 a[140:143], v33 offset:64
v_exp_f32 v68, v68
v_add_f32 v176, v176, v67
v_cvt_pk_bf16_f32 v128, v64, v65
v_mfma_f32_32x32x16_bf16 a[48:63], a[164:167], v[132:135], a[48:63]
ds_read_b128 a[144:147], v32 offset:128
v_exp_f32 v69, v69
v_add_f32 v177, v177, v68
v_mfma_f32_32x32x16_bf16 a[80:95], a[168:171], v[132:135], a[80:95]
ds_read_b128 a[148:151], v33 offset:128
v_exp_f32 v70, v70
v_add_f32 v176, v176, v69
v_cvt_pk_bf16_f32 v129, v66, v67
v_mfma_f32_32x32x16_bf16 a[112:127], a[172:175], v[132:135], a[112:127]
ds_read_b128 a[152:155], v32 offset:192
v_exp_f32 v71, v71
v_add_f32 v177, v177, v70
s_waitcnt lgkmcnt(13)
v_mfma_f32_32x32x16_bf16 a[0:15], a[176:179], v[136:139], a[0:15]
ds_read_b128 a[156:159], v33 offset:192
v_exp_f32 v80, v80
v_add_f32 v176, v176, v71
v_cvt_pk_bf16_f32 v130, v68, v69
s_waitcnt lgkmcnt(12)
v_mfma_f32_32x32x16_bf16 a[32:47], a[180:183], v[136:139], a[32:47]
v_exp_f32 v81, v81
v_add_f32 v179, v179, v80
s_add_u32 m0, s52, 0x4400
s_mov_b32 s50, 0xa000
s_waitcnt lgkmcnt(10)
v_mfma_f32_32x32x16_bf16 a[64:79], a[184:187], v[136:139], a[64:79]
buffer_load_dwordx4 v38, s[32:35], s50 offen lds
v_exp_f32 v82, v82
v_add_f32 v178, v178, v81
v_cvt_pk_bf16_f32 v131, v70, v71
s_waitcnt lgkmcnt(8)
v_mfma_f32_32x32x16_bf16 a[96:111], a[188:191], v[136:139], a[96:111]
buffer_load_dwordx4 v39, s[32:35], s50 offen offset:1088 lds
v_exp_f32 v83, v83
v_add_f32 v179, v179, v82
v_mfma_f32_32x32x16_bf16 a[16:31], a[176:179], v[140:143], a[16:31]
v_exp_f32 v84, v84
v_add_f32 v178, v178, v83
v_cvt_pk_bf16_f32 v132, v80, v81
v_mfma_f32_32x32x16_bf16 a[48:63], a[180:183], v[140:143], a[48:63]
v_exp_f32 v85, v85
v_add_f32 v179, v179, v84
s_add_u32 m0, s53, 0
s_mov_b32 s51, 0x8000
v_mfma_f32_32x32x16_bf16 a[80:95], a[184:187], v[140:143], a[80:95]
buffer_load_dwordx4 v40, s[36:39], s51 offen lds
v_exp_f32 v86, v86
v_add_f32 v178, v178, v85
v_cvt_pk_bf16_f32 v133, v82, v83
v_mfma_f32_32x32x16_bf16 a[112:127], a[188:191], v[140:143], a[112:127]
buffer_load_dwordx4 v40, s[36:39], s51 offen offset:1024 lds
v_exp_f32 v87, v87
v_add_f32 v179, v179, v86
s_waitcnt lgkmcnt(7)
v_mfma_f32_32x32x16_bf16 v[96:111], a[128:131], v[192:195], v[144:159]
ds_read_b64_tr_b16 a[160:161], v34 offset:16384
v_exp_f32 v72, v72
v_add_f32 v178, v178, v87
v_cvt_pk_bf16_f32 v134, v84, v85
v_mfma_f32_32x32x16_bf16 v[112:127], a[128:131], v[196:199], v[160:175]
ds_read_b64_tr_b16 a[162:163], v34 offset:17408
v_exp_f32 v73, v73
v_add_f32 v177, v177, v72
s_add_u32 s7, s56, 0x1000
s_add_u32 m0, s96, 0x1000
s_add_u32 s49, s20, 0x10000
s_waitcnt lgkmcnt(8)
v_mfma_f32_32x32x16_bf16 v[96:111], a[132:135], v[200:203], v[96:111]
ds_read_b64_tr_b16 a[164:165], v35 offset:16384
buffer_store_dwordx4 a[224:227], v248, s[40:43], s7 offen sc1
buffer_load_dwordx4 v244, s[16:19], s49 offen lds
v_exp_f32 v74, v74
v_add_f32 v176, v176, v73
v_cvt_pk_bf16_f32 v135, v86, v87
v_mfma_f32_32x32x16_bf16 v[112:127], a[132:135], v[204:207], v[112:127]
ds_read_b64_tr_b16 a[166:167], v35 offset:17408
buffer_load_dwordx4 v245, s[16:19], s49 offen offset:1024 lds
v_exp_f32 v75, v75
v_add_f32 v177, v177, v74
s_waitcnt lgkmcnt(9)
v_mfma_f32_32x32x16_bf16 v[96:111], a[136:139], v[208:211], v[96:111]
ds_read_b64_tr_b16 a[168:169], v36 offset:16384
v_exp_f32 v76, v76
v_add_f32 v176, v176, v75
v_cvt_pk_bf16_f32 v136, v72, v73
s_add_u32 m0, s96, 0
s_add_u32 s49, s20, 0x10080
v_mfma_f32_32x32x16_bf16 v[112:127], a[136:139], v[212:215], v[112:127]
ds_read_b64_tr_b16 a[170:171], v36 offset:17408
buffer_load_dwordx4 v244, s[16:19], s49 offen lds
v_exp_f32 v77, v77
v_add_f32 v177, v177, v76
s_add_u32 s7, s56, 0x1000
s_waitcnt lgkmcnt(10)
v_mfma_f32_32x32x16_bf16 v[96:111], a[140:143], v[216:219], v[96:111]
ds_read_b64_tr_b16 a[172:173], v37 offset:16384
buffer_store_dwordx4 a[228:231], v248, s[40:43], s7 offen offset:1024 sc1
buffer_load_dwordx4 v245, s[16:19], s49 offen offset:1024 lds
v_exp_f32 v78, v78
v_add_f32 v176, v176, v77
v_cvt_pk_bf16_f32 v137, v74, v75
v_mfma_f32_32x32x16_bf16 v[112:127], a[140:143], v[220:223], v[112:127]
ds_read_b64_tr_b16 a[174:175], v37 offset:17408
v_exp_f32 v79, v79
v_add_f32 v177, v177, v78
s_add_u32 m0, s96, 0x800
s_add_u32 s49, s20, 0x14000
s_waitcnt lgkmcnt(11)
v_mfma_f32_32x32x16_bf16 v[96:111], a[144:147], v[0:3], v[96:111]
ds_read_b64_tr_b16 a[176:177], v34 offset:20480
buffer_load_dwordx4 v244, s[16:19], s49 offen lds
v_exp_f32 v88, v88
v_add_f32 v176, v176, v79
v_cvt_pk_bf16_f32 v138, v76, v77
v_mfma_f32_32x32x16_bf16 v[112:127], a[144:147], v[4:7], v[112:127]
ds_read_b64_tr_b16 a[178:179], v34 offset:21504
buffer_load_dwordx4 v245, s[16:19], s49 offen offset:1024 lds
v_exp_f32 v89, v89
v_add_f32 v179, v179, v88
s_waitcnt lgkmcnt(12)
v_mfma_f32_32x32x16_bf16 v[96:111], a[148:151], v[8:11], v[96:111]
ds_read_b64_tr_b16 a[180:181], v35 offset:20480
v_exp_f32 v90, v90
v_add_f32 v178, v178, v89
v_cvt_pk_bf16_f32 v139, v78, v79
v_mfma_f32_32x32x16_bf16 v[112:127], a[148:151], v[12:15], v[112:127]
ds_read_b64_tr_b16 a[182:183], v35 offset:21504
v_exp_f32 v91, v91
v_add_f32 v179, v179, v90
s_waitcnt lgkmcnt(13)
v_mfma_f32_32x32x16_bf16 v[96:111], a[152:155], v[16:19], v[96:111]
ds_read_b64_tr_b16 a[184:185], v36 offset:20480
v_exp_f32 v92, v92
v_add_f32 v178, v178, v91
v_cvt_pk_bf16_f32 v140, v88, v89
v_mfma_f32_32x32x16_bf16 v[112:127], a[152:155], v[20:23], v[112:127]
ds_read_b64_tr_b16 a[186:187], v36 offset:21504
v_exp_f32 v93, v93
v_add_f32 v179, v179, v92
s_waitcnt lgkmcnt(14)
v_mfma_f32_32x32x16_bf16 v[96:111], a[156:159], v[24:27], v[96:111]
ds_read_b64_tr_b16 a[188:189], v37 offset:20480
v_exp_f32 v94, v94
v_add_f32 v178, v178, v93
v_cvt_pk_bf16_f32 v141, v90, v91
v_mfma_f32_32x32x16_bf16 v[112:127], a[156:159], v[28:31], v[112:127]
ds_read_b64_tr_b16 a[190:191], v37 offset:21504
v_exp_f32 v95, v95
v_add_f32 v179, v179, v94
v_add_f32 v178, v178, v95
v_cvt_pk_bf16_f32 v142, v92, v93
v_cvt_pk_bf16_f32 v143, v94, v95
s_waitcnt lgkmcnt(14)
v_mfma_f32_32x32x16_bf16 a[0:15], a[160:163], v[128:131], a[0:15]
s_waitcnt vmcnt(16)
s_barrier
v_exp_f32 v96, v96
s_waitcnt lgkmcnt(12)
v_mfma_f32_32x32x16_bf16 a[32:47], a[164:167], v[128:131], a[32:47]
ds_read_b128 a[128:131], v32 offset:8704
v_exp_f32 v97, v97
v_add_f32 v177, v177, v96
s_waitcnt lgkmcnt(11)
v_mfma_f32_32x32x16_bf16 a[64:79], a[168:171], v[128:131], a[64:79]
ds_read_b128 a[132:135], v33 offset:8704
v_exp_f32 v98, v98
v_add_f32 v176, v176, v97
s_waitcnt lgkmcnt(10)
v_mfma_f32_32x32x16_bf16 a[96:111], a[172:175], v[128:131], a[96:111]
ds_read_b128 a[136:139], v32 offset:8768
v_exp_f32 v99, v99
v_add_f32 v177, v177, v98
v_mfma_f32_32x32x16_bf16 a[16:31], a[160:163], v[132:135], a[16:31]
ds_read_b128 a[140:143], v33 offset:8768
v_exp_f32 v100, v100
v_add_f32 v176, v176, v99
v_cvt_pk_bf16_f32 v128, v96, v97
v_mfma_f32_32x32x16_bf16 a[48:63], a[164:167], v[132:135], a[48:63]
ds_read_b128 a[144:147], v32 offset:8832
v_exp_f32 v101, v101
v_add_f32 v177, v177, v100
v_mfma_f32_32x32x16_bf16 a[80:95], a[168:171], v[132:135], a[80:95]
ds_read_b128 a[148:151], v33 offset:8832
v_exp_f32 v102, v102
v_add_f32 v176, v176, v101
v_cvt_pk_bf16_f32 v129, v98, v99
v_mfma_f32_32x32x16_bf16 a[112:127], a[172:175], v[132:135], a[112:127]
ds_read_b128 a[152:155], v32 offset:8896
v_exp_f32 v103, v103
v_add_f32 v177, v177, v102
s_waitcnt lgkmcnt(13)
v_mfma_f32_32x32x16_bf16 a[0:15], a[176:179], v[136:139], a[0:15]
ds_read_b128 a[156:159], v33 offset:8896
v_exp_f32 v112, v112
v_add_f32 v176, v176, v103
v_cvt_pk_bf16_f32 v130, v100, v101
s_waitcnt lgkmcnt(12)
v_mfma_f32_32x32x16_bf16 a[32:47], a[180:183], v[136:139], a[32:47]
v_exp_f32 v113, v113
v_add_f32 v179, v179, v112
s_add_u32 m0, s52, 0
s_mov_b32 s50, 0xc000
s_waitcnt lgkmcnt(10)
v_mfma_f32_32x32x16_bf16 a[64:79], a[184:187], v[136:139], a[64:79]
buffer_load_dwordx4 v38, s[32:35], s50 offen lds
v_exp_f32 v114, v114
v_add_f32 v178, v178, v113
v_cvt_pk_bf16_f32 v131, v102, v103
s_waitcnt lgkmcnt(8)
v_mfma_f32_32x32x16_bf16 a[96:111], a[188:191], v[136:139], a[96:111]
buffer_load_dwordx4 v39, s[32:35], s50 offen offset:1088 lds
v_exp_f32 v115, v115
v_add_f32 v179, v179, v114
v_mfma_f32_32x32x16_bf16 a[16:31], a[176:179], v[140:143], a[16:31]
v_exp_f32 v116, v116
v_add_f32 v178, v178, v115
v_cvt_pk_bf16_f32 v132, v112, v113
v_mfma_f32_32x32x16_bf16 a[48:63], a[180:183], v[140:143], a[48:63]
v_exp_f32 v117, v117
v_add_f32 v179, v179, v116
s_add_u32 m0, s53, 0x2000
s_mov_b32 s51, 0xa000
v_mfma_f32_32x32x16_bf16 a[80:95], a[184:187], v[140:143], a[80:95]
buffer_load_dwordx4 v40, s[36:39], s51 offen lds
v_exp_f32 v118, v118
v_add_f32 v178, v178, v117
v_cvt_pk_bf16_f32 v133, v114, v115
v_mfma_f32_32x32x16_bf16 a[112:127], a[188:191], v[140:143], a[112:127]
buffer_load_dwordx4 v40, s[36:39], s51 offen offset:1024 lds
v_exp_f32 v119, v119
v_add_f32 v179, v179, v118
s_waitcnt lgkmcnt(7)
v_mfma_f32_32x32x16_bf16 v[64:79], a[128:131], v[192:195], v[144:159]
ds_read_b64_tr_b16 a[160:161], v34 offset:24576
v_exp_f32 v104, v104
v_add_f32 v178, v178, v119
v_cvt_pk_bf16_f32 v134, v116, v117
v_mfma_f32_32x32x16_bf16 v[80:95], a[128:131], v[196:199], v[160:175]
ds_read_b64_tr_b16 a[162:163], v34 offset:25600
v_exp_f32 v105, v105
v_add_f32 v177, v177, v104
s_add_u32 s7, s56, 0x1000
s_waitcnt lgkmcnt(8)
v_mfma_f32_32x32x16_bf16 v[64:79], a[132:135], v[200:203], v[64:79]
ds_read_b64_tr_b16 a[164:165], v35 offset:24576
buffer_store_dwordx4 a[232:235], v248, s[40:43], s7 offen offset:2048 sc1
v_exp_f32 v106, v106
v_add_f32 v176, v176, v105
v_cvt_pk_bf16_f32 v135, v118, v119
v_mfma_f32_32x32x16_bf16 v[80:95], a[132:135], v[204:207], v[80:95]
ds_read_b64_tr_b16 a[166:167], v35 offset:25600
v_exp_f32 v107, v107
v_add_f32 v177, v177, v106
s_waitcnt lgkmcnt(9)
v_mfma_f32_32x32x16_bf16 v[64:79], a[136:139], v[208:211], v[64:79]
ds_read_b64_tr_b16 a[168:169], v36 offset:24576
v_exp_f32 v108, v108
v_add_f32 v176, v176, v107
v_cvt_pk_bf16_f32 v136, v104, v105
v_mfma_f32_32x32x16_bf16 v[80:95], a[136:139], v[212:215], v[80:95]
ds_read_b64_tr_b16 a[170:171], v36 offset:25600
v_exp_f32 v109, v109
v_add_f32 v177, v177, v108
s_add_u32 s7, s56, 0x1000
s_waitcnt lgkmcnt(10)
v_mfma_f32_32x32x16_bf16 v[64:79], a[140:143], v[216:219], v[64:79]
ds_read_b64_tr_b16 a[172:173], v37 offset:24576
buffer_store_dwordx4 a[236:239], v248, s[40:43], s7 offen offset:3072 sc1
v_exp_f32 v110, v110
v_add_f32 v176, v176, v109
v_cvt_pk_bf16_f32 v137, v106, v107
v_mfma_f32_32x32x16_bf16 v[80:95], a[140:143], v[220:223], v[80:95]
ds_read_b64_tr_b16 a[174:175], v37 offset:25600
v_exp_f32 v111, v111
v_add_f32 v177, v177, v110
s_waitcnt lgkmcnt(11)
v_mfma_f32_32x32x16_bf16 v[64:79], a[144:147], v[0:3], v[64:79]
ds_read_b64_tr_b16 a[176:177], v34 offset:28672
v_exp_f32 v120, v120
v_add_f32 v176, v176, v111
v_cvt_pk_bf16_f32 v138, v108, v109
v_mfma_f32_32x32x16_bf16 v[80:95], a[144:147], v[4:7], v[80:95]
ds_read_b64_tr_b16 a[178:179], v34 offset:29696
v_exp_f32 v121, v121
v_add_f32 v179, v179, v120
s_waitcnt lgkmcnt(12)
v_mfma_f32_32x32x16_bf16 v[64:79], a[148:151], v[8:11], v[64:79]
ds_read_b64_tr_b16 a[180:181], v35 offset:28672
v_exp_f32 v122, v122
v_add_f32 v178, v178, v121
v_cvt_pk_bf16_f32 v139, v110, v111
v_mfma_f32_32x32x16_bf16 v[80:95], a[148:151], v[12:15], v[80:95]
ds_read_b64_tr_b16 a[182:183], v35 offset:29696
v_exp_f32 v123, v123
v_add_f32 v179, v179, v122
s_waitcnt lgkmcnt(13)
v_mfma_f32_32x32x16_bf16 v[64:79], a[152:155], v[16:19], v[64:79]
ds_read_b64_tr_b16 a[184:185], v36 offset:28672
v_exp_f32 v124, v124
v_add_f32 v178, v178, v123
v_cvt_pk_bf16_f32 v140, v120, v121
v_mfma_f32_32x32x16_bf16 v[80:95], a[152:155], v[20:23], v[80:95]
ds_read_b64_tr_b16 a[186:187], v36 offset:29696
v_exp_f32 v125, v125
v_add_f32 v179, v179, v124
s_waitcnt lgkmcnt(14)
v_mfma_f32_32x32x16_bf16 v[64:79], a[156:159], v[24:27], v[64:79]
ds_read_b64_tr_b16 a[188:189], v37 offset:28672
v_exp_f32 v126, v126
v_add_f32 v178, v178, v125
v_cvt_pk_bf16_f32 v141, v122, v123
v_mfma_f32_32x32x16_bf16 v[80:95], a[156:159], v[28:31], v[80:95]
ds_read_b64_tr_b16 a[190:191], v37 offset:29696
v_exp_f32 v127, v127
v_add_f32 v179, v179, v126
v_add_f32 v178, v178, v127
v_cvt_pk_bf16_f32 v142, v124, v125
v_cvt_pk_bf16_f32 v143, v126, v127
s_waitcnt lgkmcnt(14)
v_mfma_f32_32x32x16_bf16 a[0:15], a[160:163], v[128:131], a[0:15]
s_waitcnt vmcnt(14)
s_barrier
v_exp_f32 v64, v64
s_waitcnt lgkmcnt(12)
v_mfma_f32_32x32x16_bf16 a[32:47], a[164:167], v[128:131], a[32:47]
ds_read_b128 a[128:131], v32 offset:17408
v_exp_f32 v65, v65
v_add_f32 v177, v177, v64
s_waitcnt lgkmcnt(11)
v_mfma_f32_32x32x16_bf16 a[64:79], a[168:171], v[128:131], a[64:79]
ds_read_b128 a[132:135], v33 offset:17408
v_exp_f32 v66, v66
v_add_f32 v176, v176, v65
s_waitcnt lgkmcnt(10)
v_mfma_f32_32x32x16_bf16 a[96:111], a[172:175], v[128:131], a[96:111]
ds_read_b128 a[136:139], v32 offset:17472
v_exp_f32 v67, v67
v_add_f32 v177, v177, v66
v_mfma_f32_32x32x16_bf16 a[16:31], a[160:163], v[132:135], a[16:31]
ds_read_b128 a[140:143], v33 offset:17472
v_exp_f32 v68, v68
v_add_f32 v176, v176, v67
v_cvt_pk_bf16_f32 v128, v64, v65
v_mfma_f32_32x32x16_bf16 a[48:63], a[164:167], v[132:135], a[48:63]
ds_read_b128 a[144:147], v32 offset:17536
v_exp_f32 v69, v69
v_add_f32 v177, v177, v68
v_mfma_f32_32x32x16_bf16 a[80:95], a[168:171], v[132:135], a[80:95]
ds_read_b128 a[148:151], v33 offset:17536
v_exp_f32 v70, v70
v_add_f32 v176, v176, v69
v_cvt_pk_bf16_f32 v129, v66, v67
v_mfma_f32_32x32x16_bf16 a[112:127], a[172:175], v[132:135], a[112:127]
ds_read_b128 a[152:155], v32 offset:17600
v_exp_f32 v71, v71
v_add_f32 v177, v177, v70
s_waitcnt lgkmcnt(13)
v_mfma_f32_32x32x16_bf16 a[0:15], a[176:179], v[136:139], a[0:15]
ds_read_b128 a[156:159], v33 offset:17600
v_exp_f32 v80, v80
v_add_f32 v176, v176, v71
v_cvt_pk_bf16_f32 v130, v68, v69
s_waitcnt lgkmcnt(12)
v_mfma_f32_32x32x16_bf16 a[32:47], a[180:183], v[136:139], a[32:47]
v_exp_f32 v81, v81
v_add_f32 v179, v179, v80
s_add_u32 m0, s52, 0x2200
s_mov_b32 s50, 0xe000
s_waitcnt lgkmcnt(10)
v_mfma_f32_32x32x16_bf16 a[64:79], a[184:187], v[136:139], a[64:79]
buffer_load_dwordx4 v38, s[32:35], s50 offen lds
v_exp_f32 v82, v82
v_add_f32 v178, v178, v81
v_cvt_pk_bf16_f32 v131, v70, v71
s_waitcnt lgkmcnt(8)
v_mfma_f32_32x32x16_bf16 a[96:111], a[188:191], v[136:139], a[96:111]
buffer_load_dwordx4 v39, s[32:35], s50 offen offset:1088 lds
v_exp_f32 v83, v83
v_add_f32 v179, v179, v82
v_mfma_f32_32x32x16_bf16 a[16:31], a[176:179], v[140:143], a[16:31]
v_exp_f32 v84, v84
v_add_f32 v178, v178, v83
v_cvt_pk_bf16_f32 v132, v80, v81
v_mfma_f32_32x32x16_bf16 a[48:63], a[180:183], v[140:143], a[48:63]
v_exp_f32 v85, v85
v_add_f32 v179, v179, v84
s_add_u32 m0, s53, 0x4000
s_mov_b32 s51, 0xc000
v_mfma_f32_32x32x16_bf16 a[80:95], a[184:187], v[140:143], a[80:95]
buffer_load_dwordx4 v40, s[36:39], s51 offen lds
v_exp_f32 v86, v86
v_add_f32 v178, v178, v85
v_cvt_pk_bf16_f32 v133, v82, v83
v_mfma_f32_32x32x16_bf16 a[112:127], a[188:191], v[140:143], a[112:127]
buffer_load_dwordx4 v40, s[36:39], s51 offen offset:1024 lds
v_exp_f32 v87, v87
v_add_f32 v179, v179, v86
s_waitcnt lgkmcnt(7)
v_mfma_f32_32x32x16_bf16 v[96:111], a[128:131], v[192:195], v[144:159]
ds_read_b64_tr_b16 a[160:161], v34
v_exp_f32 v72, v72
v_add_f32 v178, v178, v87
v_cvt_pk_bf16_f32 v134, v84, v85
v_mfma_f32_32x32x16_bf16 v[112:127], a[128:131], v[196:199], v[160:175]
ds_read_b64_tr_b16 a[162:163], v34 offset:1024
v_exp_f32 v73, v73
v_add_f32 v177, v177, v72
s_add_u32 s7, s56, 0x2000
s_waitcnt lgkmcnt(8)
v_mfma_f32_32x32x16_bf16 v[96:111], a[132:135], v[200:203], v[96:111]
ds_read_b64_tr_b16 a[164:165], v35
buffer_store_dwordx4 a[240:243], v248, s[40:43], s7 offen sc1
v_exp_f32 v74, v74
v_add_f32 v176, v176, v73
v_cvt_pk_bf16_f32 v135, v86, v87
v_mfma_f32_32x32x16_bf16 v[112:127], a[132:135], v[204:207], v[112:127]
ds_read_b64_tr_b16 a[166:167], v35 offset:1024
v_exp_f32 v75, v75
v_add_f32 v177, v177, v74
s_waitcnt lgkmcnt(9)
v_mfma_f32_32x32x16_bf16 v[96:111], a[136:139], v[208:211], v[96:111]
ds_read_b64_tr_b16 a[168:169], v36
v_exp_f32 v76, v76
v_add_f32 v176, v176, v75
v_cvt_pk_bf16_f32 v136, v72, v73
v_mfma_f32_32x32x16_bf16 v[112:127], a[136:139], v[212:215], v[112:127]
ds_read_b64_tr_b16 a[170:171], v36 offset:1024
v_exp_f32 v77, v77
v_add_f32 v177, v177, v76
s_add_u32 s7, s56, 0x2000
s_waitcnt lgkmcnt(10)
v_mfma_f32_32x32x16_bf16 v[96:111], a[140:143], v[216:219], v[96:111]
ds_read_b64_tr_b16 a[172:173], v37
buffer_store_dwordx4 a[244:247], v248, s[40:43], s7 offen offset:1024 sc1
v_exp_f32 v78, v78
v_add_f32 v176, v176, v77
v_cvt_pk_bf16_f32 v137, v74, v75
v_mfma_f32_32x32x16_bf16 v[112:127], a[140:143], v[220:223], v[112:127]
ds_read_b64_tr_b16 a[174:175], v37 offset:1024
v_exp_f32 v79, v79
v_add_f32 v177, v177, v78
s_waitcnt lgkmcnt(11)
v_mfma_f32_32x32x16_bf16 v[96:111], a[144:147], v[0:3], v[96:111]
ds_read_b64_tr_b16 a[176:177], v34 offset:4096
v_exp_f32 v88, v88
v_add_f32 v176, v176, v79
v_cvt_pk_bf16_f32 v138, v76, v77
v_mfma_f32_32x32x16_bf16 v[112:127], a[144:147], v[4:7], v[112:127]
ds_read_b64_tr_b16 a[178:179], v34 offset:5120
v_exp_f32 v89, v89
v_add_f32 v179, v179, v88
s_waitcnt lgkmcnt(12)
v_mfma_f32_32x32x16_bf16 v[96:111], a[148:151], v[8:11], v[96:111]
ds_read_b64_tr_b16 a[180:181], v35 offset:4096
v_exp_f32 v90, v90
v_add_f32 v178, v178, v89
v_cvt_pk_bf16_f32 v139, v78, v79
v_mfma_f32_32x32x16_bf16 v[112:127], a[148:151], v[12:15], v[112:127]
ds_read_b64_tr_b16 a[182:183], v35 offset:5120
v_exp_f32 v91, v91
v_add_f32 v179, v179, v90
s_waitcnt lgkmcnt(13)
v_mfma_f32_32x32x16_bf16 v[96:111], a[152:155], v[16:19], v[96:111]
ds_read_b64_tr_b16 a[184:185], v36 offset:4096
v_exp_f32 v92, v92
v_add_f32 v178, v178, v91
v_cvt_pk_bf16_f32 v140, v88, v89
v_mfma_f32_32x32x16_bf16 v[112:127], a[152:155], v[20:23], v[112:127]
ds_read_b64_tr_b16 a[186:187], v36 offset:5120
v_exp_f32 v93, v93
v_add_f32 v179, v179, v92
s_waitcnt lgkmcnt(14)
v_mfma_f32_32x32x16_bf16 v[96:111], a[156:159], v[24:27], v[96:111]
ds_read_b64_tr_b16 a[188:189], v37 offset:4096
v_exp_f32 v94, v94
v_add_f32 v178, v178, v93
v_cvt_pk_bf16_f32 v141, v90, v91
v_mfma_f32_32x32x16_bf16 v[112:127], a[156:159], v[28:31], v[112:127]
ds_read_b64_tr_b16 a[190:191], v37 offset:5120
v_exp_f32 v95, v95
v_add_f32 v179, v179, v94
v_add_f32 v178, v178, v95
v_cvt_pk_bf16_f32 v142, v92, v93
v_cvt_pk_bf16_f32 v143, v94, v95
s_waitcnt lgkmcnt(14)
v_mfma_f32_32x32x16_bf16 a[0:15], a[160:163], v[128:131], a[0:15]
s_waitcnt vmcnt(8)
s_barrier
v_exp_f32 v96, v96
s_waitcnt lgkmcnt(12)
v_mfma_f32_32x32x16_bf16 a[32:47], a[164:167], v[128:131], a[32:47]
ds_read_b128 a[128:131], v32
v_exp_f32 v97, v97
v_add_f32 v177, v177, v96
s_waitcnt lgkmcnt(11)
v_mfma_f32_32x32x16_bf16 a[64:79], a[168:171], v[128:131], a[64:79]
ds_read_b128 a[132:135], v33
v_exp_f32 v98, v98
v_add_f32 v176, v176, v97
s_waitcnt lgkmcnt(10)
v_mfma_f32_32x32x16_bf16 a[96:111], a[172:175], v[128:131], a[96:111]
ds_read_b128 a[136:139], v32 offset:64
v_exp_f32 v99, v99
v_add_f32 v177, v177, v98
v_mfma_f32_32x32x16_bf16 a[16:31], a[160:163], v[132:135], a[16:31]
ds_read_b128 a[140:143], v33 offset:64
v_exp_f32 v100, v100
v_add_f32 v176, v176, v99
v_cvt_pk_bf16_f32 v128, v96, v97
v_mfma_f32_32x32x16_bf16 a[48:63], a[164:167], v[132:135], a[48:63]
ds_read_b128 a[144:147], v32 offset:128
v_exp_f32 v101, v101
v_add_f32 v177, v177, v100
v_mfma_f32_32x32x16_bf16 a[80:95], a[168:171], v[132:135], a[80:95]
ds_read_b128 a[148:151], v33 offset:128
v_exp_f32 v102, v102
v_add_f32 v176, v176, v101
v_cvt_pk_bf16_f32 v129, v98, v99
v_mfma_f32_32x32x16_bf16 a[112:127], a[172:175], v[132:135], a[112:127]
ds_read_b128 a[152:155], v32 offset:192
v_exp_f32 v103, v103
v_add_f32 v177, v177, v102
s_waitcnt lgkmcnt(13)
v_mfma_f32_32x32x16_bf16 a[0:15], a[176:179], v[136:139], a[0:15]
ds_read_b128 a[156:159], v33 offset:192
v_exp_f32 v112, v112
v_add_f32 v176, v176, v103
v_cvt_pk_bf16_f32 v130, v100, v101
s_waitcnt lgkmcnt(12)
v_mfma_f32_32x32x16_bf16 a[32:47], a[180:183], v[136:139], a[32:47]
v_exp_f32 v113, v113
v_add_f32 v179, v179, v112
s_add_u32 m0, s52, 0x4400
s_mov_b32 s50, 0x10000
s_waitcnt lgkmcnt(10)
v_mfma_f32_32x32x16_bf16 a[64:79], a[184:187], v[136:139], a[64:79]
buffer_load_dwordx4 v38, s[32:35], s50 offen lds
v_exp_f32 v114, v114
v_add_f32 v178, v178, v113
v_cvt_pk_bf16_f32 v131, v102, v103
s_waitcnt lgkmcnt(8)
v_mfma_f32_32x32x16_bf16 a[96:111], a[188:191], v[136:139], a[96:111]
buffer_load_dwordx4 v39, s[32:35], s50 offen offset:1088 lds
v_exp_f32 v115, v115
v_add_f32 v179, v179, v114
v_mfma_f32_32x32x16_bf16 a[16:31], a[176:179], v[140:143], a[16:31]
v_exp_f32 v116, v116
v_add_f32 v178, v178, v115
v_cvt_pk_bf16_f32 v132, v112, v113
v_mfma_f32_32x32x16_bf16 a[48:63], a[180:183], v[140:143], a[48:63]
v_exp_f32 v117, v117
v_add_f32 v179, v179, v116
s_add_u32 m0, s53, 0x6000
s_mov_b32 s51, 0xe000
v_mfma_f32_32x32x16_bf16 a[80:95], a[184:187], v[140:143], a[80:95]
buffer_load_dwordx4 v40, s[36:39], s51 offen lds
v_exp_f32 v118, v118
v_add_f32 v178, v178, v117
v_cvt_pk_bf16_f32 v133, v114, v115
v_mfma_f32_32x32x16_bf16 a[112:127], a[188:191], v[140:143], a[112:127]
buffer_load_dwordx4 v40, s[36:39], s51 offen offset:1024 lds
v_exp_f32 v119, v119
v_add_f32 v179, v179, v118
s_waitcnt lgkmcnt(7)
v_mfma_f32_32x32x16_bf16 v[64:79], a[128:131], v[192:195], v[144:159]
ds_read_b64_tr_b16 a[160:161], v34 offset:8192
v_exp_f32 v104, v104
v_add_f32 v178, v178, v119
v_cvt_pk_bf16_f32 v134, v116, v117
v_mfma_f32_32x32x16_bf16 v[80:95], a[128:131], v[196:199], v[160:175]
ds_read_b64_tr_b16 a[162:163], v34 offset:9216
v_exp_f32 v105, v105
v_add_f32 v177, v177, v104
s_add_u32 s7, s56, 0x2000
s_waitcnt lgkmcnt(8)
v_mfma_f32_32x32x16_bf16 v[64:79], a[132:135], v[200:203], v[64:79]
ds_read_b64_tr_b16 a[164:165], v35 offset:8192
buffer_store_dwordx4 a[248:251], v248, s[40:43], s7 offen offset:2048 sc1
v_exp_f32 v106, v106
v_add_f32 v176, v176, v105
v_cvt_pk_bf16_f32 v135, v118, v119
v_mfma_f32_32x32x16_bf16 v[80:95], a[132:135], v[204:207], v[80:95]
ds_read_b64_tr_b16 a[166:167], v35 offset:9216
v_exp_f32 v107, v107
v_add_f32 v177, v177, v106
s_waitcnt lgkmcnt(9)
v_mfma_f32_32x32x16_bf16 v[64:79], a[136:139], v[208:211], v[64:79]
ds_read_b64_tr_b16 a[168:169], v36 offset:8192
v_exp_f32 v108, v108
v_add_f32 v176, v176, v107
v_cvt_pk_bf16_f32 v136, v104, v105
v_mfma_f32_32x32x16_bf16 v[80:95], a[136:139], v[212:215], v[80:95]
ds_read_b64_tr_b16 a[170:171], v36 offset:9216
v_exp_f32 v109, v109
v_add_f32 v177, v177, v108
s_add_u32 s7, s56, 0x2000
s_waitcnt lgkmcnt(10)
v_mfma_f32_32x32x16_bf16 v[64:79], a[140:143], v[216:219], v[64:79]
ds_read_b64_tr_b16 a[172:173], v37 offset:8192
buffer_store_dwordx4 a[252:255], v248, s[40:43], s7 offen offset:3072 sc1
v_exp_f32 v110, v110
v_add_f32 v176, v176, v109
v_cvt_pk_bf16_f32 v137, v106, v107
v_mfma_f32_32x32x16_bf16 v[80:95], a[140:143], v[220:223], v[80:95]
ds_read_b64_tr_b16 a[174:175], v37 offset:9216
v_exp_f32 v111, v111
v_add_f32 v177, v177, v110
s_waitcnt lgkmcnt(11)
v_mfma_f32_32x32x16_bf16 v[64:79], a[144:147], v[0:3], v[64:79]
ds_read_b64_tr_b16 a[176:177], v34 offset:12288
v_exp_f32 v120, v120
v_add_f32 v176, v176, v111
v_cvt_pk_bf16_f32 v138, v108, v109
v_mfma_f32_32x32x16_bf16 v[80:95], a[144:147], v[4:7], v[80:95]
ds_read_b64_tr_b16 a[178:179], v34 offset:13312
v_exp_f32 v121, v121
v_add_f32 v179, v179, v120
s_waitcnt lgkmcnt(12)
v_mfma_f32_32x32x16_bf16 v[64:79], a[148:151], v[8:11], v[64:79]
ds_read_b64_tr_b16 a[180:181], v35 offset:12288
v_exp_f32 v122, v122
v_add_f32 v178, v178, v121
v_cvt_pk_bf16_f32 v139, v110, v111
v_mfma_f32_32x32x16_bf16 v[80:95], a[148:151], v[12:15], v[80:95]
ds_read_b64_tr_b16 a[182:183], v35 offset:13312
v_exp_f32 v123, v123
v_add_f32 v179, v179, v122
s_waitcnt lgkmcnt(13)
v_mfma_f32_32x32x16_bf16 v[64:79], a[152:155], v[16:19], v[64:79]
ds_read_b64_tr_b16 a[184:185], v36 offset:12288
v_exp_f32 v124, v124
v_add_f32 v178, v178, v123
v_cvt_pk_bf16_f32 v140, v120, v121
v_mfma_f32_32x32x16_bf16 v[80:95], a[152:155], v[20:23], v[80:95]
ds_read_b64_tr_b16 a[186:187], v36 offset:13312
v_exp_f32 v125, v125
v_add_f32 v179, v179, v124
s_waitcnt lgkmcnt(14)
v_mfma_f32_32x32x16_bf16 v[64:79], a[156:159], v[24:27], v[64:79]
ds_read_b64_tr_b16 a[188:189], v37 offset:12288
v_exp_f32 v126, v126
v_add_f32 v178, v178, v125
v_cvt_pk_bf16_f32 v141, v122, v123
v_mfma_f32_32x32x16_bf16 v[80:95], a[156:159], v[28:31], v[80:95]
ds_read_b64_tr_b16 a[190:191], v37 offset:13312
v_exp_f32 v127, v127
v_add_f32 v179, v179, v126
v_add_f32 v178, v178, v127
v_cvt_pk_bf16_f32 v142, v124, v125
v_cvt_pk_bf16_f32 v143, v126, v127
s_waitcnt lgkmcnt(14)
v_mfma_f32_32x32x16_bf16 a[0:15], a[160:163], v[128:131], a[0:15]
s_waitcnt vmcnt(8)
s_barrier
v_exp_f32 v64, v64
s_waitcnt lgkmcnt(12)
v_mfma_f32_32x32x16_bf16 a[32:47], a[164:167], v[128:131], a[32:47]
ds_read_b128 a[128:131], v32 offset:8704
v_exp_f32 v65, v65
v_add_f32 v177, v177, v64
s_waitcnt lgkmcnt(11)
v_mfma_f32_32x32x16_bf16 a[64:79], a[168:171], v[128:131], a[64:79]
ds_read_b128 a[132:135], v33 offset:8704
v_exp_f32 v66, v66
v_add_f32 v176, v176, v65
s_waitcnt lgkmcnt(10)
v_mfma_f32_32x32x16_bf16 a[96:111], a[172:175], v[128:131], a[96:111]
ds_read_b128 a[136:139], v32 offset:8768
v_exp_f32 v67, v67
v_add_f32 v177, v177, v66
v_mfma_f32_32x32x16_bf16 a[16:31], a[160:163], v[132:135], a[16:31]
ds_read_b128 a[140:143], v33 offset:8768
v_exp_f32 v68, v68
v_add_f32 v176, v176, v67
v_cvt_pk_bf16_f32 v128, v64, v65
v_mfma_f32_32x32x16_bf16 a[48:63], a[164:167], v[132:135], a[48:63]
ds_read_b128 a[144:147], v32 offset:8832
v_exp_f32 v69, v69
v_add_f32 v177, v177, v68
v_mfma_f32_32x32x16_bf16 a[80:95], a[168:171], v[132:135], a[80:95]
ds_read_b128 a[148:151], v33 offset:8832
v_exp_f32 v70, v70
v_add_f32 v176, v176, v69
v_cvt_pk_bf16_f32 v129, v66, v67
v_mfma_f32_32x32x16_bf16 a[112:127], a[172:175], v[132:135], a[112:127]
ds_read_b128 a[152:155], v32 offset:8896
v_exp_f32 v71, v71
v_add_f32 v177, v177, v70
s_waitcnt lgkmcnt(13)
v_mfma_f32_32x32x16_bf16 a[0:15], a[176:179], v[136:139], a[0:15]
ds_read_b128 a[156:159], v33 offset:8896
v_exp_f32 v80, v80
v_add_f32 v176, v176, v71
v_cvt_pk_bf16_f32 v130, v68, v69
s_waitcnt lgkmcnt(12)
v_mfma_f32_32x32x16_bf16 a[32:47], a[180:183], v[136:139], a[32:47]
v_exp_f32 v81, v81
v_add_f32 v179, v179, v80
s_add_u32 m0, s52, 0
s_mov_b32 s50, 0x12000
s_waitcnt lgkmcnt(10)
v_mfma_f32_32x32x16_bf16 a[64:79], a[184:187], v[136:139], a[64:79]
buffer_load_dwordx4 v38, s[32:35], s50 offen lds
v_exp_f32 v82, v82
v_add_f32 v178, v178, v81
v_cvt_pk_bf16_f32 v131, v70, v71
s_waitcnt lgkmcnt(8)
v_mfma_f32_32x32x16_bf16 a[96:111], a[188:191], v[136:139], a[96:111]
buffer_load_dwordx4 v39, s[32:35], s50 offen offset:1088 lds
v_exp_f32 v83, v83
v_add_f32 v179, v179, v82
v_mfma_f32_32x32x16_bf16 a[16:31], a[176:179], v[140:143], a[16:31]
v_exp_f32 v84, v84
v_add_f32 v178, v178, v83
v_cvt_pk_bf16_f32 v132, v80, v81
v_mfma_f32_32x32x16_bf16 a[48:63], a[180:183], v[140:143], a[48:63]
v_exp_f32 v85, v85
v_add_f32 v179, v179, v84
s_add_u32 m0, s53, 0
s_mov_b32 s51, 0x10000
v_mfma_f32_32x32x16_bf16 a[80:95], a[184:187], v[140:143], a[80:95]
buffer_load_dwordx4 v40, s[36:39], s51 offen lds
v_exp_f32 v86, v86
v_add_f32 v178, v178, v85
v_cvt_pk_bf16_f32 v133, v82, v83
v_mfma_f32_32x32x16_bf16 a[112:127], a[188:191], v[140:143], a[112:127]
buffer_load_dwordx4 v40, s[36:39], s51 offen offset:1024 lds
v_exp_f32 v87, v87
v_add_f32 v179, v179, v86
s_waitcnt lgkmcnt(7)
v_mfma_f32_32x32x16_bf16 v[96:111], a[128:131], v[192:195], v[144:159]
ds_read_b64_tr_b16 a[160:161], v34 offset:16384
v_exp_f32 v72, v72
v_add_f32 v178, v178, v87
v_cvt_pk_bf16_f32 v134, v84, v85
v_mfma_f32_32x32x16_bf16 v[112:127], a[128:131], v[196:199], v[160:175]
ds_read_b64_tr_b16 a[162:163], v34 offset:17408
v_exp_f32 v73, v73
v_add_f32 v177, v177, v72
s_add_u32 s7, s56, 0x3000
s_waitcnt lgkmcnt(8)
v_mfma_f32_32x32x16_bf16 v[96:111], a[132:135], v[200:203], v[96:111]
ds_read_b64_tr_b16 a[164:165], v35 offset:16384
buffer_store_dwordx4 a[192:195], v248, s[40:43], s7 offen sc1
v_exp_f32 v74, v74
v_add_f32 v176, v176, v73
v_cvt_pk_bf16_f32 v135, v86, v87
v_mfma_f32_32x32x16_bf16 v[112:127], a[132:135], v[204:207], v[112:127]
ds_read_b64_tr_b16 a[166:167], v35 offset:17408
v_exp_f32 v75, v75
v_add_f32 v177, v177, v74
s_waitcnt lgkmcnt(9)
v_mfma_f32_32x32x16_bf16 v[96:111], a[136:139], v[208:211], v[96:111]
ds_read_b64_tr_b16 a[168:169], v36 offset:16384
v_exp_f32 v76, v76
v_add_f32 v176, v176, v75
v_cvt_pk_bf16_f32 v136, v72, v73
v_mfma_f32_32x32x16_bf16 v[112:127], a[136:139], v[212:215], v[112:127]
ds_read_b64_tr_b16 a[170:171], v36 offset:17408
v_exp_f32 v77, v77
v_add_f32 v177, v177, v76
s_add_u32 s7, s56, 0x3000
s_waitcnt lgkmcnt(10)
v_mfma_f32_32x32x16_bf16 v[96:111], a[140:143], v[216:219], v[96:111]
ds_read_b64_tr_b16 a[172:173], v37 offset:16384
buffer_store_dwordx4 a[196:199], v248, s[40:43], s7 offen offset:1024 sc1
v_exp_f32 v78, v78
v_add_f32 v176, v176, v77
v_cvt_pk_bf16_f32 v137, v74, v75
v_mfma_f32_32x32x16_bf16 v[112:127], a[140:143], v[220:223], v[112:127]
ds_read_b64_tr_b16 a[174:175], v37 offset:17408
v_exp_f32 v79, v79
v_add_f32 v177, v177, v78
s_waitcnt lgkmcnt(11)
v_mfma_f32_32x32x16_bf16 v[96:111], a[144:147], v[0:3], v[96:111]
ds_read_b64_tr_b16 a[176:177], v34 offset:20480
v_exp_f32 v88, v88
v_add_f32 v176, v176, v79
v_cvt_pk_bf16_f32 v138, v76, v77
v_mfma_f32_32x32x16_bf16 v[112:127], a[144:147], v[4:7], v[112:127]
ds_read_b64_tr_b16 a[178:179], v34 offset:21504
v_exp_f32 v89, v89
v_add_f32 v179, v179, v88
s_waitcnt lgkmcnt(12)
v_mfma_f32_32x32x16_bf16 v[96:111], a[148:151], v[8:11], v[96:111]
ds_read_b64_tr_b16 a[180:181], v35 offset:20480
v_exp_f32 v90, v90
v_add_f32 v178, v178, v89
v_cvt_pk_bf16_f32 v139, v78, v79
v_mfma_f32_32x32x16_bf16 v[112:127], a[148:151], v[12:15], v[112:127]
ds_read_b64_tr_b16 a[182:183], v35 offset:21504
v_exp_f32 v91, v91
v_add_f32 v179, v179, v90
s_waitcnt lgkmcnt(13)
v_mfma_f32_32x32x16_bf16 v[96:111], a[152:155], v[16:19], v[96:111]
ds_read_b64_tr_b16 a[184:185], v36 offset:20480
v_exp_f32 v92, v92
v_add_f32 v178, v178, v91
v_cvt_pk_bf16_f32 v140, v88, v89
v_mfma_f32_32x32x16_bf16 v[112:127], a[152:155], v[20:23], v[112:127]
ds_read_b64_tr_b16 a[186:187], v36 offset:21504
v_exp_f32 v93, v93
v_add_f32 v179, v179, v92
s_waitcnt lgkmcnt(14)
v_mfma_f32_32x32x16_bf16 v[96:111], a[156:159], v[24:27], v[96:111]
ds_read_b64_tr_b16 a[188:189], v37 offset:20480
v_exp_f32 v94, v94
v_add_f32 v178, v178, v93
v_cvt_pk_bf16_f32 v141, v90, v91
v_mfma_f32_32x32x16_bf16 v[112:127], a[156:159], v[28:31], v[112:127]
ds_read_b64_tr_b16 a[190:191], v37 offset:21504
v_exp_f32 v95, v95
v_add_f32 v179, v179, v94
v_add_f32 v178, v178, v95
v_cvt_pk_bf16_f32 v142, v92, v93
v_cvt_pk_bf16_f32 v143, v94, v95
s_waitcnt lgkmcnt(14)
v_mfma_f32_32x32x16_bf16 a[0:15], a[160:163], v[128:131], a[0:15]
s_waitcnt vmcnt(8)
s_barrier
v_exp_f32 v96, v96
s_waitcnt lgkmcnt(12)
v_mfma_f32_32x32x16_bf16 a[32:47], a[164:167], v[128:131], a[32:47]
ds_read_b128 a[128:131], v32 offset:17408
v_exp_f32 v97, v97
v_add_f32 v177, v177, v96
s_waitcnt lgkmcnt(11)
v_mfma_f32_32x32x16_bf16 a[64:79], a[168:171], v[128:131], a[64:79]
ds_read_b128 a[132:135], v33 offset:17408
v_exp_f32 v98, v98
v_add_f32 v176, v176, v97
s_waitcnt lgkmcnt(10)
v_mfma_f32_32x32x16_bf16 a[96:111], a[172:175], v[128:131], a[96:111]
ds_read_b128 a[136:139], v32 offset:17472
v_exp_f32 v99, v99
v_add_f32 v177, v177, v98
v_mfma_f32_32x32x16_bf16 a[16:31], a[160:163], v[132:135], a[16:31]
ds_read_b128 a[140:143], v33 offset:17472
v_exp_f32 v100, v100
v_add_f32 v176, v176, v99
v_cvt_pk_bf16_f32 v128, v96, v97
v_mfma_f32_32x32x16_bf16 a[48:63], a[164:167], v[132:135], a[48:63]
ds_read_b128 a[144:147], v32 offset:17536
v_exp_f32 v101, v101
v_add_f32 v177, v177, v100
v_mfma_f32_32x32x16_bf16 a[80:95], a[168:171], v[132:135], a[80:95]
ds_read_b128 a[148:151], v33 offset:17536
v_exp_f32 v102, v102
v_add_f32 v176, v176, v101
v_cvt_pk_bf16_f32 v129, v98, v99
v_mfma_f32_32x32x16_bf16 a[112:127], a[172:175], v[132:135], a[112:127]
ds_read_b128 a[152:155], v32 offset:17600
v_exp_f32 v103, v103
v_add_f32 v177, v177, v102
s_waitcnt lgkmcnt(13)
v_mfma_f32_32x32x16_bf16 a[0:15], a[176:179], v[136:139], a[0:15]
ds_read_b128 a[156:159], v33 offset:17600
v_exp_f32 v112, v112
v_add_f32 v176, v176, v103
v_cvt_pk_bf16_f32 v130, v100, v101
s_waitcnt lgkmcnt(12)
v_mfma_f32_32x32x16_bf16 a[32:47], a[180:183], v[136:139], a[32:47]
v_exp_f32 v113, v113
v_add_f32 v179, v179, v112
s_add_u32 m0, s52, 0x2200
s_mov_b32 s50, 0x14000
s_waitcnt lgkmcnt(10)
v_mfma_f32_32x32x16_bf16 a[64:79], a[184:187], v[136:139], a[64:79]
buffer_load_dwordx4 v38, s[32:35], s50 offen lds
v_exp_f32 v114, v114
v_add_f32 v178, v178, v113
v_cvt_pk_bf16_f32 v131, v102, v103
s_waitcnt lgkmcnt(8)
v_mfma_f32_32x32x16_bf16 a[96:111], a[188:191], v[136:139], a[96:111]
buffer_load_dwordx4 v39, s[32:35], s50 offen offset:1088 lds
v_exp_f32 v115, v115
v_add_f32 v179, v179, v114
v_mfma_f32_32x32x16_bf16 a[16:31], a[176:179], v[140:143], a[16:31]
v_exp_f32 v116, v116
v_add_f32 v178, v178, v115
v_cvt_pk_bf16_f32 v132, v112, v113
v_mfma_f32_32x32x16_bf16 a[48:63], a[180:183], v[140:143], a[48:63]
v_exp_f32 v117, v117
v_add_f32 v179, v179, v116
s_add_u32 m0, s53, 0x2000
s_mov_b32 s51, 0x12000
v_mfma_f32_32x32x16_bf16 a[80:95], a[184:187], v[140:143], a[80:95]
buffer_load_dwordx4 v40, s[36:39], s51 offen lds
v_exp_f32 v118, v118
v_add_f32 v178, v178, v117
v_cvt_pk_bf16_f32 v133, v114, v115
v_mfma_f32_32x32x16_bf16 a[112:127], a[188:191], v[140:143], a[112:127]
buffer_load_dwordx4 v40, s[36:39], s51 offen offset:1024 lds
v_exp_f32 v119, v119
v_add_f32 v179, v179, v118
s_waitcnt lgkmcnt(7)
v_mfma_f32_32x32x16_bf16 v[64:79], a[128:131], v[192:195], v[144:159]
ds_read_b64_tr_b16 a[160:161], v34 offset:24576
v_exp_f32 v104, v104
v_add_f32 v178, v178, v119
v_cvt_pk_bf16_f32 v134, v116, v117
v_mfma_f32_32x32x16_bf16 v[80:95], a[128:131], v[196:199], v[160:175]
ds_read_b64_tr_b16 a[162:163], v34 offset:25600
v_exp_f32 v105, v105
v_add_f32 v177, v177, v104
s_add_u32 s7, s56, 0x3000
s_waitcnt lgkmcnt(8)
v_mfma_f32_32x32x16_bf16 v[64:79], a[132:135], v[200:203], v[64:79]
ds_read_b64_tr_b16 a[164:165], v35 offset:24576
buffer_store_dwordx4 a[200:203], v248, s[40:43], s7 offen offset:2048 sc1
v_exp_f32 v106, v106
v_add_f32 v176, v176, v105
v_cvt_pk_bf16_f32 v135, v118, v119
v_mfma_f32_32x32x16_bf16 v[80:95], a[132:135], v[204:207], v[80:95]
ds_read_b64_tr_b16 a[166:167], v35 offset:25600
v_exp_f32 v107, v107
v_add_f32 v177, v177, v106
s_waitcnt lgkmcnt(9)
v_mfma_f32_32x32x16_bf16 v[64:79], a[136:139], v[208:211], v[64:79]
ds_read_b64_tr_b16 a[168:169], v36 offset:24576
v_exp_f32 v108, v108
v_add_f32 v176, v176, v107
v_cvt_pk_bf16_f32 v136, v104, v105
v_mfma_f32_32x32x16_bf16 v[80:95], a[136:139], v[212:215], v[80:95]
ds_read_b64_tr_b16 a[170:171], v36 offset:25600
v_exp_f32 v109, v109
v_add_f32 v177, v177, v108
s_add_u32 s7, s56, 0x3000
s_waitcnt lgkmcnt(10)
v_mfma_f32_32x32x16_bf16 v[64:79], a[140:143], v[216:219], v[64:79]
ds_read_b64_tr_b16 a[172:173], v37 offset:24576
buffer_store_dwordx4 a[204:207], v248, s[40:43], s7 offen offset:3072 sc1
v_exp_f32 v110, v110
v_add_f32 v176, v176, v109
v_cvt_pk_bf16_f32 v137, v106, v107
v_mfma_f32_32x32x16_bf16 v[80:95], a[140:143], v[220:223], v[80:95]
ds_read_b64_tr_b16 a[174:175], v37 offset:25600
v_exp_f32 v111, v111
v_add_f32 v177, v177, v110
s_waitcnt lgkmcnt(11)
v_mfma_f32_32x32x16_bf16 v[64:79], a[144:147], v[0:3], v[64:79]
ds_read_b64_tr_b16 a[176:177], v34 offset:28672
v_exp_f32 v120, v120
v_add_f32 v176, v176, v111
v_cvt_pk_bf16_f32 v138, v108, v109
v_mfma_f32_32x32x16_bf16 v[80:95], a[144:147], v[4:7], v[80:95]
ds_read_b64_tr_b16 a[178:179], v34 offset:29696
v_exp_f32 v121, v121
v_add_f32 v179, v179, v120
s_waitcnt lgkmcnt(12)
v_mfma_f32_32x32x16_bf16 v[64:79], a[148:151], v[8:11], v[64:79]
ds_read_b64_tr_b16 a[180:181], v35 offset:28672
v_exp_f32 v122, v122
v_add_f32 v178, v178, v121
v_cvt_pk_bf16_f32 v139, v110, v111
v_mfma_f32_32x32x16_bf16 v[80:95], a[148:151], v[12:15], v[80:95]
ds_read_b64_tr_b16 a[182:183], v35 offset:29696
v_exp_f32 v123, v123
v_add_f32 v179, v179, v122
s_waitcnt lgkmcnt(13)
v_mfma_f32_32x32x16_bf16 v[64:79], a[152:155], v[16:19], v[64:79]
ds_read_b64_tr_b16 a[184:185], v36 offset:28672
v_exp_f32 v124, v124
v_add_f32 v178, v178, v123
v_cvt_pk_bf16_f32 v140, v120, v121
v_mfma_f32_32x32x16_bf16 v[80:95], a[152:155], v[20:23], v[80:95]
ds_read_b64_tr_b16 a[186:187], v36 offset:29696
v_exp_f32 v125, v125
v_add_f32 v179, v179, v124
s_waitcnt lgkmcnt(14)
v_mfma_f32_32x32x16_bf16 v[64:79], a[156:159], v[24:27], v[64:79]
ds_read_b64_tr_b16 a[188:189], v37 offset:28672
v_exp_f32 v126, v126
v_add_f32 v178, v178, v125
v_cvt_pk_bf16_f32 v141, v122, v123
v_mfma_f32_32x32x16_bf16 v[80:95], a[156:159], v[28:31], v[80:95]
ds_read_b64_tr_b16 a[190:191], v37 offset:29696
v_exp_f32 v127, v127
v_add_f32 v179, v179, v126
v_add_f32 v178, v178, v127
v_cvt_pk_bf16_f32 v142, v124, v125
v_cvt_pk_bf16_f32 v143, v126, v127
s_waitcnt lgkmcnt(14)
v_mfma_f32_32x32x16_bf16 a[0:15], a[160:163], v[128:131], a[0:15]
s_waitcnt vmcnt(8)
s_barrier
v_exp_f32 v64, v64
s_waitcnt lgkmcnt(12)
v_mfma_f32_32x32x16_bf16 a[32:47], a[164:167], v[128:131], a[32:47]
ds_read_b128 a[128:131], v32
v_exp_f32 v65, v65
v_add_f32 v177, v177, v64
s_waitcnt lgkmcnt(11)
v_mfma_f32_32x32x16_bf16 a[64:79], a[168:171], v[128:131], a[64:79]
ds_read_b128 a[132:135], v33
v_exp_f32 v66, v66
v_add_f32 v176, v176, v65
s_waitcnt lgkmcnt(10)
v_mfma_f32_32x32x16_bf16 a[96:111], a[172:175], v[128:131], a[96:111]
ds_read_b128 a[136:139], v32 offset:64
v_exp_f32 v67, v67
v_add_f32 v177, v177, v66
v_mfma_f32_32x32x16_bf16 a[16:31], a[160:163], v[132:135], a[16:31]
ds_read_b128 a[140:143], v33 offset:64
v_exp_f32 v68, v68
v_add_f32 v176, v176, v67
v_cvt_pk_bf16_f32 v128, v64, v65
v_mfma_f32_32x32x16_bf16 a[48:63], a[164:167], v[132:135], a[48:63]
ds_read_b128 a[144:147], v32 offset:128
v_exp_f32 v69, v69
v_add_f32 v177, v177, v68
v_mfma_f32_32x32x16_bf16 a[80:95], a[168:171], v[132:135], a[80:95]
ds_read_b128 a[148:151], v33 offset:128
v_exp_f32 v70, v70
v_add_f32 v176, v176, v69
v_cvt_pk_bf16_f32 v129, v66, v67
v_mfma_f32_32x32x16_bf16 a[112:127], a[172:175], v[132:135], a[112:127]
ds_read_b128 a[152:155], v32 offset:192
v_exp_f32 v71, v71
v_add_f32 v177, v177, v70
s_waitcnt lgkmcnt(13)
v_mfma_f32_32x32x16_bf16 a[0:15], a[176:179], v[136:139], a[0:15]
ds_read_b128 a[156:159], v33 offset:192
v_exp_f32 v80, v80
v_add_f32 v176, v176, v71
v_cvt_pk_bf16_f32 v130, v68, v69
s_waitcnt lgkmcnt(12)
v_mfma_f32_32x32x16_bf16 a[32:47], a[180:183], v[136:139], a[32:47]
v_exp_f32 v81, v81
v_add_f32 v179, v179, v80
s_add_u32 m0, s52, 0x4400
s_mov_b32 s50, 0x16000
s_waitcnt lgkmcnt(10)
v_mfma_f32_32x32x16_bf16 a[64:79], a[184:187], v[136:139], a[64:79]
buffer_load_dwordx4 v38, s[32:35], s50 offen lds
v_exp_f32 v82, v82
v_add_f32 v178, v178, v81
v_cvt_pk_bf16_f32 v131, v70, v71
s_waitcnt lgkmcnt(8)
v_mfma_f32_32x32x16_bf16 a[96:111], a[188:191], v[136:139], a[96:111]
buffer_load_dwordx4 v39, s[32:35], s50 offen offset:1088 lds
v_exp_f32 v83, v83
v_add_f32 v179, v179, v82
v_mfma_f32_32x32x16_bf16 a[16:31], a[176:179], v[140:143], a[16:31]
v_exp_f32 v84, v84
v_add_f32 v178, v178, v83
v_cvt_pk_bf16_f32 v132, v80, v81
v_mfma_f32_32x32x16_bf16 a[48:63], a[180:183], v[140:143], a[48:63]
v_exp_f32 v85, v85
v_add_f32 v179, v179, v84
s_add_u32 m0, s53, 0x4000
s_mov_b32 s51, 0x14000
v_mfma_f32_32x32x16_bf16 a[80:95], a[184:187], v[140:143], a[80:95]
buffer_load_dwordx4 v40, s[36:39], s51 offen lds
v_exp_f32 v86, v86
v_add_f32 v178, v178, v85
v_cvt_pk_bf16_f32 v133, v82, v83
v_mfma_f32_32x32x16_bf16 a[112:127], a[188:191], v[140:143], a[112:127]
buffer_load_dwordx4 v40, s[36:39], s51 offen offset:1024 lds
v_exp_f32 v87, v87
v_add_f32 v179, v179, v86
s_waitcnt lgkmcnt(7)
v_mfma_f32_32x32x16_bf16 v[96:111], a[128:131], v[192:195], v[144:159]
ds_read_b64_tr_b16 a[160:161], v34
v_exp_f32 v72, v72
v_add_f32 v178, v178, v87
v_cvt_pk_bf16_f32 v134, v84, v85
v_mfma_f32_32x32x16_bf16 v[112:127], a[128:131], v[196:199], v[160:175]
ds_read_b64_tr_b16 a[162:163], v34 offset:1024
v_exp_f32 v73, v73
v_add_f32 v177, v177, v72
s_waitcnt lgkmcnt(8)
v_mfma_f32_32x32x16_bf16 v[96:111], a[132:135], v[200:203], v[96:111]
ds_read_b64_tr_b16 a[164:165], v35
v_exp_f32 v74, v74
v_add_f32 v176, v176, v73
v_cvt_pk_bf16_f32 v135, v86, v87
v_mfma_f32_32x32x16_bf16 v[112:127], a[132:135], v[204:207], v[112:127]
ds_read_b64_tr_b16 a[166:167], v35 offset:1024
v_exp_f32 v75, v75
v_add_f32 v177, v177, v74
s_waitcnt lgkmcnt(9)
v_mfma_f32_32x32x16_bf16 v[96:111], a[136:139], v[208:211], v[96:111]
ds_read_b64_tr_b16 a[168:169], v36
v_exp_f32 v76, v76
v_add_f32 v176, v176, v75
v_cvt_pk_bf16_f32 v136, v72, v73
v_mfma_f32_32x32x16_bf16 v[112:127], a[136:139], v[212:215], v[112:127]
ds_read_b64_tr_b16 a[170:171], v36 offset:1024
v_exp_f32 v77, v77
v_add_f32 v177, v177, v76
s_waitcnt lgkmcnt(10)
v_mfma_f32_32x32x16_bf16 v[96:111], a[140:143], v[216:219], v[96:111]
ds_read_b64_tr_b16 a[172:173], v37
v_exp_f32 v78, v78
v_add_f32 v176, v176, v77
v_cvt_pk_bf16_f32 v137, v74, v75
v_mfma_f32_32x32x16_bf16 v[112:127], a[140:143], v[220:223], v[112:127]
ds_read_b64_tr_b16 a[174:175], v37 offset:1024
v_exp_f32 v79, v79
v_add_f32 v177, v177, v78
s_waitcnt lgkmcnt(11)
v_mfma_f32_32x32x16_bf16 v[96:111], a[144:147], v[0:3], v[96:111]
ds_read_b64_tr_b16 a[176:177], v34 offset:4096
v_exp_f32 v88, v88
v_add_f32 v176, v176, v79
v_cvt_pk_bf16_f32 v138, v76, v77
v_mfma_f32_32x32x16_bf16 v[112:127], a[144:147], v[4:7], v[112:127]
ds_read_b64_tr_b16 a[178:179], v34 offset:5120
v_exp_f32 v89, v89
v_add_f32 v179, v179, v88
s_waitcnt lgkmcnt(12)
v_mfma_f32_32x32x16_bf16 v[96:111], a[148:151], v[8:11], v[96:111]
ds_read_b64_tr_b16 a[180:181], v35 offset:4096
v_exp_f32 v90, v90
v_add_f32 v178, v178, v89
v_cvt_pk_bf16_f32 v139, v78, v79
v_mfma_f32_32x32x16_bf16 v[112:127], a[148:151], v[12:15], v[112:127]
ds_read_b64_tr_b16 a[182:183], v35 offset:5120
v_exp_f32 v91, v91
v_add_f32 v179, v179, v90
s_waitcnt lgkmcnt(13)
v_mfma_f32_32x32x16_bf16 v[96:111], a[152:155], v[16:19], v[96:111]
ds_read_b64_tr_b16 a[184:185], v36 offset:4096
v_exp_f32 v92, v92
v_add_f32 v178, v178, v91
v_cvt_pk_bf16_f32 v140, v88, v89
v_mfma_f32_32x32x16_bf16 v[112:127], a[152:155], v[20:23], v[112:127]
ds_read_b64_tr_b16 a[186:187], v36 offset:5120
v_exp_f32 v93, v93
v_add_f32 v179, v179, v92
s_waitcnt lgkmcnt(14)
v_mfma_f32_32x32x16_bf16 v[96:111], a[156:159], v[24:27], v[96:111]
ds_read_b64_tr_b16 a[188:189], v37 offset:4096
v_exp_f32 v94, v94
v_add_f32 v178, v178, v93
v_cvt_pk_bf16_f32 v141, v90, v91
v_mfma_f32_32x32x16_bf16 v[112:127], a[156:159], v[28:31], v[112:127]
ds_read_b64_tr_b16 a[190:191], v37 offset:5120
v_exp_f32 v95, v95
v_add_f32 v179, v179, v94
v_add_f32 v178, v178, v95
v_cvt_pk_bf16_f32 v142, v92, v93
v_cvt_pk_bf16_f32 v143, v94, v95
s_waitcnt lgkmcnt(14)
v_mfma_f32_32x32x16_bf16 a[0:15], a[160:163], v[128:131], a[0:15]
s_waitcnt vmcnt(4)
s_barrier
buffer_store_dword v60, v252, s[40:43], 0 offen sc1
v_exp_f32 v96, v96
s_waitcnt lgkmcnt(12)
v_mfma_f32_32x32x16_bf16 a[32:47], a[164:167], v[128:131], a[32:47]
ds_read_b128 a[128:131], v32 offset:8704
v_exp_f32 v97, v97
v_add_f32 v177, v177, v96
s_waitcnt lgkmcnt(11)
v_mfma_f32_32x32x16_bf16 a[64:79], a[168:171], v[128:131], a[64:79]
ds_read_b128 a[132:135], v33 offset:8704
v_exp_f32 v98, v98
v_add_f32 v176, v176, v97
s_waitcnt lgkmcnt(10)
v_mfma_f32_32x32x16_bf16 a[96:111], a[172:175], v[128:131], a[96:111]
ds_read_b128 a[136:139], v32 offset:8768
v_exp_f32 v99, v99
v_add_f32 v177, v177, v98
v_mfma_f32_32x32x16_bf16 a[16:31], a[160:163], v[132:135], a[16:31]
ds_read_b128 a[140:143], v33 offset:8768
v_exp_f32 v100, v100
v_add_f32 v176, v176, v99
v_cvt_pk_bf16_f32 v128, v96, v97
v_mfma_f32_32x32x16_bf16 a[48:63], a[164:167], v[132:135], a[48:63]
ds_read_b128 a[144:147], v32 offset:8832
v_exp_f32 v101, v101
v_add_f32 v177, v177, v100
v_mfma_f32_32x32x16_bf16 a[80:95], a[168:171], v[132:135], a[80:95]
ds_read_b128 a[148:151], v33 offset:8832
v_exp_f32 v102, v102
v_add_f32 v176, v176, v101
v_cvt_pk_bf16_f32 v129, v98, v99
v_mfma_f32_32x32x16_bf16 a[112:127], a[172:175], v[132:135], a[112:127]
ds_read_b128 a[152:155], v32 offset:8896
v_exp_f32 v103, v103
v_add_f32 v177, v177, v102
s_waitcnt lgkmcnt(13)
v_mfma_f32_32x32x16_bf16 a[0:15], a[176:179], v[136:139], a[0:15]
ds_read_b128 a[156:159], v33 offset:8896
v_exp_f32 v112, v112
v_add_f32 v176, v176, v103
v_cvt_pk_bf16_f32 v130, v100, v101
s_waitcnt lgkmcnt(12)
v_mfma_f32_32x32x16_bf16 a[32:47], a[180:183], v[136:139], a[32:47]
v_exp_f32 v113, v113
v_add_f32 v179, v179, v112
s_add_u32 m0, s52, 0
s_mov_b32 s50, 0x18000
s_waitcnt lgkmcnt(10)
v_mfma_f32_32x32x16_bf16 a[64:79], a[184:187], v[136:139], a[64:79]
buffer_load_dwordx4 v38, s[32:35], s50 offen lds
v_exp_f32 v114, v114
v_add_f32 v178, v178, v113
v_cvt_pk_bf16_f32 v131, v102, v103
s_waitcnt lgkmcnt(8)
v_mfma_f32_32x32x16_bf16 a[96:111], a[188:191], v[136:139], a[96:111]
buffer_load_dwordx4 v39, s[32:35], s50 offen offset:1088 lds
v_exp_f32 v115, v115
v_add_f32 v179, v179, v114
v_mfma_f32_32x32x16_bf16 a[16:31], a[176:179], v[140:143], a[16:31]
v_exp_f32 v116, v116
v_add_f32 v178, v178, v115
v_cvt_pk_bf16_f32 v132, v112, v113
v_mfma_f32_32x32x16_bf16 a[48:63], a[180:183], v[140:143], a[48:63]
v_exp_f32 v117, v117
v_add_f32 v179, v179, v116
s_add_u32 m0, s53, 0x6000
s_mov_b32 s51, 0x16000
v_mfma_f32_32x32x16_bf16 a[80:95], a[184:187], v[140:143], a[80:95]
buffer_load_dwordx4 v40, s[36:39], s51 offen lds
v_exp_f32 v118, v118
v_add_f32 v178, v178, v117
v_cvt_pk_bf16_f32 v133, v114, v115
v_mfma_f32_32x32x16_bf16 a[112:127], a[188:191], v[140:143], a[112:127]
buffer_load_dwordx4 v40, s[36:39], s51 offen offset:1024 lds
v_exp_f32 v119, v119
v_add_f32 v179, v179, v118
s_waitcnt lgkmcnt(7)
v_mfma_f32_32x32x16_bf16 v[64:79], a[128:131], v[192:195], v[144:159]
ds_read_b64_tr_b16 a[160:161], v34 offset:8192
v_exp_f32 v104, v104
v_add_f32 v178, v178, v119
v_cvt_pk_bf16_f32 v134, v116, v117
v_mfma_f32_32x32x16_bf16 v[80:95], a[128:131], v[196:199], v[160:175]
ds_read_b64_tr_b16 a[162:163], v34 offset:9216
v_exp_f32 v105, v105
v_add_f32 v177, v177, v104
s_waitcnt lgkmcnt(8)
v_mfma_f32_32x32x16_bf16 v[64:79], a[132:135], v[200:203], v[64:79]
ds_read_b64_tr_b16 a[164:165], v35 offset:8192
v_exp_f32 v106, v106
v_add_f32 v176, v176, v105
v_cvt_pk_bf16_f32 v135, v118, v119
v_mfma_f32_32x32x16_bf16 v[80:95], a[132:135], v[204:207], v[80:95]
ds_read_b64_tr_b16 a[166:167], v35 offset:9216
v_exp_f32 v107, v107
v_add_f32 v177, v177, v106
s_waitcnt lgkmcnt(9)
v_mfma_f32_32x32x16_bf16 v[64:79], a[136:139], v[208:211], v[64:79]
ds_read_b64_tr_b16 a[168:169], v36 offset:8192
v_exp_f32 v108, v108
v_add_f32 v176, v176, v107
v_cvt_pk_bf16_f32 v136, v104, v105
v_mfma_f32_32x32x16_bf16 v[80:95], a[136:139], v[212:215], v[80:95]
ds_read_b64_tr_b16 a[170:171], v36 offset:9216
v_exp_f32 v109, v109
v_add_f32 v177, v177, v108
s_waitcnt lgkmcnt(10)
v_mfma_f32_32x32x16_bf16 v[64:79], a[140:143], v[216:219], v[64:79]
ds_read_b64_tr_b16 a[172:173], v37 offset:8192
v_exp_f32 v110, v110
v_add_f32 v176, v176, v109
v_cvt_pk_bf16_f32 v137, v106, v107
v_mfma_f32_32x32x16_bf16 v[80:95], a[140:143], v[220:223], v[80:95]
ds_read_b64_tr_b16 a[174:175], v37 offset:9216
v_exp_f32 v111, v111
v_add_f32 v177, v177, v110
s_waitcnt lgkmcnt(11)
v_mfma_f32_32x32x16_bf16 v[64:79], a[144:147], v[0:3], v[64:79]
ds_read_b64_tr_b16 a[176:177], v34 offset:12288
v_exp_f32 v120, v120
v_add_f32 v176, v176, v111
v_cvt_pk_bf16_f32 v138, v108, v109
v_mfma_f32_32x32x16_bf16 v[80:95], a[144:147], v[4:7], v[80:95]
ds_read_b64_tr_b16 a[178:179], v34 offset:13312
v_exp_f32 v121, v121
v_add_f32 v179, v179, v120
s_waitcnt lgkmcnt(12)
v_mfma_f32_32x32x16_bf16 v[64:79], a[148:151], v[8:11], v[64:79]
ds_read_b64_tr_b16 a[180:181], v35 offset:12288
v_exp_f32 v122, v122
v_add_f32 v178, v178, v121
v_cvt_pk_bf16_f32 v139, v110, v111
v_mfma_f32_32x32x16_bf16 v[80:95], a[148:151], v[12:15], v[80:95]
ds_read_b64_tr_b16 a[182:183], v35 offset:13312
v_exp_f32 v123, v123
v_add_f32 v179, v179, v122
s_waitcnt lgkmcnt(13)
v_mfma_f32_32x32x16_bf16 v[64:79], a[152:155], v[16:19], v[64:79]
ds_read_b64_tr_b16 a[184:185], v36 offset:12288
v_exp_f32 v124, v124
v_add_f32 v178, v178, v123
v_cvt_pk_bf16_f32 v140, v120, v121
v_mfma_f32_32x32x16_bf16 v[80:95], a[152:155], v[20:23], v[80:95]
ds_read_b64_tr_b16 a[186:187], v36 offset:13312
v_exp_f32 v125, v125
v_add_f32 v179, v179, v124
s_waitcnt lgkmcnt(14)
v_mfma_f32_32x32x16_bf16 v[64:79], a[156:159], v[24:27], v[64:79]
ds_read_b64_tr_b16 a[188:189], v37 offset:12288
v_exp_f32 v126, v126
v_add_f32 v178, v178, v125
v_cvt_pk_bf16_f32 v141, v122, v123
v_mfma_f32_32x32x16_bf16 v[80:95], a[156:159], v[28:31], v[80:95]
ds_read_b64_tr_b16 a[190:191], v37 offset:13312
v_exp_f32 v127, v127
v_add_f32 v179, v179, v126
v_add_f32 v178, v178, v127
v_cvt_pk_bf16_f32 v142, v124, v125
v_cvt_pk_bf16_f32 v143, v126, v127
s_waitcnt lgkmcnt(14)
v_mfma_f32_32x32x16_bf16 a[0:15], a[160:163], v[128:131], a[0:15]
s_waitcnt vmcnt(5)
s_barrier
v_exp_f32 v64, v64
s_waitcnt lgkmcnt(12)
v_mfma_f32_32x32x16_bf16 a[32:47], a[164:167], v[128:131], a[32:47]
ds_read_b128 a[128:131], v32 offset:17408
v_exp_f32 v65, v65
v_add_f32 v177, v177, v64
s_waitcnt lgkmcnt(11)
v_mfma_f32_32x32x16_bf16 a[64:79], a[168:171], v[128:131], a[64:79]
ds_read_b128 a[132:135], v33 offset:17408
v_exp_f32 v66, v66
v_add_f32 v176, v176, v65
s_waitcnt lgkmcnt(10)
v_mfma_f32_32x32x16_bf16 a[96:111], a[172:175], v[128:131], a[96:111]
ds_read_b128 a[136:139], v32 offset:17472
v_exp_f32 v67, v67
v_add_f32 v177, v177, v66
v_mfma_f32_32x32x16_bf16 a[16:31], a[160:163], v[132:135], a[16:31]
ds_read_b128 a[140:143], v33 offset:17472
v_exp_f32 v68, v68
v_add_f32 v176, v176, v67
v_cvt_pk_bf16_f32 v128, v64, v65
v_mfma_f32_32x32x16_bf16 a[48:63], a[164:167], v[132:135], a[48:63]
ds_read_b128 a[144:147], v32 offset:17536
v_exp_f32 v69, v69
v_add_f32 v177, v177, v68
v_mfma_f32_32x32x16_bf16 a[80:95], a[168:171], v[132:135], a[80:95]
ds_read_b128 a[148:151], v33 offset:17536
v_exp_f32 v70, v70
v_add_f32 v176, v176, v69
v_cvt_pk_bf16_f32 v129, v66, v67
v_mfma_f32_32x32x16_bf16 a[112:127], a[172:175], v[132:135], a[112:127]
ds_read_b128 a[152:155], v32 offset:17600
v_exp_f32 v71, v71
v_add_f32 v177, v177, v70
s_waitcnt lgkmcnt(13)
v_mfma_f32_32x32x16_bf16 a[0:15], a[176:179], v[136:139], a[0:15]
ds_read_b128 a[156:159], v33 offset:17600
v_exp_f32 v80, v80
v_add_f32 v176, v176, v71
v_cvt_pk_bf16_f32 v130, v68, v69
s_waitcnt lgkmcnt(12)
v_mfma_f32_32x32x16_bf16 a[32:47], a[180:183], v[136:139], a[32:47]
v_exp_f32 v81, v81
v_add_f32 v179, v179, v80
s_add_u32 m0, s52, 0x2200
s_mov_b32 s50, 0x1a000
s_waitcnt lgkmcnt(10)
v_mfma_f32_32x32x16_bf16 a[64:79], a[184:187], v[136:139], a[64:79]
buffer_load_dwordx4 v38, s[32:35], s50 offen lds
v_exp_f32 v82, v82
v_add_f32 v178, v178, v81
v_cvt_pk_bf16_f32 v131, v70, v71
s_waitcnt lgkmcnt(8)
v_mfma_f32_32x32x16_bf16 a[96:111], a[188:191], v[136:139], a[96:111]
buffer_load_dwordx4 v39, s[32:35], s50 offen offset:1088 lds
v_exp_f32 v83, v83
v_add_f32 v179, v179, v82
v_mfma_f32_32x32x16_bf16 a[16:31], a[176:179], v[140:143], a[16:31]
v_exp_f32 v84, v84
v_add_f32 v178, v178, v83
v_cvt_pk_bf16_f32 v132, v80, v81
v_mfma_f32_32x32x16_bf16 a[48:63], a[180:183], v[140:143], a[48:63]
v_exp_f32 v85, v85
v_add_f32 v179, v179, v84
s_add_u32 m0, s53, 0
s_mov_b32 s51, 0x18000
v_mfma_f32_32x32x16_bf16 a[80:95], a[184:187], v[140:143], a[80:95]
buffer_load_dwordx4 v40, s[36:39], s51 offen lds
v_exp_f32 v86, v86
v_add_f32 v178, v178, v85
v_cvt_pk_bf16_f32 v133, v82, v83
v_mfma_f32_32x32x16_bf16 a[112:127], a[188:191], v[140:143], a[112:127]
buffer_load_dwordx4 v40, s[36:39], s51 offen offset:1024 lds
v_exp_f32 v87, v87
v_add_f32 v179, v179, v86
s_waitcnt lgkmcnt(7)
v_mfma_f32_32x32x16_bf16 v[96:111], a[128:131], v[192:195], v[144:159]
ds_read_b64_tr_b16 a[160:161], v34 offset:16384
v_exp_f32 v72, v72
v_add_f32 v178, v178, v87
v_cvt_pk_bf16_f32 v134, v84, v85
v_mfma_f32_32x32x16_bf16 v[112:127], a[128:131], v[196:199], v[160:175]
ds_read_b64_tr_b16 a[162:163], v34 offset:17408
v_exp_f32 v73, v73
v_add_f32 v177, v177, v72
s_waitcnt lgkmcnt(8)
v_mfma_f32_32x32x16_bf16 v[96:111], a[132:135], v[200:203], v[96:111]
ds_read_b64_tr_b16 a[164:165], v35 offset:16384
v_exp_f32 v74, v74
v_add_f32 v176, v176, v73
v_cvt_pk_bf16_f32 v135, v86, v87
v_mfma_f32_32x32x16_bf16 v[112:127], a[132:135], v[204:207], v[112:127]
ds_read_b64_tr_b16 a[166:167], v35 offset:17408
v_exp_f32 v75, v75
v_add_f32 v177, v177, v74
s_waitcnt lgkmcnt(9)
v_mfma_f32_32x32x16_bf16 v[96:111], a[136:139], v[208:211], v[96:111]
ds_read_b64_tr_b16 a[168:169], v36 offset:16384
v_exp_f32 v76, v76
v_add_f32 v176, v176, v75
v_cvt_pk_bf16_f32 v136, v72, v73
v_mfma_f32_32x32x16_bf16 v[112:127], a[136:139], v[212:215], v[112:127]
ds_read_b64_tr_b16 a[170:171], v36 offset:17408
v_exp_f32 v77, v77
v_add_f32 v177, v177, v76
s_waitcnt lgkmcnt(10)
v_mfma_f32_32x32x16_bf16 v[96:111], a[140:143], v[216:219], v[96:111]
ds_read_b64_tr_b16 a[172:173], v37 offset:16384
v_exp_f32 v78, v78
v_add_f32 v176, v176, v77
v_cvt_pk_bf16_f32 v137, v74, v75
v_mfma_f32_32x32x16_bf16 v[112:127], a[140:143], v[220:223], v[112:127]
ds_read_b64_tr_b16 a[174:175], v37 offset:17408
v_exp_f32 v79, v79
v_add_f32 v177, v177, v78
s_waitcnt lgkmcnt(11)
v_mfma_f32_32x32x16_bf16 v[96:111], a[144:147], v[0:3], v[96:111]
ds_read_b64_tr_b16 a[176:177], v34 offset:20480
v_exp_f32 v88, v88
v_add_f32 v176, v176, v79
v_cvt_pk_bf16_f32 v138, v76, v77
v_mfma_f32_32x32x16_bf16 v[112:127], a[144:147], v[4:7], v[112:127]
ds_read_b64_tr_b16 a[178:179], v34 offset:21504
v_exp_f32 v89, v89
v_add_f32 v179, v179, v88
s_waitcnt lgkmcnt(12)
v_mfma_f32_32x32x16_bf16 v[96:111], a[148:151], v[8:11], v[96:111]
ds_read_b64_tr_b16 a[180:181], v35 offset:20480
v_exp_f32 v90, v90
v_add_f32 v178, v178, v89
v_cvt_pk_bf16_f32 v139, v78, v79
v_mfma_f32_32x32x16_bf16 v[112:127], a[148:151], v[12:15], v[112:127]
ds_read_b64_tr_b16 a[182:183], v35 offset:21504
v_exp_f32 v91, v91
v_add_f32 v179, v179, v90
s_waitcnt lgkmcnt(13)
v_mfma_f32_32x32x16_bf16 v[96:111], a[152:155], v[16:19], v[96:111]
ds_read_b64_tr_b16 a[184:185], v36 offset:20480
v_exp_f32 v92, v92
v_add_f32 v178, v178, v91
v_cvt_pk_bf16_f32 v140, v88, v89
v_mfma_f32_32x32x16_bf16 v[112:127], a[152:155], v[20:23], v[112:127]
ds_read_b64_tr_b16 a[186:187], v36 offset:21504
v_exp_f32 v93, v93
v_add_f32 v179, v179, v92
s_waitcnt lgkmcnt(14)
v_mfma_f32_32x32x16_bf16 v[96:111], a[156:159], v[24:27], v[96:111]
ds_read_b64_tr_b16 a[188:189], v37 offset:20480
v_exp_f32 v94, v94
v_add_f32 v178, v178, v93
v_cvt_pk_bf16_f32 v141, v90, v91
v_mfma_f32_32x32x16_bf16 v[112:127], a[156:159], v[28:31], v[112:127]
ds_read_b64_tr_b16 a[190:191], v37 offset:21504
v_exp_f32 v95, v95
v_add_f32 v179, v179, v94
v_add_f32 v178, v178, v95
v_cvt_pk_bf16_f32 v142, v92, v93
v_cvt_pk_bf16_f32 v143, v94, v95
s_waitcnt lgkmcnt(14)
v_mfma_f32_32x32x16_bf16 a[0:15], a[160:163], v[128:131], a[0:15]
s_waitcnt vmcnt(4)
s_barrier
v_exp_f32 v96, v96
s_waitcnt lgkmcnt(12)
v_mfma_f32_32x32x16_bf16 a[32:47], a[164:167], v[128:131], a[32:47]
ds_read_b128 a[128:131], v32
v_exp_f32 v97, v97
v_add_f32 v177, v177, v96
s_waitcnt lgkmcnt(11)
v_mfma_f32_32x32x16_bf16 a[64:79], a[168:171], v[128:131], a[64:79]
ds_read_b128 a[132:135], v33
buffer_load_dword v52, v53, s[68:71], 0 offen sc1
v_exp_f32 v98, v98
v_add_f32 v176, v176, v97
s_waitcnt lgkmcnt(10)
v_mfma_f32_32x32x16_bf16 a[96:111], a[172:175], v[128:131], a[96:111]
ds_read_b128 a[136:139], v32 offset:64
buffer_load_dword v54, v55, s[40:43], 0 offen sc1
v_exp_f32 v99, v99
v_add_f32 v177, v177, v98
v_mfma_f32_32x32x16_bf16 a[16:31], a[160:163], v[132:135], a[16:31]
ds_read_b128 a[140:143], v33 offset:64
v_exp_f32 v100, v100
v_add_f32 v176, v176, v99
v_cvt_pk_bf16_f32 v128, v96, v97
v_mfma_f32_32x32x16_bf16 a[48:63], a[164:167], v[132:135], a[48:63]
ds_read_b128 a[144:147], v32 offset:128
v_exp_f32 v101, v101
v_add_f32 v177, v177, v100
v_mfma_f32_32x32x16_bf16 a[80:95], a[168:171], v[132:135], a[80:95]
ds_read_b128 a[148:151], v33 offset:128
v_exp_f32 v102, v102
v_add_f32 v176, v176, v101
v_cvt_pk_bf16_f32 v129, v98, v99
v_mfma_f32_32x32x16_bf16 a[112:127], a[172:175], v[132:135], a[112:127]
ds_read_b128 a[152:155], v32 offset:192
v_exp_f32 v103, v103
v_add_f32 v177, v177, v102
s_waitcnt lgkmcnt(13)
v_mfma_f32_32x32x16_bf16 a[0:15], a[176:179], v[136:139], a[0:15]
ds_read_b128 a[156:159], v33 offset:192
v_exp_f32 v112, v112
v_add_f32 v176, v176, v103
v_cvt_pk_bf16_f32 v130, v100, v101
s_waitcnt lgkmcnt(12)
v_mfma_f32_32x32x16_bf16 a[32:47], a[180:183], v[136:139], a[32:47]
v_exp_f32 v113, v113
v_add_f32 v179, v179, v112
s_add_u32 m0, s52, 0x4400
s_mov_b32 s50, 0x1c000
s_waitcnt lgkmcnt(10)
v_mfma_f32_32x32x16_bf16 a[64:79], a[184:187], v[136:139], a[64:79]
buffer_load_dwordx4 v38, s[32:35], s50 offen lds
v_exp_f32 v114, v114
v_add_f32 v178, v178, v113
v_cvt_pk_bf16_f32 v131, v102, v103
s_waitcnt lgkmcnt(8)
v_mfma_f32_32x32x16_bf16 a[96:111], a[188:191], v[136:139], a[96:111]
buffer_load_dwordx4 v39, s[32:35], s50 offen offset:1088 lds
v_exp_f32 v115, v115
v_add_f32 v179, v179, v114
v_mfma_f32_32x32x16_bf16 a[16:31], a[176:179], v[140:143], a[16:31]
v_exp_f32 v116, v116
v_add_f32 v178, v178, v115
v_cvt_pk_bf16_f32 v132, v112, v113
v_mfma_f32_32x32x16_bf16 a[48:63], a[180:183], v[140:143], a[48:63]
v_exp_f32 v117, v117
v_add_f32 v179, v179, v116
s_add_u32 m0, s53, 0x2000
s_mov_b32 s51, 0x1a000
v_mfma_f32_32x32x16_bf16 a[80:95], a[184:187], v[140:143], a[80:95]
buffer_load_dwordx4 v40, s[36:39], s51 offen lds
v_exp_f32 v118, v118
v_add_f32 v178, v178, v117
v_cvt_pk_bf16_f32 v133, v114, v115
v_mfma_f32_32x32x16_bf16 a[112:127], a[188:191], v[140:143], a[112:127]
buffer_load_dwordx4 v40, s[36:39], s51 offen offset:1024 lds
v_exp_f32 v119, v119
v_add_f32 v179, v179, v118
s_waitcnt lgkmcnt(7)
v_mfma_f32_32x32x16_bf16 v[64:79], a[128:131], v[192:195], v[144:159]
ds_read_b64_tr_b16 a[160:161], v34 offset:24576
v_exp_f32 v104, v104
v_add_f32 v178, v178, v119
v_cvt_pk_bf16_f32 v134, v116, v117
v_mfma_f32_32x32x16_bf16 v[80:95], a[128:131], v[196:199], v[160:175]
ds_read_b64_tr_b16 a[162:163], v34 offset:25600
v_exp_f32 v105, v105
v_add_f32 v177, v177, v104
s_waitcnt lgkmcnt(8)
v_mfma_f32_32x32x16_bf16 v[64:79], a[132:135], v[200:203], v[64:79]
ds_read_b64_tr_b16 a[164:165], v35 offset:24576
v_exp_f32 v106, v106
v_add_f32 v176, v176, v105
v_cvt_pk_bf16_f32 v135, v118, v119
v_mfma_f32_32x32x16_bf16 v[80:95], a[132:135], v[204:207], v[80:95]
ds_read_b64_tr_b16 a[166:167], v35 offset:25600
v_exp_f32 v107, v107
v_add_f32 v177, v177, v106
s_waitcnt lgkmcnt(9)
v_mfma_f32_32x32x16_bf16 v[64:79], a[136:139], v[208:211], v[64:79]
ds_read_b64_tr_b16 a[168:169], v36 offset:24576
v_exp_f32 v108, v108
v_add_f32 v176, v176, v107
v_cvt_pk_bf16_f32 v136, v104, v105
v_mfma_f32_32x32x16_bf16 v[80:95], a[136:139], v[212:215], v[80:95]
ds_read_b64_tr_b16 a[170:171], v36 offset:25600
v_exp_f32 v109, v109
v_add_f32 v177, v177, v108
s_waitcnt lgkmcnt(10)
v_mfma_f32_32x32x16_bf16 v[64:79], a[140:143], v[216:219], v[64:79]
ds_read_b64_tr_b16 a[172:173], v37 offset:24576
v_exp_f32 v110, v110
v_add_f32 v176, v176, v109
v_cvt_pk_bf16_f32 v137, v106, v107
v_mfma_f32_32x32x16_bf16 v[80:95], a[140:143], v[220:223], v[80:95]
ds_read_b64_tr_b16 a[174:175], v37 offset:25600
v_exp_f32 v111, v111
v_add_f32 v177, v177, v110
s_waitcnt lgkmcnt(11)
v_mfma_f32_32x32x16_bf16 v[64:79], a[144:147], v[0:3], v[64:79]
ds_read_b64_tr_b16 a[176:177], v34 offset:28672
v_exp_f32 v120, v120
v_add_f32 v176, v176, v111
v_cvt_pk_bf16_f32 v138, v108, v109
v_mfma_f32_32x32x16_bf16 v[80:95], a[144:147], v[4:7], v[80:95]
ds_read_b64_tr_b16 a[178:179], v34 offset:29696
v_exp_f32 v121, v121
v_add_f32 v179, v179, v120
s_waitcnt lgkmcnt(12)
v_mfma_f32_32x32x16_bf16 v[64:79], a[148:151], v[8:11], v[64:79]
ds_read_b64_tr_b16 a[180:181], v35 offset:28672
v_exp_f32 v122, v122
v_add_f32 v178, v178, v121
v_cvt_pk_bf16_f32 v139, v110, v111
v_mfma_f32_32x32x16_bf16 v[80:95], a[148:151], v[12:15], v[80:95]
ds_read_b64_tr_b16 a[182:183], v35 offset:29696
v_exp_f32 v123, v123
v_add_f32 v179, v179, v122
s_waitcnt lgkmcnt(13)
v_mfma_f32_32x32x16_bf16 v[64:79], a[152:155], v[16:19], v[64:79]
ds_read_b64_tr_b16 a[184:185], v36 offset:28672
v_exp_f32 v124, v124
v_add_f32 v178, v178, v123
v_cvt_pk_bf16_f32 v140, v120, v121
v_mfma_f32_32x32x16_bf16 v[80:95], a[152:155], v[20:23], v[80:95]
ds_read_b64_tr_b16 a[186:187], v36 offset:29696
v_exp_f32 v125, v125
v_add_f32 v179, v179, v124
s_waitcnt lgkmcnt(14)
v_mfma_f32_32x32x16_bf16 v[64:79], a[156:159], v[24:27], v[64:79]
ds_read_b64_tr_b16 a[188:189], v37 offset:28672
v_exp_f32 v126, v126
v_add_f32 v178, v178, v125
v_cvt_pk_bf16_f32 v141, v122, v123
v_mfma_f32_32x32x16_bf16 v[80:95], a[156:159], v[28:31], v[80:95]
ds_read_b64_tr_b16 a[190:191], v37 offset:29696
v_exp_f32 v127, v127
v_add_f32 v179, v179, v126
v_add_f32 v178, v178, v127
v_cvt_pk_bf16_f32 v142, v124, v125
v_cvt_pk_bf16_f32 v143, v126, v127
s_mov_b32 s6, 0
L_start_chk:
s_waitcnt vmcnt(5)
v_cmp_le_u32 vcc, 8, v52
s_add_u32 s6, s6, 1
s_cmp_eq_u64 vcc, -1
s_cbranch_scc1 L_start_ok
s_cmp_gt_u32 s6, 0x61a80
s_cbranch_scc1 L_start_ok
s_sleep 1
buffer_load_dword v52, v53, s[68:71], 0 offen sc1
s_waitcnt vmcnt(0)
s_branch L_start_chk
L_start_ok:
L_bflag_chk:
s_waitcnt vmcnt(4)
v_or_b32 v54, v54, v61
v_cmp_eq_u32 vcc, 1, v54
s_add_u32 s6, s6, 1
s_cmp_eq_u64 vcc, -1
s_cbranch_scc1 L_bflag_ok
s_cmp_gt_u32 s6, 0x61a80
s_cbranch_scc1 L_bflag_ok
s_sleep 1
buffer_load_dword v54, v55, s[40:43], 0 offen sc1
s_waitcnt vmcnt(0)
s_branch L_bflag_chk
L_bflag_ok:
s_waitcnt lgkmcnt(14)
v_mfma_f32_32x32x16_bf16 a[0:15], a[160:163], v[128:131], a[0:15]
s_barrier
v_exp_f32 v64, v64
s_waitcnt lgkmcnt(12)
v_mfma_f32_32x32x16_bf16 a[32:47], a[164:167], v[128:131], a[32:47]
ds_read_b128 a[128:131], v32 offset:8704
v_exp_f32 v65, v65
v_add_f32 v177, v177, v64
s_waitcnt lgkmcnt(11)
v_mfma_f32_32x32x16_bf16 a[64:79], a[168:171], v[128:131], a[64:79]
ds_read_b128 a[132:135], v33 offset:8704
v_exp_f32 v66, v66
v_add_f32 v176, v176, v65
s_waitcnt lgkmcnt(10)
v_mfma_f32_32x32x16_bf16 a[96:111], a[172:175], v[128:131], a[96:111]
ds_read_b128 a[136:139], v32 offset:8768
v_exp_f32 v67, v67
v_add_f32 v177, v177, v66
v_mfma_f32_32x32x16_bf16 a[16:31], a[160:163], v[132:135], a[16:31]
ds_read_b128 a[140:143], v33 offset:8768
v_exp_f32 v68, v68
v_add_f32 v176, v176, v67
v_cvt_pk_bf16_f32 v128, v64, v65
v_mfma_f32_32x32x16_bf16 a[48:63], a[164:167], v[132:135], a[48:63]
ds_read_b128 a[144:147], v32 offset:8832
v_exp_f32 v69, v69
v_add_f32 v177, v177, v68
v_mfma_f32_32x32x16_bf16 a[80:95], a[168:171], v[132:135], a[80:95]
ds_read_b128 a[148:151], v33 offset:8832
v_exp_f32 v70, v70
v_add_f32 v176, v176, v69
v_cvt_pk_bf16_f32 v129, v66, v67
v_mfma_f32_32x32x16_bf16 a[112:127], a[172:175], v[132:135], a[112:127]
ds_read_b128 a[152:155], v32 offset:8896
v_exp_f32 v71, v71
v_add_f32 v177, v177, v70
s_waitcnt lgkmcnt(13)
v_mfma_f32_32x32x16_bf16 a[0:15], a[176:179], v[136:139], a[0:15]
ds_read_b128 a[156:159], v33 offset:8896
v_exp_f32 v80, v80
v_add_f32 v176, v176, v71
v_cvt_pk_bf16_f32 v130, v68, v69
s_waitcnt lgkmcnt(12)
v_mfma_f32_32x32x16_bf16 a[32:47], a[180:183], v[136:139], a[32:47]
v_exp_f32 v81, v81
v_add_f32 v179, v179, v80
s_add_u32 m0, s52, 0
s_mov_b32 s50, 0x1e000
s_waitcnt lgkmcnt(10)
v_mfma_f32_32x32x16_bf16 a[64:79], a[184:187], v[136:139], a[64:79]
buffer_load_dwordx4 v38, s[32:35], s50 offen lds
v_exp_f32 v82, v82
v_add_f32 v178, v178, v81
v_cvt_pk_bf16_f32 v131, v70, v71
s_waitcnt lgkmcnt(8)
v_mfma_f32_32x32x16_bf16 a[96:111], a[188:191], v[136:139], a[96:111]
buffer_load_dwordx4 v39, s[32:35], s50 offen offset:1088 lds
v_exp_f32 v83, v83
v_add_f32 v179, v179, v82
v_mfma_f32_32x32x16_bf16 a[16:31], a[176:179], v[140:143], a[16:31]
v_exp_f32 v84, v84
v_add_f32 v178, v178, v83
v_cvt_pk_bf16_f32 v132, v80, v81
v_mfma_f32_32x32x16_bf16 a[48:63], a[180:183], v[140:143], a[48:63]
v_exp_f32 v85, v85
v_add_f32 v179, v179, v84
s_add_u32 m0, s53, 0x4000
s_mov_b32 s51, 0x1c000
v_mfma_f32_32x32x16_bf16 a[80:95], a[184:187], v[140:143], a[80:95]
buffer_load_dwordx4 v40, s[36:39], s51 offen lds
v_exp_f32 v86, v86
v_add_f32 v178, v178, v85
v_cvt_pk_bf16_f32 v133, v82, v83
v_mfma_f32_32x32x16_bf16 a[112:127], a[188:191], v[140:143], a[112:127]
buffer_load_dwordx4 v40, s[36:39], s51 offen offset:1024 lds
v_exp_f32 v87, v87
v_add_f32 v179, v179, v86
s_waitcnt lgkmcnt(7)
v_mfma_f32_32x32x16_bf16 v[96:111], a[128:131], v[192:195], v[144:159]
ds_read_b64_tr_b16 a[160:161], v34
v_exp_f32 v72, v72
v_add_f32 v178, v178, v87
v_cvt_pk_bf16_f32 v134, v84, v85
v_mfma_f32_32x32x16_bf16 v[112:127], a[128:131], v[196:199], v[160:175]
ds_read_b64_tr_b16 a[162:163], v34 offset:1024
v_exp_f32 v73, v73
v_add_f32 v177, v177, v72
s_add_u32 s62, s97, 0
s_waitcnt lgkmcnt(8)
v_mfma_f32_32x32x16_bf16 v[96:111], a[132:135], v[200:203], v[96:111]
ds_read_b64_tr_b16 a[164:165], v35
buffer_load_dwordx4 a[192:195], v248, s[40:43], s62 offen sc1
v_exp_f32 v74, v74
v_add_f32 v176, v176, v73
v_cvt_pk_bf16_f32 v135, v86, v87
v_mfma_f32_32x32x16_bf16 v[112:127], a[132:135], v[204:207], v[112:127]
ds_read_b64_tr_b16 a[166:167], v35 offset:1024
v_exp_f32 v75, v75
v_add_f32 v177, v177, v74
s_waitcnt lgkmcnt(9)
v_mfma_f32_32x32x16_bf16 v[96:111], a[136:139], v[208:211], v[96:111]
ds_read_b64_tr_b16 a[168:169], v36
v_exp_f32 v76, v76
v_add_f32 v176, v176, v75
v_cvt_pk_bf16_f32 v136, v72, v73
s_add_u32 s62, s97, 0x10000
v_mfma_f32_32x32x16_bf16 v[112:127], a[136:139], v[212:215], v[112:127]
ds_read_b64_tr_b16 a[170:171], v36 offset:1024
buffer_load_dwordx4 a[196:199], v248, s[40:43], s62 offen sc1
v_exp_f32 v77, v77
v_add_f32 v177, v177, v76
s_waitcnt lgkmcnt(10)
v_mfma_f32_32x32x16_bf16 v[96:111], a[140:143], v[216:219], v[96:111]
ds_read_b64_tr_b16 a[172:173], v37
v_exp_f32 v78, v78
v_add_f32 v176, v176, v77
v_cvt_pk_bf16_f32 v137, v74, v75
v_mfma_f32_32x32x16_bf16 v[112:127], a[140:143], v[220:223], v[112:127]
ds_read_b64_tr_b16 a[174:175], v37 offset:1024
v_exp_f32 v79, v79
v_add_f32 v177, v177, v78
s_add_u32 s62, s97, 0x20000
s_waitcnt lgkmcnt(11)
v_mfma_f32_32x32x16_bf16 v[96:111], a[144:147], v[0:3], v[96:111]
ds_read_b64_tr_b16 a[176:177], v34 offset:4096
buffer_load_dwordx4 a[200:203], v248, s[40:43], s62 offen sc1
v_exp_f32 v88, v88
v_add_f32 v176, v176, v79
v_cvt_pk_bf16_f32 v138, v76, v77
v_mfma_f32_32x32x16_bf16 v[112:127], a[144:147], v[4:7], v[112:127]
ds_read_b64_tr_b16 a[178:179], v34 offset:5120
v_exp_f32 v89, v89
v_add_f32 v179, v179, v88
s_waitcnt lgkmcnt(12)
v_mfma_f32_32x32x16_bf16 v[96:111], a[148:151], v[8:11], v[96:111]
ds_read_b64_tr_b16 a[180:181], v35 offset:4096
v_exp_f32 v90, v90
v_add_f32 v178, v178, v89
v_cvt_pk_bf16_f32 v139, v78, v79
s_add_u32 s62, s97, 0x30000
v_mfma_f32_32x32x16_bf16 v[112:127], a[148:151], v[12:15], v[112:127]
ds_read_b64_tr_b16 a[182:183], v35 offset:5120
buffer_load_dwordx4 a[204:207], v248, s[40:43], s62 offen sc1
v_exp_f32 v91, v91
v_add_f32 v179, v179, v90
s_waitcnt lgkmcnt(13)
v_mfma_f32_32x32x16_bf16 v[96:111], a[152:155], v[16:19], v[96:111]
ds_read_b64_tr_b16 a[184:185], v36 offset:4096
v_exp_f32 v92, v92
v_add_f32 v178, v178, v91
v_cvt_pk_bf16_f32 v140, v88, v89
v_mfma_f32_32x32x16_bf16 v[112:127], a[152:155], v[20:23], v[112:127]
ds_read_b64_tr_b16 a[186:187], v36 offset:5120
v_exp_f32 v93, v93
v_add_f32 v179, v179, v92
s_waitcnt lgkmcnt(14)
v_mfma_f32_32x32x16_bf16 v[96:111], a[156:159], v[24:27], v[96:111]
ds_read_b64_tr_b16 a[188:189], v37 offset:4096
v_exp_f32 v94, v94
v_add_f32 v178, v178, v93
v_cvt_pk_bf16_f32 v141, v90, v91
v_mfma_f32_32x32x16_bf16 v[112:127], a[156:159], v[28:31], v[112:127]
ds_read_b64_tr_b16 a[190:191], v37 offset:5120
v_exp_f32 v95, v95
v_add_f32 v179, v179, v94
v_add_f32 v178, v178, v95
v_cvt_pk_bf16_f32 v142, v92, v93
v_cvt_pk_bf16_f32 v143, v94, v95
s_waitcnt lgkmcnt(14)
v_mfma_f32_32x32x16_bf16 a[0:15], a[160:163], v[128:131], a[0:15]
s_waitcnt vmcnt(8)
s_barrier
v_exp_f32 v96, v96
s_waitcnt lgkmcnt(12)
v_mfma_f32_32x32x16_bf16 a[32:47], a[164:167], v[128:131], a[32:47]
ds_read_b128 a[128:131], v32 offset:17408
v_exp_f32 v97, v97
v_add_f32 v177, v177, v96
s_waitcnt lgkmcnt(11)
v_mfma_f32_32x32x16_bf16 a[64:79], a[168:171], v[128:131], a[64:79]
ds_read_b128 a[132:135], v33 offset:17408
v_exp_f32 v98, v98
v_add_f32 v176, v176, v97
s_waitcnt lgkmcnt(10)
v_mfma_f32_32x32x16_bf16 a[96:111], a[172:175], v[128:131], a[96:111]
ds_read_b128 a[136:139], v32 offset:17472
v_exp_f32 v99, v99
v_add_f32 v177, v177, v98
v_mfma_f32_32x32x16_bf16 a[16:31], a[160:163], v[132:135], a[16:31]
ds_read_b128 a[140:143], v33 offset:17472
v_exp_f32 v100, v100
v_add_f32 v176, v176, v99
v_cvt_pk_bf16_f32 v128, v96, v97
v_mfma_f32_32x32x16_bf16 a[48:63], a[164:167], v[132:135], a[48:63]
ds_read_b128 a[144:147], v32 offset:17536
v_exp_f32 v101, v101
v_add_f32 v177, v177, v100
v_mfma_f32_32x32x16_bf16 a[80:95], a[168:171], v[132:135], a[80:95]
ds_read_b128 a[148:151], v33 offset:17536
v_exp_f32 v102, v102
v_add_f32 v176, v176, v101
v_cvt_pk_bf16_f32 v129, v98, v99
v_mfma_f32_32x32x16_bf16 a[112:127], a[172:175], v[132:135], a[112:127]
ds_read_b128 a[152:155], v32 offset:17600
v_exp_f32 v103, v103
v_add_f32 v177, v177, v102
s_waitcnt lgkmcnt(13)
v_mfma_f32_32x32x16_bf16 a[0:15], a[176:179], v[136:139], a[0:15]
ds_read_b128 a[156:159], v33 offset:17600
v_exp_f32 v112, v112
v_add_f32 v176, v176, v103
v_cvt_pk_bf16_f32 v130, v100, v101
s_waitcnt lgkmcnt(12)
v_mfma_f32_32x32x16_bf16 a[32:47], a[180:183], v[136:139], a[32:47]
v_exp_f32 v113, v113
v_add_f32 v179, v179, v112
s_add_u32 m0, s53, 0x6000
s_mov_b32 s51, 0x1e000
s_waitcnt lgkmcnt(10)
v_mfma_f32_32x32x16_bf16 a[64:79], a[184:187], v[136:139], a[64:79]
buffer_load_dwordx4 v40, s[36:39], s51 offen lds
v_exp_f32 v114, v114
v_add_f32 v178, v178, v113
v_cvt_pk_bf16_f32 v131, v102, v103
s_waitcnt lgkmcnt(8)
v_mfma_f32_32x32x16_bf16 a[96:111], a[188:191], v[136:139], a[96:111]
buffer_load_dwordx4 v40, s[36:39], s51 offen offset:1024 lds
v_exp_f32 v115, v115
v_add_f32 v179, v179, v114
v_mfma_f32_32x32x16_bf16 a[16:31], a[176:179], v[140:143], a[16:31]
v_exp_f32 v116, v116
v_add_f32 v178, v178, v115
v_cvt_pk_bf16_f32 v132, v112, v113
v_mfma_f32_32x32x16_bf16 a[48:63], a[180:183], v[140:143], a[48:63]
v_exp_f32 v117, v117
v_add_f32 v179, v179, v116
v_mfma_f32_32x32x16_bf16 a[80:95], a[184:187], v[140:143], a[80:95]
v_exp_f32 v118, v118
v_add_f32 v178, v178, v117
v_cvt_pk_bf16_f32 v133, v114, v115
v_mfma_f32_32x32x16_bf16 a[112:127], a[188:191], v[140:143], a[112:127]
v_exp_f32 v119, v119
v_add_f32 v179, v179, v118
s_waitcnt lgkmcnt(7)
v_mfma_f32_32x32x16_bf16 v[64:79], a[128:131], v[192:195], v[144:159]
ds_read_b64_tr_b16 a[160:161], v34 offset:8192
v_exp_f32 v104, v104
v_add_f32 v178, v178, v119
v_cvt_pk_bf16_f32 v134, v116, v117
v_mfma_f32_32x32x16_bf16 v[80:95], a[128:131], v[196:199], v[160:175]
ds_read_b64_tr_b16 a[162:163], v34 offset:9216
v_exp_f32 v105, v105
v_add_f32 v177, v177, v104
s_add_u32 s62, s97, 0x40000
s_waitcnt lgkmcnt(8)
v_mfma_f32_32x32x16_bf16 v[64:79], a[132:135], v[200:203], v[64:79]
ds_read_b64_tr_b16 a[164:165], v35 offset:8192
buffer_load_dwordx4 a[208:211], v248, s[40:43], s62 offen sc1
v_exp_f32 v106, v106
v_add_f32 v176, v176, v105
v_cvt_pk_bf16_f32 v135, v118, v119
v_mfma_f32_32x32x16_bf16 v[80:95], a[132:135], v[204:207], v[80:95]
ds_read_b64_tr_b16 a[166:167], v35 offset:9216
v_exp_f32 v107, v107
v_add_f32 v177, v177, v106
s_waitcnt lgkmcnt(9)
v_mfma_f32_32x32x16_bf16 v[64:79], a[136:139], v[208:211], v[64:79]
ds_read_b64_tr_b16 a[168:169], v36 offset:8192
v_exp_f32 v108, v108
v_add_f32 v176, v176, v107
v_cvt_pk_bf16_f32 v136, v104, v105
s_add_u32 s62, s97, 0x50000
v_mfma_f32_32x32x16_bf16 v[80:95], a[136:139], v[212:215], v[80:95]
ds_read_b64_tr_b16 a[170:171], v36 offset:9216
buffer_load_dwordx4 a[212:215], v248, s[40:43], s62 offen sc1
v_exp_f32 v109, v109
v_add_f32 v177, v177, v108
s_waitcnt lgkmcnt(10)
v_mfma_f32_32x32x16_bf16 v[64:79], a[140:143], v[216:219], v[64:79]
ds_read_b64_tr_b16 a[172:173], v37 offset:8192
v_exp_f32 v110, v110
v_add_f32 v176, v176, v109
v_cvt_pk_bf16_f32 v137, v106, v107
v_mfma_f32_32x32x16_bf16 v[80:95], a[140:143], v[220:223], v[80:95]
ds_read_b64_tr_b16 a[174:175], v37 offset:9216
v_exp_f32 v111, v111
v_add_f32 v177, v177, v110
s_add_u32 s62, s97, 0x60000
s_waitcnt lgkmcnt(11)
v_mfma_f32_32x32x16_bf16 v[64:79], a[144:147], v[0:3], v[64:79]
ds_read_b64_tr_b16 a[176:177], v34 offset:12288
buffer_load_dwordx4 a[216:219], v248, s[40:43], s62 offen sc1
v_exp_f32 v120, v120
v_add_f32 v176, v176, v111
v_cvt_pk_bf16_f32 v138, v108, v109
v_mfma_f32_32x32x16_bf16 v[80:95], a[144:147], v[4:7], v[80:95]
ds_read_b64_tr_b16 a[178:179], v34 offset:13312
v_exp_f32 v121, v121
v_add_f32 v179, v179, v120
s_waitcnt lgkmcnt(12)
v_mfma_f32_32x32x16_bf16 v[64:79], a[148:151], v[8:11], v[64:79]
ds_read_b64_tr_b16 a[180:181], v35 offset:12288
v_exp_f32 v122, v122
v_add_f32 v178, v178, v121
v_cvt_pk_bf16_f32 v139, v110, v111
s_add_u32 s62, s97, 0x70000
v_mfma_f32_32x32x16_bf16 v[80:95], a[148:151], v[12:15], v[80:95]
ds_read_b64_tr_b16 a[182:183], v35 offset:13312
buffer_load_dwordx4 a[220:223], v248, s[40:43], s62 offen sc1
v_exp_f32 v123, v123
v_add_f32 v179, v179, v122
s_waitcnt lgkmcnt(13)
v_mfma_f32_32x32x16_bf16 v[64:79], a[152:155], v[16:19], v[64:79]
ds_read_b64_tr_b16 a[184:185], v36 offset:12288
v_exp_f32 v124, v124
v_add_f32 v178, v178, v123
v_cvt_pk_bf16_f32 v140, v120, v121
v_mfma_f32_32x32x16_bf16 v[80:95], a[152:155], v[20:23], v[80:95]
ds_read_b64_tr_b16 a[186:187], v36 offset:13312
v_exp_f32 v125, v125
v_add_f32 v179, v179, v124
s_waitcnt lgkmcnt(14)
v_mfma_f32_32x32x16_bf16 v[64:79], a[156:159], v[24:27], v[64:79]
ds_read_b64_tr_b16 a[188:189], v37 offset:12288
v_exp_f32 v126, v126
v_add_f32 v178, v178, v125
v_cvt_pk_bf16_f32 v141, v122, v123
v_mfma_f32_32x32x16_bf16 v[80:95], a[156:159], v[28:31], v[80:95]
ds_read_b64_tr_b16 a[190:191], v37 offset:13312
v_exp_f32 v127, v127
v_add_f32 v179, v179, v126
v_add_f32 v178, v178, v127
v_cvt_pk_bf16_f32 v142, v124, v125
v_cvt_pk_bf16_f32 v143, v126, v127
s_waitcnt lgkmcnt(14)
v_mfma_f32_32x32x16_bf16 a[0:15], a[160:163], v[128:131], a[0:15]
s_waitcnt vmcnt(10)
s_barrier
v_exp_f32 v64, v64
s_waitcnt lgkmcnt(12)
v_mfma_f32_32x32x16_bf16 a[32:47], a[164:167], v[128:131], a[32:47]
ds_read_b128 a[128:131], v32
v_exp_f32 v65, v65
v_add_f32 v177, v177, v64
s_waitcnt lgkmcnt(11)
v_mfma_f32_32x32x16_bf16 a[64:79], a[168:171], v[128:131], a[64:79]
ds_read_b128 a[132:135], v33
v_exp_f32 v66, v66
v_add_f32 v176, v176, v65
s_waitcnt lgkmcnt(10)
v_mfma_f32_32x32x16_bf16 a[96:111], a[172:175], v[128:131], a[96:111]
ds_read_b128 a[136:139], v32 offset:64
v_exp_f32 v67, v67
v_add_f32 v177, v177, v66
v_mfma_f32_32x32x16_bf16 a[16:31], a[160:163], v[132:135], a[16:31]
ds_read_b128 a[140:143], v33 offset:64
v_exp_f32 v68, v68
v_add_f32 v176, v176, v67
v_cvt_pk_bf16_f32 v128, v64, v65
v_mfma_f32_32x32x16_bf16 a[48:63], a[164:167], v[132:135], a[48:63]
ds_read_b128 a[144:147], v32 offset:128
v_exp_f32 v69, v69
v_add_f32 v177, v177, v68
v_mfma_f32_32x32x16_bf16 a[80:95], a[168:171], v[132:135], a[80:95]
ds_read_b128 a[148:151], v33 offset:128
v_exp_f32 v70, v70
v_add_f32 v176, v176, v69
v_cvt_pk_bf16_f32 v129, v66, v67
v_mfma_f32_32x32x16_bf16 a[112:127], a[172:175], v[132:135], a[112:127]
ds_read_b128 a[152:155], v32 offset:192
v_exp_f32 v71, v71
v_add_f32 v177, v177, v70
s_waitcnt lgkmcnt(13)
v_mfma_f32_32x32x16_bf16 a[0:15], a[176:179], v[136:139], a[0:15]
ds_read_b128 a[156:159], v33 offset:192
v_exp_f32 v80, v80
v_add_f32 v176, v176, v71
v_cvt_pk_bf16_f32 v130, v68, v69
s_waitcnt lgkmcnt(12)
v_mfma_f32_32x32x16_bf16 a[32:47], a[180:183], v[136:139], a[32:47]
v_exp_f32 v81, v81
v_add_f32 v179, v179, v80
s_waitcnt lgkmcnt(10)
v_mfma_f32_32x32x16_bf16 a[64:79], a[184:187], v[136:139], a[64:79]
v_exp_f32 v82, v82
v_add_f32 v178, v178, v81
v_cvt_pk_bf16_f32 v131, v70, v71
s_waitcnt lgkmcnt(8)
v_mfma_f32_32x32x16_bf16 a[96:111], a[188:191], v[136:139], a[96:111]
v_exp_f32 v83, v83
v_add_f32 v179, v179, v82
v_mfma_f32_32x32x16_bf16 a[16:31], a[176:179], v[140:143], a[16:31]
v_exp_f32 v84, v84
v_add_f32 v178, v178, v83
v_cvt_pk_bf16_f32 v132, v80, v81
v_mfma_f32_32x32x16_bf16 a[48:63], a[180:183], v[140:143], a[48:63]
v_exp_f32 v85, v85
v_add_f32 v179, v179, v84
v_mfma_f32_32x32x16_bf16 a[80:95], a[184:187], v[140:143], a[80:95]
v_exp_f32 v86, v86
v_add_f32 v178, v178, v85
v_cvt_pk_bf16_f32 v133, v82, v83
v_mfma_f32_32x32x16_bf16 a[112:127], a[188:191], v[140:143], a[112:127]
v_exp_f32 v87, v87
v_add_f32 v179, v179, v86
s_waitcnt lgkmcnt(7)
v_mfma_f32_32x32x16_bf16 v[96:111], a[128:131], v[192:195], v[144:159]
ds_read_b64_tr_b16 a[160:161], v34 offset:16384
v_exp_f32 v72, v72
v_add_f32 v178, v178, v87
v_cvt_pk_bf16_f32 v134, v84, v85
v_mfma_f32_32x32x16_bf16 v[112:127], a[128:131], v[196:199], v[160:175]
ds_read_b64_tr_b16 a[162:163], v34 offset:17408
v_exp_f32 v73, v73
v_add_f32 v177, v177, v72
s_add_u32 s62, s97, 0x2000
s_waitcnt lgkmcnt(8)
v_mfma_f32_32x32x16_bf16 v[96:111], a[132:135], v[200:203], v[96:111]
ds_read_b64_tr_b16 a[164:165], v35 offset:16384
buffer_load_dwordx4 a[224:227], v248, s[40:43], s62 offen sc1
v_exp_f32 v74, v74
v_add_f32 v176, v176, v73
v_cvt_pk_bf16_f32 v135, v86, v87
v_mfma_f32_32x32x16_bf16 v[112:127], a[132:135], v[204:207], v[112:127]
ds_read_b64_tr_b16 a[166:167], v35 offset:17408
v_exp_f32 v75, v75
v_add_f32 v177, v177, v74
s_waitcnt lgkmcnt(9)
v_mfma_f32_32x32x16_bf16 v[96:111], a[136:139], v[208:211], v[96:111]
ds_read_b64_tr_b16 a[168:169], v36 offset:16384
v_exp_f32 v76, v76
v_add_f32 v176, v176, v75
v_cvt_pk_bf16_f32 v136, v72, v73
s_add_u32 s62, s97, 0x12000
v_mfma_f32_32x32x16_bf16 v[112:127], a[136:139], v[212:215], v[112:127]
ds_read_b64_tr_b16 a[170:171], v36 offset:17408
buffer_load_dwordx4 a[228:231], v248, s[40:43], s62 offen sc1
v_exp_f32 v77, v77
v_add_f32 v177, v177, v76
s_waitcnt lgkmcnt(10)
v_mfma_f32_32x32x16_bf16 v[96:111], a[140:143], v[216:219], v[96:111]
ds_read_b64_tr_b16 a[172:173], v37 offset:16384
v_exp_f32 v78, v78
v_add_f32 v176, v176, v77
v_cvt_pk_bf16_f32 v137, v74, v75
v_mfma_f32_32x32x16_bf16 v[112:127], a[140:143], v[220:223], v[112:127]
ds_read_b64_tr_b16 a[174:175], v37 offset:17408
v_exp_f32 v79, v79
v_add_f32 v177, v177, v78
s_add_u32 s62, s97, 0x22000
s_waitcnt lgkmcnt(11)
v_mfma_f32_32x32x16_bf16 v[96:111], a[144:147], v[0:3], v[96:111]
ds_read_b64_tr_b16 a[176:177], v34 offset:20480
buffer_load_dwordx4 a[232:235], v248, s[40:43], s62 offen sc1
v_exp_f32 v88, v88
v_add_f32 v176, v176, v79
v_cvt_pk_bf16_f32 v138, v76, v77
v_mfma_f32_32x32x16_bf16 v[112:127], a[144:147], v[4:7], v[112:127]
ds_read_b64_tr_b16 a[178:179], v34 offset:21504
v_exp_f32 v89, v89
v_add_f32 v179, v179, v88
s_waitcnt lgkmcnt(12)
v_mfma_f32_32x32x16_bf16 v[96:111], a[148:151], v[8:11], v[96:111]
ds_read_b64_tr_b16 a[180:181], v35 offset:20480
v_exp_f32 v90, v90
v_add_f32 v178, v178, v89
v_cvt_pk_bf16_f32 v139, v78, v79
s_add_u32 s62, s97, 0x32000
v_mfma_f32_32x32x16_bf16 v[112:127], a[148:151], v[12:15], v[112:127]
ds_read_b64_tr_b16 a[182:183], v35 offset:21504
buffer_load_dwordx4 a[236:239], v248, s[40:43], s62 offen sc1
v_exp_f32 v91, v91
v_add_f32 v179, v179, v90
s_waitcnt lgkmcnt(13)
v_mfma_f32_32x32x16_bf16 v[96:111], a[152:155], v[16:19], v[96:111]
ds_read_b64_tr_b16 a[184:185], v36 offset:20480
v_exp_f32 v92, v92
v_add_f32 v178, v178, v91
v_cvt_pk_bf16_f32 v140, v88, v89
v_mfma_f32_32x32x16_bf16 v[112:127], a[152:155], v[20:23], v[112:127]
ds_read_b64_tr_b16 a[186:187], v36 offset:21504
v_exp_f32 v93, v93
v_add_f32 v179, v179, v92
s_waitcnt lgkmcnt(14)
v_mfma_f32_32x32x16_bf16 v[96:111], a[156:159], v[24:27], v[96:111]
ds_read_b64_tr_b16 a[188:189], v37 offset:20480
v_exp_f32 v94, v94
v_add_f32 v178, v178, v93
v_cvt_pk_bf16_f32 v141, v90, v91
v_mfma_f32_32x32x16_bf16 v[112:127], a[156:159], v[28:31], v[112:127]
ds_read_b64_tr_b16 a[190:191], v37 offset:21504
v_exp_f32 v95, v95
v_add_f32 v179, v179, v94
v_add_f32 v178, v178, v95
v_cvt_pk_bf16_f32 v142, v92, v93
v_cvt_pk_bf16_f32 v143, v94, v95
s_waitcnt lgkmcnt(14)
v_mfma_f32_32x32x16_bf16 a[0:15], a[160:163], v[128:131], a[0:15]
s_waitcnt vmcnt(8)
s_barrier
v_exp_f32 v96, v96
v_exp_f32 v97, v97
v_add_f32 v177, v177, v96
s_waitcnt lgkmcnt(12)
v_mfma_f32_32x32x16_bf16 a[32:47], a[164:167], v[128:131], a[32:47]
s_add_u32 s62, s97, 0x42000
v_exp_f32 v98, v98
v_add_f32 v176, v176, v97
s_waitcnt lgkmcnt(10)
v_mfma_f32_32x32x16_bf16 a[64:79], a[168:171], v[128:131], a[64:79]
buffer_load_dwordx4 a[240:243], v248, s[40:43], s62 offen sc1
v_exp_f32 v99, v99
v_add_f32 v177, v177, v98
s_waitcnt lgkmcnt(8)
v_mfma_f32_32x32x16_bf16 a[96:111], a[172:175], v[128:131], a[96:111]
s_add_u32 s62, s97, 0x52000
v_exp_f32 v100, v100
v_add_f32 v176, v176, v99
v_cvt_pk_bf16_f32 v128, v96, v97
v_mfma_f32_32x32x16_bf16 a[16:31], a[160:163], v[132:135], a[16:31]
buffer_load_dwordx4 a[244:247], v248, s[40:43], s62 offen sc1
ds_read_b64_tr_b16 a[160:161], v34 offset:24576
ds_read_b64_tr_b16 a[162:163], v34 offset:25600
v_exp_f32 v101, v101
v_add_f32 v177, v177, v100
v_exp_f32 v102, v102
v_add_f32 v176, v176, v101
v_cvt_pk_bf16_f32 v129, v98, v99
v_mfma_f32_32x32x16_bf16 a[48:63], a[164:167], v[132:135], a[48:63]
ds_read_b64_tr_b16 a[164:165], v35 offset:24576
ds_read_b64_tr_b16 a[166:167], v35 offset:25600
s_add_u32 s62, s97, 0x62000
v_exp_f32 v103, v103
v_add_f32 v177, v177, v102
v_mfma_f32_32x32x16_bf16 a[80:95], a[168:171], v[132:135], a[80:95]
buffer_load_dwordx4 a[248:251], v248, s[40:43], s62 offen sc1
ds_read_b64_tr_b16 a[168:169], v36 offset:24576
ds_read_b64_tr_b16 a[170:171], v36 offset:25600
v_exp_f32 v112, v112
v_add_f32 v176, v176, v103
v_cvt_pk_bf16_f32 v130, v100, v101
v_mfma_f32_32x32x16_bf16 a[112:127], a[172:175], v[132:135], a[112:127]
ds_read_b64_tr_b16 a[172:173], v37 offset:24576
ds_read_b64_tr_b16 a[174:175], v37 offset:25600
s_add_u32 s62, s97, 0x72000
v_exp_f32 v113, v113
v_add_f32 v179, v179, v112
s_waitcnt lgkmcnt(14)
v_mfma_f32_32x32x16_bf16 a[0:15], a[176:179], v[136:139], a[0:15]
buffer_load_dwordx4 a[252:255], v248, s[40:43], s62 offen sc1
v_exp_f32 v114, v114
v_add_f32 v178, v178, v113
v_cvt_pk_bf16_f32 v131, v102, v103
v_exp_f32 v115, v115
v_add_f32 v179, v179, v114
s_waitcnt lgkmcnt(12)
v_mfma_f32_32x32x16_bf16 a[32:47], a[180:183], v[136:139], a[32:47]
v_exp_f32 v116, v116
v_add_f32 v178, v178, v115
v_cvt_pk_bf16_f32 v132, v112, v113
s_waitcnt lgkmcnt(10)
v_mfma_f32_32x32x16_bf16 a[64:79], a[184:187], v[136:139], a[64:79]
v_exp_f32 v117, v117
v_add_f32 v179, v179, v116
s_waitcnt lgkmcnt(8)
v_mfma_f32_32x32x16_bf16 a[96:111], a[188:191], v[136:139], a[96:111]
v_exp_f32 v118, v118
v_add_f32 v178, v178, v117
v_cvt_pk_bf16_f32 v133, v114, v115
v_mfma_f32_32x32x16_bf16 a[16:31], a[176:179], v[140:143], a[16:31]
ds_read_b64_tr_b16 a[176:177], v34 offset:28672
ds_read_b64_tr_b16 a[178:179], v34 offset:29696
v_exp_f32 v119, v119
v_add_f32 v179, v179, v118
v_exp_f32 v104, v104
v_add_f32 v178, v178, v119
v_cvt_pk_bf16_f32 v134, v116, v117
v_mfma_f32_32x32x16_bf16 a[48:63], a[180:183], v[140:143], a[48:63]
ds_read_b64_tr_b16 a[180:181], v35 offset:28672
ds_read_b64_tr_b16 a[182:183], v35 offset:29696
v_exp_f32 v105, v105
v_add_f32 v177, v177, v104
v_mfma_f32_32x32x16_bf16 a[80:95], a[184:187], v[140:143], a[80:95]
ds_read_b64_tr_b16 a[184:185], v36 offset:28672
ds_read_b64_tr_b16 a[186:187], v36 offset:29696
v_exp_f32 v106, v106
v_add_f32 v176, v176, v105
v_cvt_pk_bf16_f32 v135, v118, v119
v_mfma_f32_32x32x16_bf16 a[112:127], a[188:191], v[140:143], a[112:127]
ds_read_b64_tr_b16 a[188:189], v37 offset:28672
ds_read_b64_tr_b16 a[190:191], v37 offset:29696
v_exp_f32 v107, v107
v_add_f32 v177, v177, v106
s_waitcnt lgkmcnt(14)
v_mfma_f32_32x32x16_bf16 a[0:15], a[160:163], v[128:131], a[0:15]
v_exp_f32 v108, v108
v_add_f32 v176, v176, v107
v_cvt_pk_bf16_f32 v136, v104, v105
v_exp_f32 v109, v109
v_add_f32 v177, v177, v108
s_waitcnt lgkmcnt(12)
v_mfma_f32_32x32x16_bf16 a[32:47], a[164:167], v[128:131], a[32:47]
v_exp_f32 v110, v110
v_add_f32 v176, v176, v109
v_cvt_pk_bf16_f32 v137, v106, v107
s_waitcnt lgkmcnt(10)
v_mfma_f32_32x32x16_bf16 a[64:79], a[168:171], v[128:131], a[64:79]
v_exp_f32 v111, v111
v_add_f32 v177, v177, v110
s_waitcnt lgkmcnt(8)
v_mfma_f32_32x32x16_bf16 a[96:111], a[172:175], v[128:131], a[96:111]
v_exp_f32 v120, v120
v_add_f32 v176, v176, v111
v_cvt_pk_bf16_f32 v138, v108, v109
v_mfma_f32_32x32x16_bf16 a[16:31], a[160:163], v[132:135], a[16:31]
v_exp_f32 v121, v121
v_add_f32 v179, v179, v120
v_exp_f32 v122, v122
v_add_f32 v178, v178, v121
v_cvt_pk_bf16_f32 v139, v110, v111
v_mfma_f32_32x32x16_bf16 a[48:63], a[164:167], v[132:135], a[48:63]
v_exp_f32 v123, v123
v_add_f32 v179, v179, v122
v_mfma_f32_32x32x16_bf16 a[80:95], a[168:171], v[132:135], a[80:95]
v_exp_f32 v124, v124
v_add_f32 v178, v178, v123
v_cvt_pk_bf16_f32 v140, v120, v121
v_mfma_f32_32x32x16_bf16 a[112:127], a[172:175], v[132:135], a[112:127]
v_exp_f32 v125, v125
v_add_f32 v179, v179, v124
s_waitcnt lgkmcnt(6)
v_mfma_f32_32x32x16_bf16 a[0:15], a[176:179], v[136:139], a[0:15]
v_exp_f32 v126, v126
v_add_f32 v178, v178, v125
v_cvt_pk_bf16_f32 v141, v122, v123
v_exp_f32 v127, v127
v_add_f32 v179, v179, v126
s_waitcnt lgkmcnt(4)
v_mfma_f32_32x32x16_bf16 a[32:47], a[180:183], v[136:139], a[32:47]
v_add_f32 v178, v178, v127
v_cvt_pk_bf16_f32 v142, v124, v125
s_waitcnt lgkmcnt(2)
v_mfma_f32_32x32x16_bf16 a[64:79], a[184:187], v[136:139], a[64:79]
v_add_f32 v180, v176, v177
v_add_f32 v181, v178, v179
v_mov_b32 v182, v180
v_mov_b32 v183, v181
s_lshl_b32 s63, s5, 2
s_add_u32 s63, s63, 0x27000
v_permlane32_swap_b32 v180, v182
v_permlane32_swap_b32 v181, v183
s_waitcnt lgkmcnt(0)
v_mfma_f32_32x32x16_bf16 a[96:111], a[188:191], v[136:139], a[96:111]
v_cvt_pk_bf16_f32 v143, v126, v127
v_mov_b32 v185, s63
v_add_f32 v180, v180, v182
v_add_f32 v181, v181, v183
v_max_f32 v182, v180, v181
v_cmp_nge_f32 vcc, s59, v182
v_rcp_f32 v254, v180
v_rcp_f32 v255, v181
v_mfma_f32_32x32x16_bf16 a[16:31], a[176:179], v[140:143], a[16:31]
s_cmp_lg_u64 vcc, 0
s_cselect_b32 s62, 1, 0
v_mov_b32 v184, s62
ds_write_b32 v185, v184
v_mfma_f32_32x32x16_bf16 a[48:63], a[180:183], v[140:143], a[48:63]
v_mov_b32 v185, 0x27000
s_waitcnt lgkmcnt(0)
s_barrier
ds_read_b128 v[186:189], v185
v_mfma_f32_32x32x16_bf16 a[80:95], a[184:187], v[140:143], a[80:95]
ds_read_b64_tr_b16 v[224:225], v246 offset:12288
ds_read_b64_tr_b16 v[226:227], v246 offset:12800
v_mfma_f32_32x32x16_bf16 a[112:127], a[188:191], v[140:143], a[112:127]
ds_read_b64_tr_b16 v[228:229], v247 offset:12288
ds_read_b64_tr_b16 v[230:231], v247 offset:12800
v_add_u32 v250, s24, v248
s_waitcnt lgkmcnt(4)
v_or3_b32 v186, v186, v187, v188
v_or_b32 v186, v186, v189
s_nop 0
v_readfirstlane_b32 s62, v186
s_nop 0
s_cmp_gt_u32 s62, s60
s_cbranch_scc1 L_fallback
v_accvgpr_read_b32 v0, a0
v_accvgpr_read_b32 v1, a1
v_accvgpr_read_b32 v2, a2
v_accvgpr_read_b32 v3, a3
v_accvgpr_read_b32 v4, a4
v_accvgpr_read_b32 v5, a5
v_accvgpr_read_b32 v6, a6
v_accvgpr_read_b32 v7, a7
v_mul_f32 v0, v254, v0
v_mul_f32 v1, v254, v1
v_mul_f32 v2, v254, v2
v_mul_f32 v3, v254, v3
v_mul_f32 v4, v254, v4
v_mul_f32 v5, v254, v5
v_mul_f32 v6, v254, v6
v_mul_f32 v7, v254, v7
v_cvt_pk_bf16_f32 v0, v0, v1
v_cvt_pk_bf16_f32 v1, v2, v3
v_cvt_pk_bf16_f32 v2, v4, v5
v_cvt_pk_bf16_f32 v3, v6, v7
ds_write_b128 v250, v[0:3]
v_accvgpr_read_b32 v8, a16
v_accvgpr_read_b32 v9, a17
v_accvgpr_read_b32 v10, a18
v_accvgpr_read_b32 v11, a19
v_accvgpr_read_b32 v12, a20
v_accvgpr_read_b32 v13, a21
v_accvgpr_read_b32 v14, a22
v_accvgpr_read_b32 v15, a23
v_mul_f32 v8, v255, v8
v_mul_f32 v9, v255, v9
v_mul_f32 v10, v255, v10
v_mul_f32 v11, v255, v11
v_mul_f32 v12, v255, v12
v_mul_f32 v13, v255, v13
v_mul_f32 v14, v255, v14
v_mul_f32 v15, v255, v15
v_cvt_pk_bf16_f32 v8, v8, v9
v_cvt_pk_bf16_f32 v9, v10, v11
v_cvt_pk_bf16_f32 v10, v12, v13
v_cvt_pk_bf16_f32 v11, v14, v15
ds_write_b128 v250, v[8:11] offset:1024
s_waitcnt lgkmcnt(4)
v_mfma_f32_32x32x16_bf16 v[64:79], v[224:227], v[0:3], 0
ds_read_b64_tr_b16 v[232:233], v246 offset:14336
ds_read_b64_tr_b16 v[234:235], v246 offset:14848
v_accvgpr_read_b32 v16, a8
v_accvgpr_read_b32 v17, a9
v_accvgpr_read_b32 v18, a10
v_accvgpr_read_b32 v19, a11
v_accvgpr_read_b32 v20, a12
v_accvgpr_read_b32 v21, a13
v_accvgpr_read_b32 v22, a14
v_mfma_f32_32x32x16_bf16 v[80:95], v[224:227], v[8:11], 0
ds_read_b64_tr_b16 v[236:237], v247 offset:14336
ds_read_b64_tr_b16 v[238:239], v247 offset:14848
s_add_u32 m0, s48, 0x3000
s_add_u32 s49, s20, 0x14080
v_accvgpr_read_b32 v23, a15
v_mul_f32 v16, v254, v16
v_mul_f32 v17, v254, v17
v_mul_f32 v18, v254, v18
v_mul_f32 v19, v254, v19
v_mul_f32 v20, v254, v20
v_mul_f32 v21, v254, v21
s_waitcnt lgkmcnt(6)
v_mfma_f32_32x32x16_bf16 v[96:111], v[228:231], v[0:3], 0
buffer_load_dwordx4 v244, s[16:19], s49 offen lds
v_mul_f32 v22, v254, v22
v_mul_f32 v23, v254, v23
v_cvt_pk_bf16_f32 v16, v16, v17
v_cvt_pk_bf16_f32 v17, v18, v19
v_cvt_pk_bf16_f32 v18, v20, v21
v_cvt_pk_bf16_f32 v19, v22, v23
v_mfma_f32_32x32x16_bf16 v[112:127], v[228:231], v[8:11], 0
buffer_load_dwordx4 v245, s[16:19], s49 offen offset:1024 lds
ds_write_b128 v250, v[16:19] offset:2048
v_accvgpr_read_b32 v24, a24
v_accvgpr_read_b32 v25, a25
v_accvgpr_read_b32 v26, a26
v_accvgpr_read_b32 v27, a27
v_accvgpr_read_b32 v28, a28
v_accvgpr_read_b32 v29, a29
v_accvgpr_read_b32 v30, a30
s_waitcnt lgkmcnt(3)
v_mfma_f32_32x32x16_bf16 v[128:143], v[232:235], v[0:3], 0
ds_read_b64_tr_b16 v[224:225], v246
ds_read_b64_tr_b16 v[226:227], v246 offset:512
v_accvgpr_read_b32 v31, a31
v_mul_f32 v24, v255, v24
v_mul_f32 v25, v255, v25
v_mul_f32 v26, v255, v26
v_mul_f32 v27, v255, v27
v_mul_f32 v28, v255, v28
v_mul_f32 v29, v255, v29
v_mfma_f32_32x32x16_bf16 v[144:159], v[232:235], v[8:11], 0
ds_read_b64_tr_b16 v[228:229], v247
ds_read_b64_tr_b16 v[230:231], v247 offset:512
s_add_u32 m0, s48, 0x3800
s_add_u32 s49, s20, 0x18000
v_mul_f32 v30, v255, v30
v_mul_f32 v31, v255, v31
v_cvt_pk_bf16_f32 v24, v24, v25
v_cvt_pk_bf16_f32 v25, v26, v27
v_cvt_pk_bf16_f32 v26, v28, v29
v_cvt_pk_bf16_f32 v27, v30, v31
s_waitcnt lgkmcnt(5)
v_mfma_f32_32x32x16_bf16 v[160:175], v[236:239], v[0:3], 0
buffer_load_dwordx4 v244, s[16:19], s49 offen lds
ds_write_b128 v250, v[24:27] offset:3072
v_mfma_f32_32x32x16_bf16 v[176:191], v[236:239], v[8:11], 0
buffer_load_dwordx4 v245, s[16:19], s49 offen offset:1024 lds
s_waitcnt lgkmcnt(3)
v_mfma_f32_32x32x16_bf16 v[64:79], v[224:227], v[16:19], v[64:79]
ds_read_b64_tr_b16 v[232:233], v246 offset:2048
ds_read_b64_tr_b16 v[234:235], v246 offset:2560
v_accvgpr_read_b32 v0, a32
v_accvgpr_read_b32 v1, a33
v_accvgpr_read_b32 v2, a34
v_accvgpr_read_b32 v3, a35
v_accvgpr_read_b32 v4, a36
v_accvgpr_read_b32 v5, a37
v_accvgpr_read_b32 v6, a38
v_mfma_f32_32x32x16_bf16 v[80:95], v[224:227], v[24:27], v[80:95]
ds_read_b64_tr_b16 v[236:237], v247 offset:2048
ds_read_b64_tr_b16 v[238:239], v247 offset:2560
s_add_u32 m0, s48, 0
s_add_u32 s49, s20, 0x18080
v_accvgpr_read_b32 v7, a39
v_mul_f32 v0, v254, v0
v_mul_f32 v1, v254, v1
v_mul_f32 v2, v254, v2
v_mul_f32 v3, v254, v3
v_mul_f32 v4, v254, v4
v_mul_f32 v5, v254, v5
s_waitcnt lgkmcnt(5)
v_mfma_f32_32x32x16_bf16 v[96:111], v[228:231], v[16:19], v[96:111]
buffer_load_dwordx4 v244, s[16:19], s49 offen lds
v_mul_f32 v6, v254, v6
v_mul_f32 v7, v254, v7
v_cvt_pk_bf16_f32 v0, v0, v1
v_cvt_pk_bf16_f32 v1, v2, v3
v_cvt_pk_bf16_f32 v2, v4, v5
v_cvt_pk_bf16_f32 v3, v6, v7
v_mfma_f32_32x32x16_bf16 v[112:127], v[228:231], v[24:27], v[112:127]
buffer_load_dwordx4 v245, s[16:19], s49 offen offset:1024 lds
ds_write_b128 v250, v[0:3] offset:4096
v_accvgpr_read_b32 v8, a48
v_accvgpr_read_b32 v9, a49
v_accvgpr_read_b32 v10, a50
v_accvgpr_read_b32 v11, a51
v_accvgpr_read_b32 v12, a52
v_accvgpr_read_b32 v13, a53
v_accvgpr_read_b32 v14, a54
s_waitcnt lgkmcnt(3)
v_mfma_f32_32x32x16_bf16 v[128:143], v[232:235], v[16:19], v[128:143]
ds_read_b64_tr_b16 v[224:225], v246 offset:4096
ds_read_b64_tr_b16 v[226:227], v246 offset:4608
v_accvgpr_read_b32 v15, a55
v_mul_f32 v8, v255, v8
v_mul_f32 v9, v255, v9
v_mul_f32 v10, v255, v10
v_mul_f32 v11, v255, v11
v_mul_f32 v12, v255, v12
v_mul_f32 v13, v255, v13
v_mfma_f32_32x32x16_bf16 v[144:159], v[232:235], v[24:27], v[144:159]
ds_read_b64_tr_b16 v[228:229], v247 offset:4096
ds_read_b64_tr_b16 v[230:231], v247 offset:4608
s_add_u32 m0, s48, 0x800
s_add_u32 s49, s20, 0x1c000
v_mul_f32 v14, v255, v14
v_mul_f32 v15, v255, v15
v_cvt_pk_bf16_f32 v8, v8, v9
v_cvt_pk_bf16_f32 v9, v10, v11
v_cvt_pk_bf16_f32 v10, v12, v13
v_cvt_pk_bf16_f32 v11, v14, v15
s_waitcnt lgkmcnt(5)
v_mfma_f32_32x32x16_bf16 v[160:175], v[236:239], v[16:19], v[160:175]
buffer_load_dwordx4 v244, s[16:19], s49 offen lds
ds_write_b128 v250, v[8:11] offset:5120
v_mfma_f32_32x32x16_bf16 v[176:191], v[236:239], v[24:27], v[176:191]
buffer_load_dwordx4 v245, s[16:19], s49 offen offset:1024 lds
s_waitcnt lgkmcnt(3)
v_mfma_f32_32x32x16_bf16 v[64:79], v[224:227], v[0:3], v[64:79]
ds_read_b64_tr_b16 v[232:233], v246 offset:6144
ds_read_b64_tr_b16 v[234:235], v246 offset:6656
v_accvgpr_read_b32 v16, a40
v_accvgpr_read_b32 v17, a41
v_accvgpr_read_b32 v18, a42
v_accvgpr_read_b32 v19, a43
v_accvgpr_read_b32 v20, a44
v_accvgpr_read_b32 v21, a45
v_accvgpr_read_b32 v22, a46
v_mfma_f32_32x32x16_bf16 v[80:95], v[224:227], v[8:11], v[80:95]
ds_read_b64_tr_b16 v[236:237], v247 offset:6144
ds_read_b64_tr_b16 v[238:239], v247 offset:6656
s_add_u32 m0, s48, 0x1000
s_add_u32 s49, s20, 0x1c080
v_accvgpr_read_b32 v23, a47
v_mul_f32 v16, v254, v16
v_mul_f32 v17, v254, v17
v_mul_f32 v18, v254, v18
v_mul_f32 v19, v254, v19
v_mul_f32 v20, v254, v20
v_mul_f32 v21, v254, v21
s_waitcnt lgkmcnt(5)
v_mfma_f32_32x32x16_bf16 v[96:111], v[228:231], v[0:3], v[96:111]
buffer_load_dwordx4 v244, s[16:19], s49 offen lds
v_mul_f32 v22, v254, v22
v_mul_f32 v23, v254, v23
v_cvt_pk_bf16_f32 v16, v16, v17
v_cvt_pk_bf16_f32 v17, v18, v19
v_cvt_pk_bf16_f32 v18, v20, v21
v_cvt_pk_bf16_f32 v19, v22, v23
v_mfma_f32_32x32x16_bf16 v[112:127], v[228:231], v[8:11], v[112:127]
buffer_load_dwordx4 v245, s[16:19], s49 offen offset:1024 lds
ds_write_b128 v250, v[16:19] offset:6144
v_accvgpr_read_b32 v24, a56
v_accvgpr_read_b32 v25, a57
v_accvgpr_read_b32 v26, a58
v_accvgpr_read_b32 v27, a59
v_accvgpr_read_b32 v28, a60
v_accvgpr_read_b32 v29, a61
v_accvgpr_read_b32 v30, a62
s_waitcnt lgkmcnt(3)
v_mfma_f32_32x32x16_bf16 v[128:143], v[232:235], v[0:3], v[128:143]
ds_read_b64_tr_b16 v[224:225], v246 offset:8192
ds_read_b64_tr_b16 v[226:227], v246 offset:8704
v_accvgpr_read_b32 v31, a63
v_mul_f32 v24, v255, v24
v_mul_f32 v25, v255, v25
v_mul_f32 v26, v255, v26
v_mul_f32 v27, v255, v27
v_mul_f32 v28, v255, v28
v_mul_f32 v29, v255, v29
v_mfma_f32_32x32x16_bf16 v[144:159], v[232:235], v[8:11], v[144:159]
ds_read_b64_tr_b16 v[228:229], v247 offset:8192
ds_read_b64_tr_b16 v[230:231], v247 offset:8704
s_add_u32 m0, s48, 0x1800
s_add_u32 s49, s21, 0
v_mul_f32 v30, v255, v30
v_mul_f32 v31, v255, v31
v_cvt_pk_bf16_f32 v24, v24, v25
v_cvt_pk_bf16_f32 v25, v26, v27
v_cvt_pk_bf16_f32 v26, v28, v29
v_cvt_pk_bf16_f32 v27, v30, v31
s_waitcnt lgkmcnt(5)
v_mfma_f32_32x32x16_bf16 v[160:175], v[236:239], v[0:3], v[160:175]
buffer_load_dwordx4 v244, s[16:19], s49 offen lds
ds_write_b128 v250, v[24:27] offset:7168
v_mfma_f32_32x32x16_bf16 v[176:191], v[236:239], v[8:11], v[176:191]
buffer_load_dwordx4 v245, s[16:19], s49 offen offset:1024 lds
s_waitcnt lgkmcnt(3)
v_mfma_f32_32x32x16_bf16 v[64:79], v[224:227], v[16:19], v[64:79]
ds_read_b64_tr_b16 v[232:233], v246 offset:10240
ds_read_b64_tr_b16 v[234:235], v246 offset:10752
v_accvgpr_read_b32 v0, a64
v_accvgpr_read_b32 v1, a65
v_accvgpr_read_b32 v2, a66
v_accvgpr_read_b32 v3, a67
v_accvgpr_read_b32 v4, a68
v_accvgpr_read_b32 v5, a69
v_accvgpr_read_b32 v6, a70
v_mfma_f32_32x32x16_bf16 v[80:95], v[224:227], v[24:27], v[80:95]
ds_read_b64_tr_b16 v[236:237], v247 offset:10240
ds_read_b64_tr_b16 v[238:239], v247 offset:10752
s_add_u32 m0, s48, 0x2000
s_add_u32 s49, s21, 0x4000
v_accvgpr_read_b32 v7, a71
v_mul_f32 v0, v254, v0
v_mul_f32 v1, v254, v1
v_mul_f32 v2, v254, v2
v_mul_f32 v3, v254, v3
v_mul_f32 v4, v254, v4
v_mul_f32 v5, v254, v5
s_waitcnt lgkmcnt(5)
v_mfma_f32_32x32x16_bf16 v[96:111], v[228:231], v[16:19], v[96:111]
buffer_load_dwordx4 v244, s[16:19], s49 offen lds
v_mul_f32 v6, v254, v6
v_mul_f32 v7, v254, v7
v_cvt_pk_bf16_f32 v0, v0, v1
v_cvt_pk_bf16_f32 v1, v2, v3
v_cvt_pk_bf16_f32 v2, v4, v5
v_cvt_pk_bf16_f32 v3, v6, v7
v_mfma_f32_32x32x16_bf16 v[112:127], v[228:231], v[24:27], v[112:127]
buffer_load_dwordx4 v245, s[16:19], s49 offen offset:1024 lds
ds_write_b128 v250, v[0:3] offset:8192
v_accvgpr_read_b32 v8, a80
v_accvgpr_read_b32 v9, a81
v_accvgpr_read_b32 v10, a82
v_accvgpr_read_b32 v11, a83
v_accvgpr_read_b32 v12, a84
v_accvgpr_read_b32 v13, a85
v_accvgpr_read_b32 v14, a86
s_waitcnt lgkmcnt(3)
v_mfma_f32_32x32x16_bf16 v[128:143], v[232:235], v[16:19], v[128:143]
ds_read_b64_tr_b16 v[224:225], v240 offset:4096
ds_read_b64_tr_b16 v[226:227], v240 offset:4608
v_accvgpr_read_b32 v15, a87
v_mul_f32 v8, v255, v8
v_mul_f32 v9, v255, v9
v_mul_f32 v10, v255, v10
v_mul_f32 v11, v255, v11
v_mul_f32 v12, v255, v12
v_mul_f32 v13, v255, v13
v_mfma_f32_32x32x16_bf16 v[144:159], v[232:235], v[24:27], v[144:159]
ds_read_b64_tr_b16 v[228:229], v241 offset:4096
ds_read_b64_tr_b16 v[230:231], v241 offset:4608
s_add_u32 m0, s48, 0x2800
s_add_u32 s49, s21, 0x8000
v_mul_f32 v14, v255, v14
v_mul_f32 v15, v255, v15
v_cvt_pk_bf16_f32 v8, v8, v9
v_cvt_pk_bf16_f32 v9, v10, v11
v_cvt_pk_bf16_f32 v10, v12, v13
v_cvt_pk_bf16_f32 v11, v14, v15
s_waitcnt lgkmcnt(5)
v_mfma_f32_32x32x16_bf16 v[160:175], v[236:239], v[16:19], v[160:175]
buffer_load_dwordx4 v244, s[16:19], s49 offen lds
ds_write_b128 v250, v[8:11] offset:9216
v_mfma_f32_32x32x16_bf16 v[176:191], v[236:239], v[24:27], v[176:191]
buffer_load_dwordx4 v245, s[16:19], s49 offen offset:1024 lds
s_waitcnt lgkmcnt(3)
v_mfma_f32_32x32x16_bf16 v[64:79], v[224:227], v[0:3], v[64:79]
ds_read_b64_tr_b16 v[232:233], v240
ds_read_b64_tr_b16 v[234:235], v240 offset:512
v_accvgpr_read_b32 v16, a72
v_accvgpr_read_b32 v17, a73
v_accvgpr_read_b32 v18, a74
v_accvgpr_read_b32 v19, a75
v_accvgpr_read_b32 v20, a76
v_accvgpr_read_b32 v21, a77
v_accvgpr_read_b32 v22, a78
v_mfma_f32_32x32x16_bf16 v[80:95], v[224:227], v[8:11], v[80:95]
ds_read_b64_tr_b16 v[236:237], v241
ds_read_b64_tr_b16 v[238:239], v241 offset:512
s_add_u32 m0, s96, 0x1000
s_add_u32 s49, s21, 0xc000
v_accvgpr_read_b32 v23, a79
v_mul_f32 v16, v254, v16
v_mul_f32 v17, v254, v17
v_mul_f32 v18, v254, v18
v_mul_f32 v19, v254, v19
v_mul_f32 v20, v254, v20
v_mul_f32 v21, v254, v21
s_waitcnt lgkmcnt(5)
v_mfma_f32_32x32x16_bf16 v[96:111], v[228:231], v[0:3], v[96:111]
buffer_load_dwordx4 v244, s[16:19], s49 offen lds
v_mul_f32 v22, v254, v22
v_mul_f32 v23, v254, v23
v_cvt_pk_bf16_f32 v16, v16, v17
v_cvt_pk_bf16_f32 v17, v18, v19
v_cvt_pk_bf16_f32 v18, v20, v21
v_cvt_pk_bf16_f32 v19, v22, v23
v_mfma_f32_32x32x16_bf16 v[112:127], v[228:231], v[8:11], v[112:127]
buffer_load_dwordx4 v245, s[16:19], s49 offen offset:1024 lds
ds_write_b128 v250, v[16:19] offset:10240
v_accvgpr_read_b32 v24, a88
v_accvgpr_read_b32 v25, a89
v_accvgpr_read_b32 v26, a90
v_accvgpr_read_b32 v27, a91
v_accvgpr_read_b32 v28, a92
v_accvgpr_read_b32 v29, a93
v_accvgpr_read_b32 v30, a94
s_waitcnt lgkmcnt(3)
v_mfma_f32_32x32x16_bf16 v[128:143], v[232:235], v[0:3], v[128:143]
ds_read_b64_tr_b16 v[224:225], v240 offset:2048
ds_read_b64_tr_b16 v[226:227], v240 offset:2560
v_accvgpr_read_b32 v31, a95
v_mul_f32 v24, v255, v24
v_mul_f32 v25, v255, v25
v_mul_f32 v26, v255, v26
v_mul_f32 v27, v255, v27
v_mul_f32 v28, v255, v28
v_mul_f32 v29, v255, v29
v_mfma_f32_32x32x16_bf16 v[144:159], v[232:235], v[8:11], v[144:159]
ds_read_b64_tr_b16 v[228:229], v241 offset:2048
ds_read_b64_tr_b16 v[230:231], v241 offset:2560
s_add_u32 m0, s96, 0
s_add_u32 s49, s21, 0x10000
v_mul_f32 v30, v255, v30
v_mul_f32 v31, v255, v31
v_cvt_pk_bf16_f32 v24, v24, v25
v_cvt_pk_bf16_f32 v25, v26, v27
v_cvt_pk_bf16_f32 v26, v28, v29
v_cvt_pk_bf16_f32 v27, v30, v31
s_waitcnt lgkmcnt(5)
v_mfma_f32_32x32x16_bf16 v[160:175], v[236:239], v[0:3], v[160:175]
buffer_load_dwordx4 v244, s[16:19], s49 offen lds
ds_write_b128 v250, v[24:27] offset:11264
v_mfma_f32_32x32x16_bf16 v[176:191], v[236:239], v[8:11], v[176:191]
buffer_load_dwordx4 v245, s[16:19], s49 offen offset:1024 lds
s_waitcnt vmcnt(18) lgkmcnt(3)
v_mfma_f32_32x32x16_bf16 v[64:79], v[224:227], v[16:19], v[64:79]
ds_read_b64_tr_b16 v[232:233], v246 offset:12288
ds_read_b64_tr_b16 v[234:235], v246 offset:12800
v_accvgpr_read_b32 v0, a96
v_accvgpr_read_b32 v1, a97
v_accvgpr_read_b32 v2, a98
v_accvgpr_read_b32 v3, a99
v_accvgpr_read_b32 v4, a100
v_accvgpr_read_b32 v5, a101
v_accvgpr_read_b32 v6, a102
v_mfma_f32_32x32x16_bf16 v[80:95], v[224:227], v[24:27], v[80:95]
ds_read_b64_tr_b16 v[236:237], v247 offset:12288
ds_read_b64_tr_b16 v[238:239], v247 offset:12800
s_add_u32 m0, s96, 0x800
s_add_u32 s49, s21, 0x14000
v_accvgpr_read_b32 v7, a103
v_mul_f32 v0, v254, v0
v_mul_f32 v1, v254, v1
v_mul_f32 v2, v254, v2
v_mul_f32 v3, v254, v3
v_mul_f32 v4, v254, v4
v_mul_f32 v5, v254, v5
s_waitcnt lgkmcnt(5)
v_mfma_f32_32x32x16_bf16 v[96:111], v[228:231], v[16:19], v[96:111]
buffer_load_dwordx4 v244, s[16:19], s49 offen lds
v_mul_f32 v6, v254, v6
v_mul_f32 v7, v254, v7
v_cvt_pk_bf16_f32 v0, v0, v1
v_cvt_pk_bf16_f32 v1, v2, v3
v_cvt_pk_bf16_f32 v2, v4, v5
v_cvt_pk_bf16_f32 v3, v6, v7
v_mfma_f32_32x32x16_bf16 v[112:127], v[228:231], v[24:27], v[112:127]
buffer_load_dwordx4 v245, s[16:19], s49 offen offset:1024 lds
ds_write_b128 v250, v[0:3] offset:12288
v_accvgpr_read_b32 v8, a112
v_accvgpr_read_b32 v9, a113
v_accvgpr_read_b32 v10, a114
v_accvgpr_read_b32 v11, a115
v_accvgpr_read_b32 v12, a116
v_accvgpr_read_b32 v13, a117
v_accvgpr_read_b32 v14, a118
s_waitcnt vmcnt(18) lgkmcnt(3)
v_mfma_f32_32x32x16_bf16 v[128:143], v[232:235], v[16:19], v[128:143]
ds_read_b64_tr_b16 v[224:225], v246 offset:14336
ds_read_b64_tr_b16 v[226:227], v246 offset:14848
v_accvgpr_read_b32 v15, a119
v_mul_f32 v8, v255, v8
v_mul_f32 v9, v255, v9
v_mul_f32 v10, v255, v10
v_mul_f32 v11, v255, v11
v_mul_f32 v12, v255, v12
v_mul_f32 v13, v255, v13
v_mfma_f32_32x32x16_bf16 v[144:159], v[232:235], v[24:27], v[144:159]
ds_read_b64_tr_b16 v[228:229], v247 offset:14336
ds_read_b64_tr_b16 v[230:231], v247 offset:14848
s_add_u32 m0, s48, 0x3000
s_add_u32 s49, s21, 0x18000
v_mul_f32 v14, v255, v14
v_mul_f32 v15, v255, v15
v_cvt_pk_bf16_f32 v8, v8, v9
v_cvt_pk_bf16_f32 v9, v10, v11
v_cvt_pk_bf16_f32 v10, v12, v13
v_cvt_pk_bf16_f32 v11, v14, v15
s_waitcnt lgkmcnt(5)
v_mfma_f32_32x32x16_bf16 v[160:175], v[236:239], v[16:19], v[160:175]
buffer_load_dwordx4 v244, s[16:19], s49 offen lds
ds_write_b128 v250, v[8:11] offset:13312
v_mfma_f32_32x32x16_bf16 v[176:191], v[236:239], v[24:27], v[176:191]
buffer_load_dwordx4 v245, s[16:19], s49 offen offset:1024 lds
s_waitcnt vmcnt(18) lgkmcnt(3)
v_mfma_f32_32x32x16_bf16 v[64:79], v[224:227], v[0:3], v[64:79]
ds_read_b64_tr_b16 v[232:233], v246
ds_read_b64_tr_b16 v[234:235], v246 offset:512
v_accvgpr_read_b32 v16, a104
v_accvgpr_read_b32 v17, a105
v_accvgpr_read_b32 v18, a106
v_accvgpr_read_b32 v19, a107
v_accvgpr_read_b32 v20, a108
v_accvgpr_read_b32 v21, a109
v_accvgpr_read_b32 v22, a110
v_mfma_f32_32x32x16_bf16 v[80:95], v[224:227], v[8:11], v[80:95]
ds_read_b64_tr_b16 v[236:237], v247
ds_read_b64_tr_b16 v[238:239], v247 offset:512
s_add_u32 m0, s48, 0x3800
s_add_u32 s49, s21, 0x1c000
v_accvgpr_read_b32 v23, a111
v_mul_f32 v16, v254, v16
v_mul_f32 v17, v254, v17
v_mul_f32 v18, v254, v18
v_mul_f32 v19, v254, v19
v_mul_f32 v20, v254, v20
v_mul_f32 v21, v254, v21
s_waitcnt lgkmcnt(5)
v_mfma_f32_32x32x16_bf16 v[96:111], v[228:231], v[0:3], v[96:111]
buffer_load_dwordx4 v244, s[16:19], s49 offen lds
v_mul_f32 v22, v254, v22
v_mul_f32 v23, v254, v23
v_cvt_pk_bf16_f32 v16, v16, v17
v_cvt_pk_bf16_f32 v17, v18, v19
v_cvt_pk_bf16_f32 v18, v20, v21
v_cvt_pk_bf16_f32 v19, v22, v23
v_mfma_f32_32x32x16_bf16 v[112:127], v[228:231], v[8:11], v[112:127]
buffer_load_dwordx4 v245, s[16:19], s49 offen offset:1024 lds
ds_write_b128 v250, v[16:19] offset:14336
v_accvgpr_read_b32 v24, a120
v_accvgpr_read_b32 v25, a121
v_accvgpr_read_b32 v26, a122
v_accvgpr_read_b32 v27, a123
v_accvgpr_read_b32 v28, a124
v_accvgpr_read_b32 v29, a125
v_accvgpr_read_b32 v30, a126
s_waitcnt vmcnt(18) lgkmcnt(3)
v_mfma_f32_32x32x16_bf16 v[128:143], v[232:235], v[0:3], v[128:143]
ds_read_b64_tr_b16 v[224:225], v246 offset:2048
ds_read_b64_tr_b16 v[226:227], v246 offset:2560
v_accvgpr_read_b32 v31, a127
v_mul_f32 v24, v255, v24
v_mul_f32 v25, v255, v25
v_mul_f32 v26, v255, v26
v_mul_f32 v27, v255, v27
v_mul_f32 v28, v255, v28
v_mul_f32 v29, v255, v29
v_mfma_f32_32x32x16_bf16 v[144:159], v[232:235], v[8:11], v[144:159]
ds_read_b64_tr_b16 v[228:229], v247 offset:2048
ds_read_b64_tr_b16 v[230:231], v247 offset:2560
s_add_u32 m0, s48, 0
s_add_u32 s49, s22, 0
v_mul_f32 v30, v255, v30
v_mul_f32 v31, v255, v31
v_cvt_pk_bf16_f32 v24, v24, v25
v_cvt_pk_bf16_f32 v25, v26, v27
v_cvt_pk_bf16_f32 v26, v28, v29
v_cvt_pk_bf16_f32 v27, v30, v31
s_waitcnt lgkmcnt(5)
v_mfma_f32_32x32x16_bf16 v[160:175], v[236:239], v[0:3], v[160:175]
buffer_load_dwordx4 v244, s[16:19], s49 offen lds
ds_write_b128 v250, v[24:27] offset:15360
v_mfma_f32_32x32x16_bf16 v[176:191], v[236:239], v[8:11], v[176:191]
buffer_load_dwordx4 v245, s[16:19], s49 offen offset:1024 lds
s_waitcnt vmcnt(18) lgkmcnt(3)
v_mfma_f32_32x32x16_bf16 v[64:79], v[224:227], v[16:19], v[64:79]
ds_read_b64_tr_b16 v[232:233], v246 offset:4096
ds_read_b64_tr_b16 v[234:235], v246 offset:4608
v_mfma_f32_32x32x16_bf16 v[80:95], v[224:227], v[24:27], v[80:95]
ds_read_b64_tr_b16 v[236:237], v247 offset:4096
ds_read_b64_tr_b16 v[238:239], v247 offset:4608
s_add_u32 m0, s48, 0x800
s_add_u32 s49, s22, 0x4000
s_waitcnt lgkmcnt(5)
v_mfma_f32_32x32x16_bf16 v[96:111], v[228:231], v[16:19], v[96:111]
buffer_load_dwordx4 v244, s[16:19], s49 offen lds
v_mfma_f32_32x32x16_bf16 v[112:127], v[228:231], v[24:27], v[112:127]
buffer_load_dwordx4 v245, s[16:19], s49 offen offset:1024 lds
v_add_u32 v251, s25, v248
s_waitcnt lgkmcnt(4)
s_barrier
s_waitcnt vmcnt(18) lgkmcnt(2)
v_mfma_f32_32x32x16_bf16 v[128:143], v[232:235], v[16:19], v[128:143]
ds_read_b64_tr_b16 v[224:225], v246 offset:6144
ds_read_b64_tr_b16 v[226:227], v246 offset:6656
ds_read_b128 a[128:131], v251
v_mfma_f32_32x32x16_bf16 v[144:159], v[232:235], v[24:27], v[144:159]
ds_read_b128 a[132:135], v251 offset:1024
ds_read_b64_tr_b16 v[228:229], v247 offset:6144
ds_read_b64_tr_b16 v[230:231], v247 offset:6656
s_add_u32 m0, s48, 0x1000
s_add_u32 s49, s22, 0x8000
s_waitcnt lgkmcnt(6)
v_mfma_f32_32x32x16_bf16 v[160:175], v[236:239], v[16:19], v[160:175]
buffer_load_dwordx4 v244, s[16:19], s49 offen lds
v_mfma_f32_32x32x16_bf16 v[176:191], v[236:239], v[24:27], v[176:191]
buffer_load_dwordx4 v245, s[16:19], s49 offen offset:1024 lds
s_waitcnt vmcnt(18) lgkmcnt(3)
v_mfma_f32_32x32x16_bf16 v[64:79], v[224:227], a[128:131], v[64:79]
ds_read_b64_tr_b16 v[232:233], v246 offset:8192
ds_read_b64_tr_b16 v[234:235], v246 offset:8704
ds_read_b128 a[136:139], v251 offset:2048
s_waitcnt lgkmcnt(5)
v_mfma_f32_32x32x16_bf16 v[80:95], v[224:227], a[132:135], v[80:95]
ds_read_b128 a[140:143], v251 offset:3072
ds_read_b64_tr_b16 v[236:237], v247 offset:8192
ds_read_b64_tr_b16 v[238:239], v247 offset:8704
s_add_u32 m0, s48, 0x1800
s_add_u32 s49, s22, 0xc000
s_waitcnt lgkmcnt(6)
v_mfma_f32_32x32x16_bf16 v[96:111], v[228:231], a[128:131], v[96:111]
buffer_load_dwordx4 v244, s[16:19], s49 offen lds
v_mfma_f32_32x32x16_bf16 v[112:127], v[228:231], a[132:135], v[112:127]
buffer_load_dwordx4 v245, s[16:19], s49 offen offset:1024 lds
s_waitcnt vmcnt(18) lgkmcnt(3)
v_mfma_f32_32x32x16_bf16 v[64:79], v[232:235], a[136:139], v[64:79]
ds_read_b64_tr_b16 v[224:225], v246 offset:10240
ds_read_b64_tr_b16 v[226:227], v246 offset:10752
ds_read_b128 a[128:131], v251 offset:4096
s_waitcnt lgkmcnt(5)
v_mfma_f32_32x32x16_bf16 v[80:95], v[232:235], a[140:143], v[80:95]
ds_read_b128 a[132:135], v251 offset:5120
ds_read_b64_tr_b16 v[228:229], v247 offset:10240
ds_read_b64_tr_b16 v[230:231], v247 offset:10752
s_add_u32 m0, s48, 0x2000
s_add_u32 s49, s22, 0x10000
s_waitcnt lgkmcnt(6)
v_mfma_f32_32x32x16_bf16 v[96:111], v[236:239], a[136:139], v[96:111]
buffer_load_dwordx4 v244, s[16:19], s49 offen lds
v_mfma_f32_32x32x16_bf16 v[112:127], v[236:239], a[140:143], v[112:127]
buffer_load_dwordx4 v245, s[16:19], s49 offen offset:1024 lds
s_waitcnt vmcnt(18) lgkmcnt(3)
v_mfma_f32_32x32x16_bf16 v[64:79], v[224:227], a[128:131], v[64:79]
ds_read_b64_tr_b16 v[232:233], v240 offset:4096
ds_read_b64_tr_b16 v[234:235], v240 offset:4608
ds_read_b128 a[136:139], v251 offset:6144
s_waitcnt lgkmcnt(5)
v_mfma_f32_32x32x16_bf16 v[80:95], v[224:227], a[132:135], v[80:95]
ds_read_b128 a[140:143], v251 offset:7168
ds_read_b64_tr_b16 v[236:237], v241 offset:4096
ds_read_b64_tr_b16 v[238:239], v241 offset:4608
s_add_u32 m0, s48, 0x2800
s_add_u32 s49, s22, 0x14000
s_waitcnt lgkmcnt(6)
v_mfma_f32_32x32x16_bf16 v[96:111], v[228:231], a[128:131], v[96:111]
buffer_load_dwordx4 v244, s[16:19], s49 offen lds
v_mfma_f32_32x32x16_bf16 v[112:127], v[228:231], a[132:135], v[112:127]
buffer_load_dwordx4 v245, s[16:19], s49 offen offset:1024 lds
s_waitcnt vmcnt(18) lgkmcnt(3)
v_mfma_f32_32x32x16_bf16 v[64:79], v[232:235], a[136:139], v[64:79]
ds_read_b64_tr_b16 v[224:225], v240
ds_read_b64_tr_b16 v[226:227], v240 offset:512
ds_read_b128 a[128:131], v251 offset:8192
s_waitcnt lgkmcnt(5)
v_mfma_f32_32x32x16_bf16 v[80:95], v[232:235], a[140:143], v[80:95]
ds_read_b128 a[132:135], v251 offset:9216
ds_read_b64_tr_b16 v[228:229], v241
ds_read_b64_tr_b16 v[230:231], v241 offset:512
s_add_u32 m0, s96, 0x1000
s_add_u32 s49, s22, 0x18000
s_waitcnt lgkmcnt(6)
v_mfma_f32_32x32x16_bf16 v[96:111], v[236:239], a[136:139], v[96:111]
buffer_load_dwordx4 v244, s[16:19], s49 offen lds
v_mfma_f32_32x32x16_bf16 v[112:127], v[236:239], a[140:143], v[112:127]
buffer_load_dwordx4 v245, s[16:19], s49 offen offset:1024 lds
s_waitcnt vmcnt(18) lgkmcnt(3)
v_mfma_f32_32x32x16_bf16 v[64:79], v[224:227], a[128:131], v[64:79]
ds_read_b64_tr_b16 v[232:233], v240 offset:2048
ds_read_b64_tr_b16 v[234:235], v240 offset:2560
ds_read_b128 a[136:139], v251 offset:10240
s_waitcnt lgkmcnt(5)
v_mfma_f32_32x32x16_bf16 v[80:95], v[224:227], a[132:135], v[80:95]
ds_read_b128 a[140:143], v251 offset:11264
ds_read_b64_tr_b16 v[236:237], v241 offset:2048
ds_read_b64_tr_b16 v[238:239], v241 offset:2560
s_add_u32 m0, s96, 0
s_add_u32 s49, s22, 0x1c000
s_waitcnt lgkmcnt(6)
v_mfma_f32_32x32x16_bf16 v[96:111], v[228:231], a[128:131], v[96:111]
buffer_load_dwordx4 v244, s[16:19], s49 offen lds
v_mfma_f32_32x32x16_bf16 v[112:127], v[228:231], a[132:135], v[112:127]
buffer_load_dwordx4 v245, s[16:19], s49 offen offset:1024 lds
s_waitcnt vmcnt(18) lgkmcnt(3)
v_mfma_f32_32x32x16_bf16 v[64:79], v[232:235], a[136:139], v[64:79]
ds_read_b64_tr_b16 v[224:225], v246 offset:12288
ds_read_b64_tr_b16 v[226:227], v246 offset:12800
ds_read_b128 a[128:131], v251 offset:12288
s_waitcnt lgkmcnt(5)
v_mfma_f32_32x32x16_bf16 v[80:95], v[232:235], a[140:143], v[80:95]
ds_read_b128 a[132:135], v251 offset:13312
ds_read_b64_tr_b16 v[228:229], v247 offset:12288
ds_read_b64_tr_b16 v[230:231], v247 offset:12800
s_add_u32 m0, s96, 0x800
s_add_u32 s49, s23, 0
s_waitcnt lgkmcnt(6)
v_mfma_f32_32x32x16_bf16 v[96:111], v[236:239], a[136:139], v[96:111]
buffer_load_dwordx4 v244, s[16:19], s49 offen lds
v_mfma_f32_32x32x16_bf16 v[112:127], v[236:239], a[140:143], v[112:127]
buffer_load_dwordx4 v245, s[16:19], s49 offen offset:1024 lds
s_waitcnt vmcnt(18) lgkmcnt(3)
v_mfma_f32_32x32x16_bf16 v[64:79], v[224:227], a[128:131], v[64:79]
ds_read_b64_tr_b16 v[232:233], v246 offset:14336
ds_read_b64_tr_b16 v[234:235], v246 offset:14848
ds_read_b128 a[136:139], v251 offset:14336
s_waitcnt lgkmcnt(5)
v_mfma_f32_32x32x16_bf16 v[80:95], v[224:227], a[132:135], v[80:95]
ds_read_b128 a[140:143], v251 offset:15360
ds_read_b64_tr_b16 v[236:237], v247 offset:14336
ds_read_b64_tr_b16 v[238:239], v247 offset:14848
s_add_u32 m0, s48, 0x3000
s_add_u32 s49, s23, 0x4000
s_waitcnt lgkmcnt(6)
v_mfma_f32_32x32x16_bf16 v[96:111], v[228:231], a[128:131], v[96:111]
buffer_load_dwordx4 v244, s[16:19], s49 offen lds
v_mfma_f32_32x32x16_bf16 v[112:127], v[228:231], a[132:135], v[112:127]
buffer_load_dwordx4 v245, s[16:19], s49 offen offset:1024 lds
v_add_u32 v250, s26, v248
s_waitcnt vmcnt(18) lgkmcnt(3)
v_mfma_f32_32x32x16_bf16 v[64:79], v[232:235], a[136:139], v[64:79]
ds_read_b64_tr_b16 v[224:225], v246
ds_read_b64_tr_b16 v[226:227], v246 offset:512
ds_read_b128 a[128:131], v250
s_waitcnt lgkmcnt(5)
v_mfma_f32_32x32x16_bf16 v[80:95], v[232:235], a[140:143], v[80:95]
ds_read_b128 a[132:135], v250 offset:1024
ds_read_b64_tr_b16 v[228:229], v247
ds_read_b64_tr_b16 v[230:231], v247 offset:512
s_add_u32 m0, s48, 0x3800
s_add_u32 s49, s23, 0x8000
s_waitcnt lgkmcnt(6)
v_mfma_f32_32x32x16_bf16 v[96:111], v[236:239], a[136:139], v[96:111]
buffer_load_dwordx4 v244, s[16:19], s49 offen lds
v_mfma_f32_32x32x16_bf16 v[112:127], v[236:239], a[140:143], v[112:127]
buffer_load_dwordx4 v245, s[16:19], s49 offen offset:1024 lds
s_waitcnt vmcnt(18) lgkmcnt(3)
v_mfma_f32_32x32x16_bf16 v[64:79], v[224:227], a[128:131], v[64:79]
ds_read_b64_tr_b16 v[232:233], v246 offset:2048
ds_read_b64_tr_b16 v[234:235], v246 offset:2560
ds_read_b128 a[136:139], v250 offset:2048
s_waitcnt lgkmcnt(5)
v_mfma_f32_32x32x16_bf16 v[80:95], v[224:227], a[132:135], v[80:95]
ds_read_b128 a[140:143], v250 offset:3072
ds_read_b64_tr_b16 v[236:237], v247 offset:2048
ds_read_b64_tr_b16 v[238:239], v247 offset:2560
s_add_u32 m0, s48, 0
s_add_u32 s49, s23, 0xc000
s_waitcnt lgkmcnt(6)
v_mfma_f32_32x32x16_bf16 v[96:111], v[228:231], a[128:131], v[96:111]
buffer_load_dwordx4 v244, s[16:19], s49 offen lds
v_mfma_f32_32x32x16_bf16 v[112:127], v[228:231], a[132:135], v[112:127]
buffer_load_dwordx4 v245, s[16:19], s49 offen offset:1024 lds
s_waitcnt vmcnt(18) lgkmcnt(3)
v_mfma_f32_32x32x16_bf16 v[64:79], v[232:235], a[136:139], v[64:79]
ds_read_b64_tr_b16 v[224:225], v246 offset:4096
ds_read_b64_tr_b16 v[226:227], v246 offset:4608
ds_read_b128 a[128:131], v250 offset:4096
s_waitcnt lgkmcnt(5)
v_mfma_f32_32x32x16_bf16 v[80:95], v[232:235], a[140:143], v[80:95]
ds_read_b128 a[132:135], v250 offset:5120
ds_read_b64_tr_b16 v[228:229], v247 offset:4096
ds_read_b64_tr_b16 v[230:231], v247 offset:4608
s_add_u32 m0, s48, 0x800
s_add_u32 s49, s23, 0x10000
s_waitcnt lgkmcnt(6)
v_mfma_f32_32x32x16_bf16 v[96:111], v[236:239], a[136:139], v[96:111]
buffer_load_dwordx4 v244, s[16:19], s49 offen lds
v_mfma_f32_32x32x16_bf16 v[112:127], v[236:239], a[140:143], v[112:127]
buffer_load_dwordx4 v245, s[16:19], s49 offen offset:1024 lds
s_waitcnt vmcnt(18) lgkmcnt(3)
v_mfma_f32_32x32x16_bf16 v[64:79], v[224:227], a[128:131], v[64:79]
ds_read_b64_tr_b16 v[232:233], v246 offset:6144
ds_read_b64_tr_b16 v[234:235], v246 offset:6656
ds_read_b128 a[136:139], v250 offset:6144
s_waitcnt lgkmcnt(5)
v_mfma_f32_32x32x16_bf16 v[80:95], v[224:227], a[132:135], v[80:95]
ds_read_b128 a[140:143], v250 offset:7168
ds_read_b64_tr_b16 v[236:237], v247 offset:6144
ds_read_b64_tr_b16 v[238:239], v247 offset:6656
s_add_u32 m0, s48, 0x1000
s_add_u32 s49, s23, 0x14000
s_waitcnt lgkmcnt(6)
v_mfma_f32_32x32x16_bf16 v[96:111], v[228:231], a[128:131], v[96:111]
buffer_load_dwordx4 v244, s[16:19], s49 offen lds
v_mfma_f32_32x32x16_bf16 v[112:127], v[228:231], a[132:135], v[112:127]
buffer_load_dwordx4 v245, s[16:19], s49 offen offset:1024 lds
s_waitcnt vmcnt(18) lgkmcnt(3)
v_mfma_f32_32x32x16_bf16 v[64:79], v[232:235], a[136:139], v[64:79]
ds_read_b64_tr_b16 v[224:225], v246 offset:8192
ds_read_b64_tr_b16 v[226:227], v246 offset:8704
ds_read_b128 a[128:131], v250 offset:8192
s_waitcnt lgkmcnt(5)
v_mfma_f32_32x32x16_bf16 v[80:95], v[232:235], a[140:143], v[80:95]
ds_read_b128 a[132:135], v250 offset:9216
ds_read_b64_tr_b16 v[228:229], v247 offset:8192
ds_read_b64_tr_b16 v[230:231], v247 offset:8704
s_add_u32 m0, s48, 0x1800
s_add_u32 s49, s23, 0x18000
s_waitcnt lgkmcnt(6)
v_mfma_f32_32x32x16_bf16 v[96:111], v[236:239], a[136:139], v[96:111]
buffer_load_dwordx4 v244, s[16:19], s49 offen lds
v_mfma_f32_32x32x16_bf16 v[112:127], v[236:239], a[140:143], v[112:127]
buffer_load_dwordx4 v245, s[16:19], s49 offen offset:1024 lds
s_waitcnt vmcnt(18) lgkmcnt(3)
v_mfma_f32_32x32x16_bf16 v[64:79], v[224:227], a[128:131], v[64:79]
ds_read_b64_tr_b16 v[232:233], v246 offset:10240
ds_read_b64_tr_b16 v[234:235], v246 offset:10752
ds_read_b128 a[136:139], v250 offset:10240
s_waitcnt lgkmcnt(5)
v_mfma_f32_32x32x16_bf16 v[80:95], v[224:227], a[132:135], v[80:95]
ds_read_b128 a[140:143], v250 offset:11264
ds_read_b64_tr_b16 v[236:237], v247 offset:10240
ds_read_b64_tr_b16 v[238:239], v247 offset:10752
s_add_u32 m0, s48, 0x2000
s_add_u32 s49, s23, 0x1c000
s_waitcnt lgkmcnt(6)
v_mfma_f32_32x32x16_bf16 v[96:111], v[228:231], a[128:131], v[96:111]
buffer_load_dwordx4 v244, s[16:19], s49 offen lds
v_mfma_f32_32x32x16_bf16 v[112:127], v[228:231], a[132:135], v[112:127]
buffer_load_dwordx4 v245, s[16:19], s49 offen offset:1024 lds
s_waitcnt vmcnt(18) lgkmcnt(3)
v_mfma_f32_32x32x16_bf16 v[64:79], v[232:235], a[136:139], v[64:79]
ds_read_b64_tr_b16 v[224:225], v240 offset:4096
ds_read_b64_tr_b16 v[226:227], v240 offset:4608
ds_read_b128 a[128:131], v250 offset:12288
s_waitcnt lgkmcnt(5)
v_mfma_f32_32x32x16_bf16 v[80:95], v[232:235], a[140:143], v[80:95]
ds_read_b128 a[132:135], v250 offset:13312
ds_read_b64_tr_b16 v[228:229], v241 offset:4096
ds_read_b64_tr_b16 v[230:231], v241 offset:4608
s_add_u32 m0, s48, 0x2800
s_add_u32 s49, s21, 0x80
s_waitcnt lgkmcnt(6)
v_mfma_f32_32x32x16_bf16 v[96:111], v[236:239], a[136:139], v[96:111]
buffer_load_dwordx4 v244, s[16:19], s49 offen lds
v_mfma_f32_32x32x16_bf16 v[112:127], v[236:239], a[140:143], v[112:127]
buffer_load_dwordx4 v245, s[16:19], s49 offen offset:1024 lds
s_waitcnt vmcnt(18) lgkmcnt(3)
v_mfma_f32_32x32x16_bf16 v[64:79], v[224:227], a[128:131], v[64:79]
ds_read_b64_tr_b16 v[232:233], v240
ds_read_b64_tr_b16 v[234:235], v240 offset:512
ds_read_b128 a[136:139], v250 offset:14336
s_waitcnt lgkmcnt(5)
v_mfma_f32_32x32x16_bf16 v[80:95], v[224:227], a[132:135], v[80:95]
ds_read_b128 a[140:143], v250 offset:15360
ds_read_b64_tr_b16 v[236:237], v241
ds_read_b64_tr_b16 v[238:239], v241 offset:512
s_add_u32 m0, s96, 0x1000
s_add_u32 s49, s21, 0x4080
s_waitcnt lgkmcnt(6)
v_mfma_f32_32x32x16_bf16 v[96:111], v[228:231], a[128:131], v[96:111]
buffer_load_dwordx4 v244, s[16:19], s49 offen lds
v_mfma_f32_32x32x16_bf16 v[112:127], v[228:231], a[132:135], v[112:127]
buffer_load_dwordx4 v245, s[16:19], s49 offen offset:1024 lds
v_add_u32 v251, s27, v248
s_waitcnt vmcnt(18) lgkmcnt(3)
v_mfma_f32_32x32x16_bf16 v[64:79], v[232:235], a[136:139], v[64:79]
ds_read_b64_tr_b16 v[224:225], v240 offset:2048
ds_read_b64_tr_b16 v[226:227], v240 offset:2560
ds_read_b128 a[128:131], v251
s_waitcnt lgkmcnt(5)
v_mfma_f32_32x32x16_bf16 v[80:95], v[232:235], a[140:143], v[80:95]
ds_read_b128 a[132:135], v251 offset:1024
ds_read_b64_tr_b16 v[228:229], v241 offset:2048
ds_read_b64_tr_b16 v[230:231], v241 offset:2560
s_add_u32 m0, s96, 0
s_add_u32 s49, s21, 0x8080
s_waitcnt lgkmcnt(6)
v_mfma_f32_32x32x16_bf16 v[96:111], v[236:239], a[136:139], v[96:111]
buffer_load_dwordx4 v244, s[16:19], s49 offen lds
v_mfma_f32_32x32x16_bf16 v[112:127], v[236:239], a[140:143], v[112:127]
buffer_load_dwordx4 v245, s[16:19], s49 offen offset:1024 lds
s_waitcnt vmcnt(18) lgkmcnt(3)
v_mfma_f32_32x32x16_bf16 v[64:79], v[224:227], a[128:131], v[64:79]
ds_read_b64_tr_b16 v[232:233], v246 offset:12288
ds_read_b64_tr_b16 v[234:235], v246 offset:12800
ds_read_b128 a[136:139], v251 offset:2048
s_waitcnt lgkmcnt(5)
v_mfma_f32_32x32x16_bf16 v[80:95], v[224:227], a[132:135], v[80:95]
ds_read_b128 a[140:143], v251 offset:3072
ds_read_b64_tr_b16 v[236:237], v247 offset:12288
ds_read_b64_tr_b16 v[238:239], v247 offset:12800
s_add_u32 m0, s96, 0x800
s_add_u32 s49, s21, 0xc080
s_waitcnt lgkmcnt(6)
v_mfma_f32_32x32x16_bf16 v[96:111], v[228:231], a[128:131], v[96:111]
buffer_load_dwordx4 v244, s[16:19], s49 offen lds
v_mfma_f32_32x32x16_bf16 v[112:127], v[228:231], a[132:135], v[112:127]
buffer_load_dwordx4 v245, s[16:19], s49 offen offset:1024 lds
s_waitcnt vmcnt(18) lgkmcnt(3)
v_mfma_f32_32x32x16_bf16 v[64:79], v[232:235], a[136:139], v[64:79]
ds_read_b64_tr_b16 v[224:225], v246 offset:14336
ds_read_b64_tr_b16 v[226:227], v246 offset:14848
ds_read_b128 a[128:131], v251 offset:4096
s_waitcnt lgkmcnt(5)
v_mfma_f32_32x32x16_bf16 v[80:95], v[232:235], a[140:143], v[80:95]
ds_read_b128 a[132:135], v251 offset:5120
ds_read_b64_tr_b16 v[228:229], v247 offset:14336
ds_read_b64_tr_b16 v[230:231], v247 offset:14848
s_add_u32 m0, s48, 0x3000
s_add_u32 s49, s21, 0x10080
s_waitcnt lgkmcnt(6)
v_mfma_f32_32x32x16_bf16 v[96:111], v[236:239], a[136:139], v[96:111]
buffer_load_dwordx4 v244, s[16:19], s49 offen lds
v_mfma_f32_32x32x16_bf16 v[112:127], v[236:239], a[140:143], v[112:127]
buffer_load_dwordx4 v245, s[16:19], s49 offen offset:1024 lds
s_waitcnt vmcnt(18) lgkmcnt(3)
v_mfma_f32_32x32x16_bf16 v[64:79], v[224:227], a[128:131], v[64:79]
ds_read_b64_tr_b16 v[232:233], v246
ds_read_b64_tr_b16 v[234:235], v246 offset:512
ds_read_b128 a[136:139], v251 offset:6144
s_waitcnt lgkmcnt(5)
v_mfma_f32_32x32x16_bf16 v[80:95], v[224:227], a[132:135], v[80:95]
ds_read_b128 a[140:143], v251 offset:7168
ds_read_b64_tr_b16 v[236:237], v247
ds_read_b64_tr_b16 v[238:239], v247 offset:512
s_add_u32 m0, s48, 0x3800
s_add_u32 s49, s21, 0x14080
s_waitcnt lgkmcnt(6)
v_mfma_f32_32x32x16_bf16 v[96:111], v[228:231], a[128:131], v[96:111]
buffer_load_dwordx4 v244, s[16:19], s49 offen lds
v_mfma_f32_32x32x16_bf16 v[112:127], v[228:231], a[132:135], v[112:127]
buffer_load_dwordx4 v245, s[16:19], s49 offen offset:1024 lds
s_waitcnt vmcnt(18) lgkmcnt(3)
v_mfma_f32_32x32x16_bf16 v[64:79], v[232:235], a[136:139], v[64:79]
ds_read_b64_tr_b16 v[224:225], v246 offset:2048
ds_read_b64_tr_b16 v[226:227], v246 offset:2560
ds_read_b128 a[128:131], v251 offset:8192
s_waitcnt lgkmcnt(5)
v_mfma_f32_32x32x16_bf16 v[80:95], v[232:235], a[140:143], v[80:95]
ds_read_b128 a[132:135], v251 offset:9216
ds_read_b64_tr_b16 v[228:229], v247 offset:2048
ds_read_b64_tr_b16 v[230:231], v247 offset:2560
s_add_u32 m0, s48, 0
s_add_u32 s49, s21, 0x18080
s_waitcnt lgkmcnt(6)
v_mfma_f32_32x32x16_bf16 v[96:111], v[236:239], a[136:139], v[96:111]
buffer_load_dwordx4 v244, s[16:19], s49 offen lds
v_mfma_f32_32x32x16_bf16 v[112:127], v[236:239], a[140:143], v[112:127]
buffer_load_dwordx4 v245, s[16:19], s49 offen offset:1024 lds
s_waitcnt vmcnt(18) lgkmcnt(3)
v_mfma_f32_32x32x16_bf16 v[64:79], v[224:227], a[128:131], v[64:79]
ds_read_b64_tr_b16 v[232:233], v246 offset:4096
ds_read_b64_tr_b16 v[234:235], v246 offset:4608
ds_read_b128 a[136:139], v251 offset:10240
s_waitcnt lgkmcnt(5)
v_mfma_f32_32x32x16_bf16 v[80:95], v[224:227], a[132:135], v[80:95]
ds_read_b128 a[140:143], v251 offset:11264
ds_read_b64_tr_b16 v[236:237], v247 offset:4096
ds_read_b64_tr_b16 v[238:239], v247 offset:4608
s_add_u32 m0, s48, 0x800
s_add_u32 s49, s21, 0x1c080
s_waitcnt lgkmcnt(6)
v_mfma_f32_32x32x16_bf16 v[96:111], v[228:231], a[128:131], v[96:111]
buffer_load_dwordx4 v244, s[16:19], s49 offen lds
v_mfma_f32_32x32x16_bf16 v[112:127], v[228:231], a[132:135], v[112:127]
buffer_load_dwordx4 v245, s[16:19], s49 offen offset:1024 lds
s_waitcnt vmcnt(18) lgkmcnt(3)
v_mfma_f32_32x32x16_bf16 v[64:79], v[232:235], a[136:139], v[64:79]
ds_read_b64_tr_b16 v[224:225], v246 offset:6144
ds_read_b64_tr_b16 v[226:227], v246 offset:6656
ds_read_b128 a[128:131], v251 offset:12288
s_waitcnt lgkmcnt(5)
v_mfma_f32_32x32x16_bf16 v[80:95], v[232:235], a[140:143], v[80:95]
ds_read_b128 a[132:135], v251 offset:13312
ds_read_b64_tr_b16 v[228:229], v247 offset:6144
ds_read_b64_tr_b16 v[230:231], v247 offset:6656
s_add_u32 m0, s48, 0x1000
s_add_u32 s49, s22, 0x80
s_waitcnt lgkmcnt(6)
v_mfma_f32_32x32x16_bf16 v[96:111], v[236:239], a[136:139], v[96:111]
buffer_load_dwordx4 v244, s[16:19], s49 offen lds
v_mfma_f32_32x32x16_bf16 v[112:127], v[236:239], a[140:143], v[112:127]
buffer_load_dwordx4 v245, s[16:19], s49 offen offset:1024 lds
s_waitcnt vmcnt(18) lgkmcnt(3)
v_mfma_f32_32x32x16_bf16 v[64:79], v[224:227], a[128:131], v[64:79]
ds_read_b64_tr_b16 v[232:233], v246 offset:8192
ds_read_b64_tr_b16 v[234:235], v246 offset:8704
ds_read_b128 a[136:139], v251 offset:14336
s_waitcnt lgkmcnt(5)
v_mfma_f32_32x32x16_bf16 v[80:95], v[224:227], a[132:135], v[80:95]
ds_read_b128 a[140:143], v251 offset:15360
ds_read_b64_tr_b16 v[236:237], v247 offset:8192
ds_read_b64_tr_b16 v[238:239], v247 offset:8704
s_add_u32 m0, s48, 0x1800
s_add_u32 s49, s22, 0x4080
s_waitcnt lgkmcnt(6)
v_mfma_f32_32x32x16_bf16 v[96:111], v[228:231], a[128:131], v[96:111]
buffer_load_dwordx4 v244, s[16:19], s49 offen lds
v_mfma_f32_32x32x16_bf16 v[112:127], v[228:231], a[132:135], v[112:127]
buffer_load_dwordx4 v245, s[16:19], s49 offen offset:1024 lds
v_add_u32 v250, s25, v248
s_waitcnt vmcnt(18) lgkmcnt(3)
v_mfma_f32_32x32x16_bf16 v[64:79], v[232:235], a[136:139], v[64:79]
ds_read_b64_tr_b16 v[224:225], v246 offset:10240
ds_read_b64_tr_b16 v[226:227], v246 offset:10752
ds_read_b128 a[128:131], v250
s_waitcnt lgkmcnt(5)
v_mfma_f32_32x32x16_bf16 v[80:95], v[232:235], a[140:143], v[80:95]
ds_read_b128 a[132:135], v250 offset:1024
ds_read_b64_tr_b16 v[228:229], v247 offset:10240
ds_read_b64_tr_b16 v[230:231], v247 offset:10752
s_add_u32 m0, s48, 0x2000
s_add_u32 s49, s22, 0x8080
s_waitcnt lgkmcnt(6)
v_mfma_f32_32x32x16_bf16 v[96:111], v[236:239], a[136:139], v[96:111]
buffer_load_dwordx4 v244, s[16:19], s49 offen lds
v_mfma_f32_32x32x16_bf16 v[112:127], v[236:239], a[140:143], v[112:127]
buffer_load_dwordx4 v245, s[16:19], s49 offen offset:1024 lds
s_waitcnt vmcnt(18) lgkmcnt(3)
v_mfma_f32_32x32x16_bf16 v[128:143], v[224:227], a[128:131], v[128:143]
ds_read_b64_tr_b16 v[232:233], v240 offset:4096
ds_read_b64_tr_b16 v[234:235], v240 offset:4608
ds_read_b128 a[136:139], v250 offset:2048
s_waitcnt lgkmcnt(5)
v_mfma_f32_32x32x16_bf16 v[144:159], v[224:227], a[132:135], v[144:159]
ds_read_b128 a[140:143], v250 offset:3072
ds_read_b64_tr_b16 v[236:237], v241 offset:4096
ds_read_b64_tr_b16 v[238:239], v241 offset:4608
s_add_u32 m0, s48, 0x2800
s_add_u32 s49, s22, 0xc080
s_waitcnt lgkmcnt(6)
v_mfma_f32_32x32x16_bf16 v[160:175], v[228:231], a[128:131], v[160:175]
buffer_load_dwordx4 v244, s[16:19], s49 offen lds
v_mfma_f32_32x32x16_bf16 v[176:191], v[228:231], a[132:135], v[176:191]
buffer_load_dwordx4 v245, s[16:19], s49 offen offset:1024 lds
s_waitcnt vmcnt(18) lgkmcnt(3)
v_mfma_f32_32x32x16_bf16 v[128:143], v[232:235], a[136:139], v[128:143]
ds_read_b64_tr_b16 v[224:225], v240
ds_read_b64_tr_b16 v[226:227], v240 offset:512
ds_read_b128 a[128:131], v250 offset:4096
v_cvt_pk_bf16_f32 v64, v64, v65
v_cvt_pk_bf16_f32 v65, v66, v67
v_cvt_pk_bf16_f32 v66, v68, v69
v_cvt_pk_bf16_f32 v67, v70, v71
s_waitcnt lgkmcnt(5)
v_mfma_f32_32x32x16_bf16 v[144:159], v[232:235], a[140:143], v[144:159]
ds_read_b128 a[132:135], v250 offset:5120
ds_read_b64_tr_b16 v[228:229], v241
ds_read_b64_tr_b16 v[230:231], v241 offset:512
s_add_u32 m0, s96, 0x1000
s_add_u32 s49, s22, 0x10080
v_cvt_pk_bf16_f32 v72, v72, v73
v_cvt_pk_bf16_f32 v73, v74, v75
v_cvt_pk_bf16_f32 v74, v76, v77
v_cvt_pk_bf16_f32 v75, v78, v79
s_waitcnt lgkmcnt(6)
v_mfma_f32_32x32x16_bf16 v[160:175], v[236:239], a[136:139], v[160:175]
buffer_load_dwordx4 v244, s[16:19], s49 offen lds
v_cvt_pk_bf16_f32 v80, v80, v81
v_cvt_pk_bf16_f32 v81, v82, v83
v_cvt_pk_bf16_f32 v82, v84, v85
v_cvt_pk_bf16_f32 v83, v86, v87
v_mfma_f32_32x32x16_bf16 v[176:191], v[236:239], a[140:143], v[176:191]
buffer_load_dwordx4 v245, s[16:19], s49 offen offset:1024 lds
v_cvt_pk_bf16_f32 v88, v88, v89
v_cvt_pk_bf16_f32 v89, v90, v91
v_cvt_pk_bf16_f32 v90, v92, v93
v_cvt_pk_bf16_f32 v91, v94, v95
s_waitcnt vmcnt(18) lgkmcnt(3)
v_mfma_f32_32x32x16_bf16 v[128:143], v[224:227], a[128:131], v[128:143]
ds_read_b64_tr_b16 v[232:233], v240 offset:2048
ds_read_b64_tr_b16 v[234:235], v240 offset:2560
ds_read_b128 a[136:139], v250 offset:6144
s_add_u32 s7, s57, 0
v_cvt_pk_bf16_f32 v96, v96, v97
v_cvt_pk_bf16_f32 v97, v98, v99
v_cvt_pk_bf16_f32 v98, v100, v101
v_cvt_pk_bf16_f32 v99, v102, v103
s_waitcnt lgkmcnt(5)
v_mfma_f32_32x32x16_bf16 v[144:159], v[224:227], a[132:135], v[144:159]
ds_read_b128 a[140:143], v250 offset:7168
ds_read_b64_tr_b16 v[236:237], v241 offset:2048
ds_read_b64_tr_b16 v[238:239], v241 offset:2560
buffer_store_dwordx4 v[64:67], v248, s[40:43], s7 offen sc1
s_add_u32 m0, s96, 0
s_add_u32 s49, s22, 0x14080
v_cvt_pk_bf16_f32 v104, v104, v105
v_cvt_pk_bf16_f32 v105, v106, v107
v_cvt_pk_bf16_f32 v106, v108, v109
v_cvt_pk_bf16_f32 v107, v110, v111
s_waitcnt lgkmcnt(6)
v_mfma_f32_32x32x16_bf16 v[160:175], v[228:231], a[128:131], v[160:175]
buffer_load_dwordx4 v244, s[16:19], s49 offen lds
v_cvt_pk_bf16_f32 v112, v112, v113
v_cvt_pk_bf16_f32 v113, v114, v115
v_cvt_pk_bf16_f32 v114, v116, v117
v_cvt_pk_bf16_f32 v115, v118, v119
v_mfma_f32_32x32x16_bf16 v[176:191], v[228:231], a[132:135], v[176:191]
buffer_load_dwordx4 v245, s[16:19], s49 offen offset:1024 lds
v_cvt_pk_bf16_f32 v120, v120, v121
v_cvt_pk_bf16_f32 v121, v122, v123
v_cvt_pk_bf16_f32 v122, v124, v125
v_cvt_pk_bf16_f32 v123, v126, v127
s_waitcnt vmcnt(19) lgkmcnt(3)
v_mfma_f32_32x32x16_bf16 v[128:143], v[232:235], a[136:139], v[128:143]
ds_read_b64_tr_b16 v[224:225], v246 offset:12288
ds_read_b64_tr_b16 v[226:227], v246 offset:12800
ds_read_b128 a[128:131], v250 offset:8192
s_add_u32 s7, s57, 0
s_waitcnt lgkmcnt(5)
v_mfma_f32_32x32x16_bf16 v[144:159], v[232:235], a[140:143], v[144:159]
ds_read_b128 a[132:135], v250 offset:9216
ds_read_b64_tr_b16 v[228:229], v247 offset:12288
ds_read_b64_tr_b16 v[230:231], v247 offset:12800
buffer_store_dwordx4 v[80:83], v248, s[40:43], s7 offen offset:1024 sc1
s_add_u32 m0, s96, 0x800
s_add_u32 s49, s22, 0x18080
s_waitcnt lgkmcnt(6)
v_mfma_f32_32x32x16_bf16 v[160:175], v[236:239], a[136:139], v[160:175]
buffer_load_dwordx4 v244, s[16:19], s49 offen lds
v_mfma_f32_32x32x16_bf16 v[176:191], v[236:239], a[140:143], v[176:191]
buffer_load_dwordx4 v245, s[16:19], s49 offen offset:1024 lds
s_waitcnt vmcnt(20) lgkmcnt(3)
v_mfma_f32_32x32x16_bf16 v[128:143], v[224:227], a[128:131], v[128:143]
ds_read_b64_tr_b16 v[232:233], v246 offset:14336
ds_read_b64_tr_b16 v[234:235], v246 offset:14848
ds_read_b128 a[136:139], v250 offset:10240
s_add_u32 s7, s57, 0
s_waitcnt lgkmcnt(5)
v_mfma_f32_32x32x16_bf16 v[144:159], v[224:227], a[132:135], v[144:159]
ds_read_b128 a[140:143], v250 offset:11264
ds_read_b64_tr_b16 v[236:237], v247 offset:14336
ds_read_b64_tr_b16 v[238:239], v247 offset:14848
buffer_store_dwordx4 v[72:75], v248, s[40:43], s7 offen offset:2048 sc1
s_add_u32 m0, s48, 0x3000
s_add_u32 s49, s22, 0x1c080
s_waitcnt lgkmcnt(6)
v_mfma_f32_32x32x16_bf16 v[160:175], v[228:231], a[128:131], v[160:175]
buffer_load_dwordx4 v244, s[16:19], s49 offen lds
v_mfma_f32_32x32x16_bf16 v[176:191], v[228:231], a[132:135], v[176:191]
buffer_load_dwordx4 v245, s[16:19], s49 offen offset:1024 lds
s_waitcnt vmcnt(21) lgkmcnt(3)
v_mfma_f32_32x32x16_bf16 v[128:143], v[232:235], a[136:139], v[128:143]
ds_read_b64_tr_b16 v[224:225], v246
ds_read_b64_tr_b16 v[226:227], v246 offset:512
ds_read_b128 a[128:131], v250 offset:12288
s_add_u32 s7, s57, 0
s_waitcnt lgkmcnt(5)
v_mfma_f32_32x32x16_bf16 v[144:159], v[232:235], a[140:143], v[144:159]
ds_read_b128 a[132:135], v250 offset:13312
ds_read_b64_tr_b16 v[228:229], v247
ds_read_b64_tr_b16 v[230:231], v247 offset:512
buffer_store_dwordx4 v[88:91], v248, s[40:43], s7 offen offset:3072 sc1
s_add_u32 m0, s48, 0x3800
s_add_u32 s49, s23, 0x80
s_waitcnt lgkmcnt(6)
v_mfma_f32_32x32x16_bf16 v[160:175], v[236:239], a[136:139], v[160:175]
buffer_load_dwordx4 v244, s[16:19], s49 offen lds
v_mfma_f32_32x32x16_bf16 v[176:191], v[236:239], a[140:143], v[176:191]
buffer_load_dwordx4 v245, s[16:19], s49 offen offset:1024 lds
s_waitcnt vmcnt(22) lgkmcnt(3)
v_mfma_f32_32x32x16_bf16 v[128:143], v[224:227], a[128:131], v[128:143]
ds_read_b64_tr_b16 v[232:233], v246 offset:2048
ds_read_b64_tr_b16 v[234:235], v246 offset:2560
ds_read_b128 a[136:139], v250 offset:14336
s_add_u32 s7, s57, 0x1000
s_waitcnt lgkmcnt(5)
v_mfma_f32_32x32x16_bf16 v[144:159], v[224:227], a[132:135], v[144:159]
ds_read_b128 a[140:143], v250 offset:15360
ds_read_b64_tr_b16 v[236:237], v247 offset:2048
ds_read_b64_tr_b16 v[238:239], v247 offset:2560
buffer_store_dwordx4 v[96:99], v248, s[40:43], s7 offen sc1
s_add_u32 m0, s48, 0
s_add_u32 s49, s23, 0x4080
s_waitcnt lgkmcnt(6)
v_mfma_f32_32x32x16_bf16 v[160:175], v[228:231], a[128:131], v[160:175]
buffer_load_dwordx4 v244, s[16:19], s49 offen lds
v_mfma_f32_32x32x16_bf16 v[176:191], v[228:231], a[132:135], v[176:191]
buffer_load_dwordx4 v245, s[16:19], s49 offen offset:1024 lds
v_add_u32 v251, s26, v248
s_waitcnt vmcnt(23) lgkmcnt(3)
v_mfma_f32_32x32x16_bf16 v[128:143], v[232:235], a[136:139], v[128:143]
ds_read_b64_tr_b16 v[224:225], v246 offset:4096
ds_read_b64_tr_b16 v[226:227], v246 offset:4608
ds_read_b128 a[128:131], v251
s_add_u32 s7, s57, 0x1000
s_waitcnt lgkmcnt(5)
v_mfma_f32_32x32x16_bf16 v[144:159], v[232:235], a[140:143], v[144:159]
ds_read_b128 a[132:135], v251 offset:1024
ds_read_b64_tr_b16 v[228:229], v247 offset:4096
ds_read_b64_tr_b16 v[230:231], v247 offset:4608
buffer_store_dwordx4 v[112:115], v248, s[40:43], s7 offen offset:1024 sc1
s_add_u32 m0, s48, 0x800
s_add_u32 s49, s23, 0x8080
s_waitcnt lgkmcnt(6)
v_mfma_f32_32x32x16_bf16 v[160:175], v[236:239], a[136:139], v[160:175]
buffer_load_dwordx4 v244, s[16:19], s49 offen lds
v_mfma_f32_32x32x16_bf16 v[176:191], v[236:239], a[140:143], v[176:191]
buffer_load_dwordx4 v245, s[16:19], s49 offen offset:1024 lds
s_waitcnt vmcnt(24) lgkmcnt(3)
v_mfma_f32_32x32x16_bf16 v[128:143], v[224:227], a[128:131], v[128:143]
ds_read_b64_tr_b16 v[232:233], v246 offset:6144
ds_read_b64_tr_b16 v[234:235], v246 offset:6656
ds_read_b128 a[136:139], v251 offset:2048
s_add_u32 s7, s57, 0x1000
s_waitcnt lgkmcnt(5)
v_mfma_f32_32x32x16_bf16 v[144:159], v[224:227], a[132:135], v[144:159]
ds_read_b128 a[140:143], v251 offset:3072
ds_read_b64_tr_b16 v[236:237], v247 offset:6144
ds_read_b64_tr_b16 v[238:239], v247 offset:6656
buffer_store_dwordx4 v[104:107], v248, s[40:43], s7 offen offset:2048 sc1
s_add_u32 m0, s48, 0x1000
s_add_u32 s49, s23, 0xc080
s_waitcnt lgkmcnt(6)
v_mfma_f32_32x32x16_bf16 v[160:175], v[228:231], a[128:131], v[160:175]
buffer_load_dwordx4 v244, s[16:19], s49 offen lds
v_mfma_f32_32x32x16_bf16 v[176:191], v[228:231], a[132:135], v[176:191]
buffer_load_dwordx4 v245, s[16:19], s49 offen offset:1024 lds
s_waitcnt vmcnt(25) lgkmcnt(3)
v_mfma_f32_32x32x16_bf16 v[128:143], v[232:235], a[136:139], v[128:143]
ds_read_b64_tr_b16 v[224:225], v246 offset:8192
ds_read_b64_tr_b16 v[226:227], v246 offset:8704
ds_read_b128 a[128:131], v251 offset:4096
s_add_u32 s7, s57, 0x1000
s_waitcnt lgkmcnt(5)
v_mfma_f32_32x32x16_bf16 v[144:159], v[232:235], a[140:143], v[144:159]
ds_read_b128 a[132:135], v251 offset:5120
ds_read_b64_tr_b16 v[228:229], v247 offset:8192
ds_read_b64_tr_b16 v[230:231], v247 offset:8704
buffer_store_dwordx4 v[120:123], v248, s[40:43], s7 offen offset:3072 sc1
s_add_u32 m0, s48, 0x1800
s_add_u32 s49, s23, 0x10080
s_waitcnt lgkmcnt(6)
v_mfma_f32_32x32x16_bf16 v[160:175], v[236:239], a[136:139], v[160:175]
buffer_load_dwordx4 v244, s[16:19], s49 offen lds
v_mfma_f32_32x32x16_bf16 v[176:191], v[236:239], a[140:143], v[176:191]
buffer_load_dwordx4 v245, s[16:19], s49 offen offset:1024 lds
s_waitcnt vmcnt(26) lgkmcnt(3)
v_mfma_f32_32x32x16_bf16 v[128:143], v[224:227], a[128:131], v[128:143]
ds_read_b64_tr_b16 v[232:233], v246 offset:10240
ds_read_b64_tr_b16 v[234:235], v246 offset:10752
ds_read_b128 a[136:139], v251 offset:6144
s_waitcnt lgkmcnt(5)
v_mfma_f32_32x32x16_bf16 v[144:159], v[224:227], a[132:135], v[144:159]
ds_read_b128 a[140:143], v251 offset:7168
ds_read_b64_tr_b16 v[236:237], v247 offset:10240
ds_read_b64_tr_b16 v[238:239], v247 offset:10752
s_add_u32 m0, s48, 0x2000
s_add_u32 s49, s23, 0x14080
s_waitcnt lgkmcnt(6)
v_mfma_f32_32x32x16_bf16 v[160:175], v[228:231], a[128:131], v[160:175]
buffer_load_dwordx4 v244, s[16:19], s49 offen lds
v_mfma_f32_32x32x16_bf16 v[176:191], v[228:231], a[132:135], v[176:191]
buffer_load_dwordx4 v245, s[16:19], s49 offen offset:1024 lds
s_waitcnt vmcnt(26) lgkmcnt(3)
v_mfma_f32_32x32x16_bf16 v[128:143], v[232:235], a[136:139], v[128:143]
ds_read_b64_tr_b16 v[224:225], v240 offset:4096
ds_read_b64_tr_b16 v[226:227], v240 offset:4608
ds_read_b128 a[128:131], v251 offset:8192
s_waitcnt lgkmcnt(5)
v_mfma_f32_32x32x16_bf16 v[144:159], v[232:235], a[140:143], v[144:159]
ds_read_b128 a[132:135], v251 offset:9216
ds_read_b64_tr_b16 v[228:229], v241 offset:4096
ds_read_b64_tr_b16 v[230:231], v241 offset:4608
s_add_u32 m0, s48, 0x2800
s_add_u32 s49, s23, 0x18080
s_waitcnt lgkmcnt(6)
v_mfma_f32_32x32x16_bf16 v[160:175], v[236:239], a[136:139], v[160:175]
buffer_load_dwordx4 v244, s[16:19], s49 offen lds
v_mfma_f32_32x32x16_bf16 v[176:191], v[236:239], a[140:143], v[176:191]
buffer_load_dwordx4 v245, s[16:19], s49 offen offset:1024 lds
s_waitcnt vmcnt(25) lgkmcnt(3)
v_mfma_f32_32x32x16_bf16 v[128:143], v[224:227], a[128:131], v[128:143]
ds_read_b64_tr_b16 v[232:233], v240
ds_read_b64_tr_b16 v[234:235], v240 offset:512
ds_read_b128 a[136:139], v251 offset:10240
s_waitcnt lgkmcnt(5)
v_mfma_f32_32x32x16_bf16 v[144:159], v[224:227], a[132:135], v[144:159]
ds_read_b128 a[140:143], v251 offset:11264
ds_read_b64_tr_b16 v[236:237], v241
ds_read_b64_tr_b16 v[238:239], v241 offset:512
s_add_u32 m0, s96, 0x1000
s_add_u32 s49, s23, 0x1c080
s_waitcnt lgkmcnt(6)
v_mfma_f32_32x32x16_bf16 v[160:175], v[228:231], a[128:131], v[160:175]
buffer_load_dwordx4 v244, s[16:19], s49 offen lds
v_mfma_f32_32x32x16_bf16 v[176:191], v[228:231], a[132:135], v[176:191]
buffer_load_dwordx4 v245, s[16:19], s49 offen offset:1024 lds
s_waitcnt vmcnt(24) lgkmcnt(3)
v_mfma_f32_32x32x16_bf16 v[128:143], v[232:235], a[136:139], v[128:143]
ds_read_b64_tr_b16 v[224:225], v240 offset:2048
ds_read_b64_tr_b16 v[226:227], v240 offset:2560
ds_read_b128 a[128:131], v251 offset:12288
s_waitcnt lgkmcnt(5)
v_mfma_f32_32x32x16_bf16 v[144:159], v[232:235], a[140:143], v[144:159]
ds_read_b128 a[132:135], v251 offset:13312
ds_read_b64_tr_b16 v[228:229], v241 offset:2048
ds_read_b64_tr_b16 v[230:231], v241 offset:2560
s_waitcnt lgkmcnt(6)
v_mfma_f32_32x32x16_bf16 v[160:175], v[236:239], a[136:139], v[160:175]
v_mfma_f32_32x32x16_bf16 v[176:191], v[236:239], a[140:143], v[176:191]
s_waitcnt vmcnt(21) lgkmcnt(3)
v_mfma_f32_32x32x16_bf16 v[128:143], v[224:227], a[128:131], v[128:143]
ds_read_b64_tr_b16 v[232:233], v246 offset:12288
ds_read_b64_tr_b16 v[234:235], v246 offset:12800
ds_read_b128 a[136:139], v251 offset:14336
s_waitcnt lgkmcnt(5)
v_mfma_f32_32x32x16_bf16 v[144:159], v[224:227], a[132:135], v[144:159]
ds_read_b128 a[140:143], v251 offset:15360
ds_read_b64_tr_b16 v[236:237], v247 offset:12288
ds_read_b64_tr_b16 v[238:239], v247 offset:12800
s_waitcnt lgkmcnt(6)
v_mfma_f32_32x32x16_bf16 v[160:175], v[228:231], a[128:131], v[160:175]
v_mfma_f32_32x32x16_bf16 v[176:191], v[228:231], a[132:135], v[176:191]
v_add_u32 v250, s27, v248
s_waitcnt vmcnt(18) lgkmcnt(3)
v_mfma_f32_32x32x16_bf16 v[128:143], v[232:235], a[136:139], v[128:143]
ds_read_b64_tr_b16 v[224:225], v246 offset:14336
ds_read_b64_tr_b16 v[226:227], v246 offset:14848
ds_read_b128 a[128:131], v250
s_waitcnt lgkmcnt(5)
v_mfma_f32_32x32x16_bf16 v[144:159], v[232:235], a[140:143], v[144:159]
ds_read_b128 a[132:135], v250 offset:1024
ds_read_b64_tr_b16 v[228:229], v247 offset:14336
ds_read_b64_tr_b16 v[230:231], v247 offset:14848
s_waitcnt lgkmcnt(6)
v_mfma_f32_32x32x16_bf16 v[160:175], v[236:239], a[136:139], v[160:175]
v_mfma_f32_32x32x16_bf16 v[176:191], v[236:239], a[140:143], v[176:191]
s_waitcnt vmcnt(15) lgkmcnt(3)
v_mfma_f32_32x32x16_bf16 v[128:143], v[224:227], a[128:131], v[128:143]
ds_read_b64_tr_b16 v[232:233], v246
ds_read_b64_tr_b16 v[234:235], v246 offset:512
ds_read_b128 a[136:139], v250 offset:2048
s_waitcnt lgkmcnt(5)
v_mfma_f32_32x32x16_bf16 v[144:159], v[224:227], a[132:135], v[144:159]
ds_read_b128 a[140:143], v250 offset:3072
ds_read_b64_tr_b16 v[236:237], v247
ds_read_b64_tr_b16 v[238:239], v247 offset:512
s_waitcnt lgkmcnt(6)
v_mfma_f32_32x32x16_bf16 v[160:175], v[228:231], a[128:131], v[160:175]
v_mfma_f32_32x32x16_bf16 v[176:191], v[228:231], a[132:135], v[176:191]
s_waitcnt vmcnt(8)
s_barrier
buffer_store_dword v60, v252, s[40:43], 0 offen offset:1024 sc1
s_waitcnt lgkmcnt(3)
v_mfma_f32_32x32x16_bf16 v[128:143], v[232:235], a[136:139], v[128:143]
ds_read_b64_tr_b16 v[224:225], v246 offset:2048
ds_read_b64_tr_b16 v[226:227], v246 offset:2560
ds_read_b128 a[128:131], v250 offset:4096
s_waitcnt lgkmcnt(5)
v_mfma_f32_32x32x16_bf16 v[144:159], v[232:235], a[140:143], v[144:159]
ds_read_b128 a[132:135], v250 offset:5120
ds_read_b64_tr_b16 v[228:229], v247 offset:2048
ds_read_b64_tr_b16 v[230:231], v247 offset:2560
s_waitcnt lgkmcnt(6)
v_mfma_f32_32x32x16_bf16 v[160:175], v[236:239], a[136:139], v[160:175]
v_mfma_f32_32x32x16_bf16 v[176:191], v[236:239], a[140:143], v[176:191]
s_waitcnt lgkmcnt(3)
v_mfma_f32_32x32x16_bf16 v[128:143], v[224:227], a[128:131], v[128:143]
ds_read_b64_tr_b16 v[232:233], v246 offset:4096
ds_read_b64_tr_b16 v[234:235], v246 offset:4608
ds_read_b128 a[136:139], v250 offset:6144
buffer_load_dwordx4 v[200:203], v56, s[8:11], 0 offen
s_waitcnt lgkmcnt(5)
v_mfma_f32_32x32x16_bf16 v[144:159], v[224:227], a[132:135], v[144:159]
ds_read_b128 a[140:143], v250 offset:7168
ds_read_b64_tr_b16 v[236:237], v247 offset:4096
ds_read_b64_tr_b16 v[238:239], v247 offset:4608
s_waitcnt lgkmcnt(6)
v_mfma_f32_32x32x16_bf16 v[160:175], v[228:231], a[128:131], v[160:175]
v_mfma_f32_32x32x16_bf16 v[176:191], v[228:231], a[132:135], v[176:191]
s_waitcnt vmcnt(8) lgkmcnt(3)
v_mfma_f32_32x32x16_bf16 v[128:143], v[232:235], a[136:139], v[128:143]
ds_read_b64_tr_b16 v[224:225], v246 offset:6144
ds_read_b64_tr_b16 v[226:227], v246 offset:6656
ds_read_b128 a[128:131], v250 offset:8192
buffer_load_dwordx4 v[204:207], v56, s[8:11], 0 offen offset:128
s_waitcnt lgkmcnt(5)
v_mfma_f32_32x32x16_bf16 v[144:159], v[232:235], a[140:143], v[144:159]
ds_read_b128 a[132:135], v250 offset:9216
ds_read_b64_tr_b16 v[228:229], v247 offset:6144
ds_read_b64_tr_b16 v[230:231], v247 offset:6656
s_waitcnt lgkmcnt(6)
v_mfma_f32_32x32x16_bf16 v[160:175], v[236:239], a[136:139], v[160:175]
v_mfma_f32_32x32x16_bf16 v[176:191], v[236:239], a[140:143], v[176:191]
s_waitcnt vmcnt(7) lgkmcnt(3)
v_mfma_f32_32x32x16_bf16 v[128:143], v[224:227], a[128:131], v[128:143]
ds_read_b64_tr_b16 v[232:233], v246 offset:8192
ds_read_b64_tr_b16 v[234:235], v246 offset:8704
ds_read_b128 a[136:139], v250 offset:10240
s_waitcnt lgkmcnt(5)
v_mfma_f32_32x32x16_bf16 v[144:159], v[224:227], a[132:135], v[144:159]
ds_read_b128 a[140:143], v250 offset:11264
ds_read_b64_tr_b16 v[236:237], v247 offset:8192
ds_read_b64_tr_b16 v[238:239], v247 offset:8704
s_waitcnt lgkmcnt(6)
v_mfma_f32_32x32x16_bf16 v[160:175], v[228:231], a[128:131], v[160:175]
v_mfma_f32_32x32x16_bf16 v[176:191], v[228:231], a[132:135], v[176:191]
s_waitcnt vmcnt(5) lgkmcnt(3)
v_mfma_f32_32x32x16_bf16 v[128:143], v[232:235], a[136:139], v[128:143]
ds_read_b64_tr_b16 v[224:225], v246 offset:10240
ds_read_b64_tr_b16 v[226:227], v246 offset:10752
ds_read_b128 a[128:131], v250 offset:12288
s_waitcnt lgkmcnt(5)
v_mfma_f32_32x32x16_bf16 v[144:159], v[232:235], a[140:143], v[144:159]
ds_read_b128 a[132:135], v250 offset:13312
ds_read_b64_tr_b16 v[228:229], v247 offset:10240
ds_read_b64_tr_b16 v[230:231], v247 offset:10752
s_waitcnt lgkmcnt(6)
v_mfma_f32_32x32x16_bf16 v[160:175], v[236:239], a[136:139], v[160:175]
v_mfma_f32_32x32x16_bf16 v[176:191], v[236:239], a[140:143], v[176:191]
s_waitcnt vmcnt(3) lgkmcnt(3)
v_mfma_f32_32x32x16_bf16 v[128:143], v[224:227], a[128:131], v[128:143]
ds_read_b64_tr_b16 v[232:233], v240 offset:4096
ds_read_b64_tr_b16 v[234:235], v240 offset:4608
ds_read_b128 a[136:139], v250 offset:14336
s_waitcnt lgkmcnt(5)
v_mfma_f32_32x32x16_bf16 v[144:159], v[224:227], a[132:135], v[144:159]
ds_read_b128 a[140:143], v250 offset:15360
ds_read_b64_tr_b16 v[236:237], v241 offset:4096
ds_read_b64_tr_b16 v[238:239], v241 offset:4608
s_waitcnt lgkmcnt(6)
v_mfma_f32_32x32x16_bf16 v[160:175], v[228:231], a[128:131], v[160:175]
v_mfma_f32_32x32x16_bf16 v[176:191], v[228:231], a[132:135], v[176:191]
s_waitcnt lgkmcnt(3)
v_mfma_f32_32x32x16_bf16 v[128:143], v[232:235], a[136:139], v[128:143]
s_waitcnt lgkmcnt(2)
v_mfma_f32_32x32x16_bf16 v[144:159], v[232:235], a[140:143], v[144:159]
s_waitcnt lgkmcnt(0)
v_mfma_f32_32x32x16_bf16 v[160:175], v[236:239], a[136:139], v[160:175]
v_mfma_f32_32x32x16_bf16 v[176:191], v[236:239], a[140:143], v[176:191]
s_nop 6
v_cvt_pk_bf16_f32 v128, v128, v129
v_cvt_pk_bf16_f32 v129, v130, v131
v_cvt_pk_bf16_f32 v130, v132, v133
v_cvt_pk_bf16_f32 v131, v134, v135
s_add_u32 s7, s57, 0x2000
buffer_store_dwordx4 v[128:131], v248, s[40:43], s7 offen sc1
v_cvt_pk_bf16_f32 v136, v136, v137
v_cvt_pk_bf16_f32 v137, v138, v139
v_cvt_pk_bf16_f32 v138, v140, v141
v_cvt_pk_bf16_f32 v139, v142, v143
s_add_u32 s7, s57, 0x2000
buffer_store_dwordx4 v[136:139], v248, s[40:43], s7 offen offset:2048 sc1
v_cvt_pk_bf16_f32 v144, v144, v145
v_cvt_pk_bf16_f32 v145, v146, v147
v_cvt_pk_bf16_f32 v146, v148, v149
v_cvt_pk_bf16_f32 v147, v150, v151
s_add_u32 s7, s57, 0x2000
buffer_store_dwordx4 v[144:147], v248, s[40:43], s7 offen offset:1024 sc1
v_cvt_pk_bf16_f32 v152, v152, v153
v_cvt_pk_bf16_f32 v153, v154, v155
v_cvt_pk_bf16_f32 v154, v156, v157
v_cvt_pk_bf16_f32 v155, v158, v159
s_add_u32 s7, s57, 0x2000
buffer_store_dwordx4 v[152:155], v248, s[40:43], s7 offen offset:3072 sc1
v_cvt_pk_bf16_f32 v160, v160, v161
v_cvt_pk_bf16_f32 v161, v162, v163
v_cvt_pk_bf16_f32 v162, v164, v165
v_cvt_pk_bf16_f32 v163, v166, v167
s_add_u32 s7, s57, 0x3000
buffer_store_dwordx4 v[160:163], v248, s[40:43], s7 offen sc1
v_cvt_pk_bf16_f32 v168, v168, v169
v_cvt_pk_bf16_f32 v169, v170, v171
v_cvt_pk_bf16_f32 v170, v172, v173
v_cvt_pk_bf16_f32 v171, v174, v175
s_add_u32 s7, s57, 0x3000
buffer_store_dwordx4 v[168:171], v248, s[40:43], s7 offen offset:2048 sc1
v_cvt_pk_bf16_f32 v176, v176, v177
v_cvt_pk_bf16_f32 v177, v178, v179
v_cvt_pk_bf16_f32 v178, v180, v181
v_cvt_pk_bf16_f32 v179, v182, v183
s_add_u32 s7, s57, 0x3000
buffer_store_dwordx4 v[176:179], v248, s[40:43], s7 offen offset:1024 sc1
v_cvt_pk_bf16_f32 v184, v184, v185
v_cvt_pk_bf16_f32 v185, v186, v187
v_cvt_pk_bf16_f32 v186, v188, v189
v_cvt_pk_bf16_f32 v187, v190, v191
s_add_u32 s7, s57, 0x3000
buffer_store_dwordx4 v[184:187], v248, s[40:43], s7 offen offset:3072 sc1
s_waitcnt vmcnt(0)
s_barrier
buffer_store_dword v60, v252, s[40:43], 0 offen offset:2048 sc1
buffer_load_dword v54, v55, s[40:43], 0 offen offset:1024 sc1
s_mov_b32 s48, 0x3f80
s_mov_b32 s49, 0x3f800000
s_mov_b32 s52, 0xbfb8aa3b
s_mov_b32 s6, 0
v_accvgpr_read_b32 v0, a192
v_accvgpr_read_b32 v1, a193
v_accvgpr_read_b32 v2, a194
v_accvgpr_read_b32 v3, a195
v_accvgpr_read_b32 v4, a196
v_accvgpr_read_b32 v5, a197
v_accvgpr_read_b32 v6, a198
v_accvgpr_read_b32 v7, a199
v_accvgpr_read_b32 v8, a200
v_accvgpr_read_b32 v9, a201
v_accvgpr_read_b32 v10, a202
v_accvgpr_read_b32 v11, a203
v_accvgpr_read_b32 v12, a204
v_accvgpr_read_b32 v13, a205
v_accvgpr_read_b32 v14, a206
v_accvgpr_read_b32 v15, a207
v_accvgpr_read_b32 v16, a208
v_accvgpr_read_b32 v17, a209
v_accvgpr_read_b32 v18, a210
v_accvgpr_read_b32 v19, a211
v_accvgpr_read_b32 v20, a212
v_accvgpr_read_b32 v21, a213
v_accvgpr_read_b32 v22, a214
v_accvgpr_read_b32 v23, a215
v_accvgpr_read_b32 v24, a216
v_accvgpr_read_b32 v25, a217
v_accvgpr_read_b32 v26, a218
v_accvgpr_read_b32 v27, a219
v_accvgpr_read_b32 v28, a220
v_accvgpr_read_b32 v29, a221
v_accvgpr_read_b32 v30, a222
v_accvgpr_read_b32 v31, a223
v_dot2_f32_bf16 v208, v0, s48, 0
v_dot2_f32_bf16 v209, v0, s49, 0
v_dot2_f32_bf16 v210, v1, s48, 0
v_dot2_f32_bf16 v211, v1, s49, 0
v_dot2_f32_bf16 v212, v2, s48, 0
v_dot2_f32_bf16 v213, v2, s49, 0
v_dot2_f32_bf16 v214, v3, s48, 0
v_dot2_f32_bf16 v215, v3, s49, 0
v_dot2_f32_bf16 v208, v4, s48, v208
v_dot2_f32_bf16 v209, v4, s49, v209
v_dot2_f32_bf16 v210, v5, s48, v210
v_dot2_f32_bf16 v211, v5, s49, v211
v_dot2_f32_bf16 v212, v6, s48, v212
v_dot2_f32_bf16 v213, v6, s49, v213
v_dot2_f32_bf16 v214, v7, s48, v214
v_dot2_f32_bf16 v215, v7, s49, v215
v_dot2_f32_bf16 v208, v8, s48, v208
v_dot2_f32_bf16 v209, v8, s49, v209
v_dot2_f32_bf16 v210, v9, s48, v210
v_dot2_f32_bf16 v211, v9, s49, v211
v_dot2_f32_bf16 v212, v10, s48, v212
v_dot2_f32_bf16 v213, v10, s49, v213
v_dot2_f32_bf16 v214, v11, s48, v214
v_dot2_f32_bf16 v215, v11, s49, v215
v_dot2_f32_bf16 v208, v12, s48, v208
v_dot2_f32_bf16 v209, v12, s49, v209
v_dot2_f32_bf16 v210, v13, s48, v210
v_dot2_f32_bf16 v211, v13, s49, v211
v_dot2_f32_bf16 v212, v14, s48, v212
v_dot2_f32_bf16 v213, v14, s49, v213
v_dot2_f32_bf16 v214, v15, s48, v214
v_dot2_f32_bf16 v215, v15, s49, v215
v_dot2_f32_bf16 v208, v16, s48, v208
v_dot2_f32_bf16 v209, v16, s49, v209
v_dot2_f32_bf16 v210, v17, s48, v210
v_dot2_f32_bf16 v211, v17, s49, v211
v_dot2_f32_bf16 v212, v18, s48, v212
v_dot2_f32_bf16 v213, v18, s49, v213
v_dot2_f32_bf16 v214, v19, s48, v214
v_dot2_f32_bf16 v215, v19, s49, v215
v_dot2_f32_bf16 v208, v20, s48, v208
v_dot2_f32_bf16 v209, v20, s49, v209
v_dot2_f32_bf16 v210, v21, s48, v210
v_dot2_f32_bf16 v211, v21, s49, v211
v_dot2_f32_bf16 v212, v22, s48, v212
v_dot2_f32_bf16 v213, v22, s49, v213
v_dot2_f32_bf16 v214, v23, s48, v214
v_dot2_f32_bf16 v215, v23, s49, v215
v_dot2_f32_bf16 v208, v24, s48, v208
v_dot2_f32_bf16 v209, v24, s49, v209
v_dot2_f32_bf16 v210, v25, s48, v210
v_dot2_f32_bf16 v211, v25, s49, v211
v_dot2_f32_bf16 v212, v26, s48, v212
v_dot2_f32_bf16 v213, v26, s49, v213
v_dot2_f32_bf16 v214, v27, s48, v214
v_dot2_f32_bf16 v215, v27, s49, v215
v_dot2_f32_bf16 v208, v28, s48, v208
v_dot2_f32_bf16 v209, v28, s49, v209
v_dot2_f32_bf16 v210, v29, s48, v210
v_dot2_f32_bf16 v211, v29, s49, v211
v_dot2_f32_bf16 v212, v30, s48, v212
v_dot2_f32_bf16 v213, v30, s49, v213
v_dot2_f32_bf16 v214, v31, s48, v214
v_dot2_f32_bf16 v215, v31, s49, v215
v_mul_f32 v224, s52, v208
v_mul_f32 v225, s52, v209
v_mul_f32 v226, s52, v210
v_mul_f32 v227, s52, v211
v_mul_f32 v228, s52, v212
v_mul_f32 v229, s52, v213
v_mul_f32 v230, s52, v214
v_mul_f32 v231, s52, v215
v_exp_f32 v224, v224
v_exp_f32 v225, v225
v_exp_f32 v226, v226
v_exp_f32 v227, v227
v_exp_f32 v228, v228
v_exp_f32 v229, v229
v_exp_f32 v230, v230
v_exp_f32 v231, v231
v_add_f32 v224, 1.0, v224
v_add_f32 v225, 1.0, v225
v_add_f32 v226, 1.0, v226
v_add_f32 v227, 1.0, v227
v_add_f32 v228, 1.0, v228
v_add_f32 v229, 1.0, v229
v_add_f32 v230, 1.0, v230
v_add_f32 v231, 1.0, v231
v_rcp_f32 v224, v224
v_rcp_f32 v225, v225
v_rcp_f32 v226, v226
v_rcp_f32 v227, v227
v_rcp_f32 v228, v228
v_rcp_f32 v229, v229
v_rcp_f32 v230, v230
v_rcp_f32 v231, v231
v_mul_f32 v208, v224, v208
v_mul_f32 v209, v225, v209
v_mul_f32 v210, v226, v210
v_mul_f32 v211, v227, v211
v_mul_f32 v212, v228, v212
v_mul_f32 v213, v229, v213
v_mul_f32 v214, v230, v214
v_mul_f32 v215, v231, v215
L_s0flag_chk:
s_waitcnt vmcnt(0)
v_or_b32 v54, v54, v61
v_cmp_eq_u32 vcc, 1, v54
s_add_u32 s6, s6, 1
s_cmp_eq_u64 vcc, -1
s_cbranch_scc1 L_s0flag_ok
s_cmp_gt_u32 s6, 0x61a80
s_cbranch_scc1 L_s0flag_ok
s_sleep 1
buffer_load_dword v54, v55, s[40:43], 0 offen offset:1024 sc1
s_waitcnt vmcnt(0)
s_branch L_s0flag_chk
L_s0flag_ok:
s_add_u32 s62, s97, 0x1000000
buffer_load_dwordx4 v[64:67], v248, s[40:43], s62 offen sc1
s_add_u32 s62, s97, 0x1010000
buffer_load_dwordx4 v[68:71], v248, s[40:43], s62 offen sc1
s_add_u32 s62, s97, 0x1020000
buffer_load_dwordx4 v[72:75], v248, s[40:43], s62 offen sc1
s_add_u32 s62, s97, 0x1030000
buffer_load_dwordx4 v[76:79], v248, s[40:43], s62 offen sc1
s_add_u32 s62, s97, 0x1040000
buffer_load_dwordx4 v[80:83], v248, s[40:43], s62 offen sc1
s_add_u32 s62, s97, 0x1050000
buffer_load_dwordx4 v[84:87], v248, s[40:43], s62 offen sc1
s_add_u32 s62, s97, 0x1060000
buffer_load_dwordx4 v[88:91], v248, s[40:43], s62 offen sc1
s_add_u32 s62, s97, 0x1070000
buffer_load_dwordx4 v[92:95], v248, s[40:43], s62 offen sc1
buffer_load_dword v52, v55, s[40:43], 0 offen offset:2048 sc1
v_accvgpr_read_b32 v0, a224
v_accvgpr_read_b32 v1, a225
v_accvgpr_read_b32 v2, a226
v_accvgpr_read_b32 v3, a227
v_accvgpr_read_b32 v4, a228
v_accvgpr_read_b32 v5, a229
v_accvgpr_read_b32 v6, a230
v_accvgpr_read_b32 v7, a231
v_accvgpr_read_b32 v8, a232
v_accvgpr_read_b32 v9, a233
v_accvgpr_read_b32 v10, a234
v_accvgpr_read_b32 v11, a235
v_accvgpr_read_b32 v12, a236
v_accvgpr_read_b32 v13, a237
v_accvgpr_read_b32 v14, a238
v_accvgpr_read_b32 v15, a239
v_accvgpr_read_b32 v16, a240
v_accvgpr_read_b32 v17, a241
v_accvgpr_read_b32 v18, a242
v_accvgpr_read_b32 v19, a243
v_accvgpr_read_b32 v20, a244
v_accvgpr_read_b32 v21, a245
v_accvgpr_read_b32 v22, a246
v_accvgpr_read_b32 v23, a247
v_accvgpr_read_b32 v24, a248
v_accvgpr_read_b32 v25, a249
v_accvgpr_read_b32 v26, a250
v_accvgpr_read_b32 v27, a251
v_accvgpr_read_b32 v28, a252
v_accvgpr_read_b32 v29, a253
v_accvgpr_read_b32 v30, a254
v_accvgpr_read_b32 v31, a255
v_dot2_f32_bf16 v216, v0, s48, 0
v_dot2_f32_bf16 v217, v0, s49, 0
v_dot2_f32_bf16 v218, v1, s48, 0
v_dot2_f32_bf16 v219, v1, s49, 0
v_dot2_f32_bf16 v220, v2, s48, 0
v_dot2_f32_bf16 v221, v2, s49, 0
v_dot2_f32_bf16 v222, v3, s48, 0
v_dot2_f32_bf16 v223, v3, s49, 0
v_dot2_f32_bf16 v216, v4, s48, v216
v_dot2_f32_bf16 v217, v4, s49, v217
v_dot2_f32_bf16 v218, v5, s48, v218
v_dot2_f32_bf16 v219, v5, s49, v219
v_dot2_f32_bf16 v220, v6, s48, v220
v_dot2_f32_bf16 v221, v6, s49, v221
v_dot2_f32_bf16 v222, v7, s48, v222
v_dot2_f32_bf16 v223, v7, s49, v223
v_dot2_f32_bf16 v216, v8, s48, v216
v_dot2_f32_bf16 v217, v8, s49, v217
v_dot2_f32_bf16 v218, v9, s48, v218
v_dot2_f32_bf16 v219, v9, s49, v219
v_dot2_f32_bf16 v220, v10, s48, v220
v_dot2_f32_bf16 v221, v10, s49, v221
v_dot2_f32_bf16 v222, v11, s48, v222
v_dot2_f32_bf16 v223, v11, s49, v223
v_dot2_f32_bf16 v216, v12, s48, v216
v_dot2_f32_bf16 v217, v12, s49, v217
v_dot2_f32_bf16 v218, v13, s48, v218
v_dot2_f32_bf16 v219, v13, s49, v219
v_dot2_f32_bf16 v220, v14, s48, v220
v_dot2_f32_bf16 v221, v14, s49, v221
v_dot2_f32_bf16 v222, v15, s48, v222
v_dot2_f32_bf16 v223, v15, s49, v223
v_dot2_f32_bf16 v216, v16, s48, v216
v_dot2_f32_bf16 v217, v16, s49, v217
v_dot2_f32_bf16 v218, v17, s48, v218
v_dot2_f32_bf16 v219, v17, s49, v219
v_dot2_f32_bf16 v220, v18, s48, v220
v_dot2_f32_bf16 v221, v18, s49, v221
v_dot2_f32_bf16 v222, v19, s48, v222
v_dot2_f32_bf16 v223, v19, s49, v223
v_dot2_f32_bf16 v216, v20, s48, v216
v_dot2_f32_bf16 v217, v20, s49, v217
v_dot2_f32_bf16 v218, v21, s48, v218
v_dot2_f32_bf16 v219, v21, s49, v219
v_dot2_f32_bf16 v220, v22, s48, v220
v_dot2_f32_bf16 v221, v22, s49, v221
v_dot2_f32_bf16 v222, v23, s48, v222
v_dot2_f32_bf16 v223, v23, s49, v223
v_dot2_f32_bf16 v216, v24, s48, v216
v_dot2_f32_bf16 v217, v24, s49, v217
v_dot2_f32_bf16 v218, v25, s48, v218
v_dot2_f32_bf16 v219, v25, s49, v219
v_dot2_f32_bf16 v220, v26, s48, v220
v_dot2_f32_bf16 v221, v26, s49, v221
v_dot2_f32_bf16 v222, v27, s48, v222
v_dot2_f32_bf16 v223, v27, s49, v223
v_dot2_f32_bf16 v216, v28, s48, v216
v_dot2_f32_bf16 v217, v28, s49, v217
v_dot2_f32_bf16 v218, v29, s48, v218
v_dot2_f32_bf16 v219, v29, s49, v219
v_dot2_f32_bf16 v220, v30, s48, v220
v_dot2_f32_bf16 v221, v30, s49, v221
v_dot2_f32_bf16 v222, v31, s48, v222
v_dot2_f32_bf16 v223, v31, s49, v223
v_mul_f32 v224, s52, v216
v_mul_f32 v225, s52, v217
v_mul_f32 v226, s52, v218
v_mul_f32 v227, s52, v219
v_mul_f32 v228, s52, v220
v_mul_f32 v229, s52, v221
v_mul_f32 v230, s52, v222
v_mul_f32 v231, s52, v223
v_exp_f32 v224, v224
v_exp_f32 v225, v225
v_exp_f32 v226, v226
v_exp_f32 v227, v227
v_exp_f32 v228, v228
v_exp_f32 v229, v229
v_exp_f32 v230, v230
v_exp_f32 v231, v231
v_add_f32 v224, 1.0, v224
v_add_f32 v225, 1.0, v225
v_add_f32 v226, 1.0, v226
v_add_f32 v227, 1.0, v227
v_add_f32 v228, 1.0, v228
v_add_f32 v229, 1.0, v229
v_add_f32 v230, 1.0, v230
v_add_f32 v231, 1.0, v231
v_rcp_f32 v224, v224
v_rcp_f32 v225, v225
v_rcp_f32 v226, v226
v_rcp_f32 v227, v227
v_rcp_f32 v228, v228
v_rcp_f32 v229, v229
v_rcp_f32 v230, v230
v_rcp_f32 v231, v231
v_mul_f32 v216, v224, v216
v_mul_f32 v217, v225, v217
v_mul_f32 v218, v226, v218
v_mul_f32 v219, v227, v219
v_mul_f32 v220, v228, v220
v_mul_f32 v221, v229, v221
v_mul_f32 v222, v230, v222
v_mul_f32 v223, v231, v223
L_s1flag_chk:
s_waitcnt vmcnt(0)
v_or_b32 v52, v52, v61
v_cmp_eq_u32 vcc, 1, v52
s_add_u32 s6, s6, 1
s_cmp_eq_u64 vcc, -1
s_cbranch_scc1 L_s1flag_ok
s_cmp_gt_u32 s6, 0x61a80
s_cbranch_scc1 L_s1flag_ok
s_sleep 1
buffer_load_dword v52, v55, s[40:43], 0 offen offset:2048 sc1
s_waitcnt vmcnt(0)
s_branch L_s1flag_chk
L_s1flag_ok:
s_add_u32 s62, s97, 0x1002000
buffer_load_dwordx4 v[96:99], v248, s[40:43], s62 offen sc1
s_add_u32 s62, s97, 0x1012000
buffer_load_dwordx4 v[100:103], v248, s[40:43], s62 offen sc1
s_add_u32 s62, s97, 0x1022000
buffer_load_dwordx4 v[104:107], v248, s[40:43], s62 offen sc1
s_add_u32 s62, s97, 0x1032000
buffer_load_dwordx4 v[108:111], v248, s[40:43], s62 offen sc1
s_add_u32 s62, s97, 0x1042000
buffer_load_dwordx4 v[112:115], v248, s[40:43], s62 offen sc1
s_add_u32 s62, s97, 0x1052000
buffer_load_dwordx4 v[116:119], v248, s[40:43], s62 offen sc1
s_add_u32 s62, s97, 0x1062000
buffer_load_dwordx4 v[120:123], v248, s[40:43], s62 offen sc1
s_add_u32 s62, s97, 0x1072000
buffer_load_dwordx4 v[124:127], v248, s[40:43], s62 offen sc1
v_lshlrev_b32 v1, 16, v200
v_and_b32 v2, 0xffff0000, v200
v_lshlrev_b32 v3, 16, v201
v_and_b32 v4, 0xffff0000, v201
v_lshlrev_b32 v5, 16, v202
v_and_b32 v6, 0xffff0000, v202
v_lshlrev_b32 v7, 16, v203
v_and_b32 v8, 0xffff0000, v203
v_dot2_f32_bf16 v18, v64, s48, 0
v_dot2_f32_bf16 v19, v64, s49, 0
v_dot2_f32_bf16 v20, v65, s48, 0
v_dot2_f32_bf16 v21, v65, s49, 0
v_dot2_f32_bf16 v22, v66, s48, 0
v_dot2_f32_bf16 v23, v66, s49, 0
v_dot2_f32_bf16 v24, v67, s48, 0
v_dot2_f32_bf16 v25, v67, s49, 0
v_dot2_f32_bf16 v18, v68, s48, v18
v_dot2_f32_bf16 v19, v68, s49, v19
v_dot2_f32_bf16 v20, v69, s48, v20
v_dot2_f32_bf16 v21, v69, s49, v21
v_dot2_f32_bf16 v22, v70, s48, v22
v_dot2_f32_bf16 v23, v70, s49, v23
v_dot2_f32_bf16 v24, v71, s48, v24
v_dot2_f32_bf16 v25, v71, s49, v25
v_dot2_f32_bf16 v18, v72, s48, v18
v_dot2_f32_bf16 v19, v72, s49, v19
v_dot2_f32_bf16 v20, v73, s48, v20
v_dot2_f32_bf16 v21, v73, s49, v21
v_dot2_f32_bf16 v22, v74, s48, v22
v_dot2_f32_bf16 v23, v74, s49, v23
v_dot2_f32_bf16 v24, v75, s48, v24
v_dot2_f32_bf16 v25, v75, s49, v25
v_dot2_f32_bf16 v18, v76, s48, v18
v_dot2_f32_bf16 v19, v76, s49, v19
v_dot2_f32_bf16 v20, v77, s48, v20
v_dot2_f32_bf16 v21, v77, s49, v21
v_dot2_f32_bf16 v22, v78, s48, v22
v_dot2_f32_bf16 v23, v78, s49, v23
v_dot2_f32_bf16 v24, v79, s48, v24
v_dot2_f32_bf16 v25, v79, s49, v25
v_dot2_f32_bf16 v18, v80, s48, v18
v_dot2_f32_bf16 v19, v80, s49, v19
v_dot2_f32_bf16 v20, v81, s48, v20
v_dot2_f32_bf16 v21, v81, s49, v21
v_dot2_f32_bf16 v22, v82, s48, v22
v_dot2_f32_bf16 v23, v82, s49, v23
v_dot2_f32_bf16 v24, v83, s48, v24
v_dot2_f32_bf16 v25, v83, s49, v25
v_dot2_f32_bf16 v18, v84, s48, v18
v_dot2_f32_bf16 v19, v84, s49, v19
v_dot2_f32_bf16 v20, v85, s48, v20
v_dot2_f32_bf16 v21, v85, s49, v21
v_dot2_f32_bf16 v22, v86, s48, v22
v_dot2_f32_bf16 v23, v86, s49, v23
v_dot2_f32_bf16 v24, v87, s48, v24
v_dot2_f32_bf16 v25, v87, s49, v25
v_dot2_f32_bf16 v18, v88, s48, v18
v_dot2_f32_bf16 v19, v88, s49, v19
v_dot2_f32_bf16 v20, v89, s48, v20
v_dot2_f32_bf16 v21, v89, s49, v21
v_dot2_f32_bf16 v22, v90, s48, v22
v_dot2_f32_bf16 v23, v90, s49, v23
v_dot2_f32_bf16 v24, v91, s48, v24
v_dot2_f32_bf16 v25, v91, s49, v25
v_dot2_f32_bf16 v18, v92, s48, v18
v_dot2_f32_bf16 v19, v92, s49, v19
v_dot2_f32_bf16 v20, v93, s48, v20
v_dot2_f32_bf16 v21, v93, s49, v21
v_dot2_f32_bf16 v22, v94, s48, v22
v_dot2_f32_bf16 v23, v94, s49, v23
v_dot2_f32_bf16 v24, v95, s48, v24
v_dot2_f32_bf16 v25, v95, s49, v25
v_fma_f32 v1, v208, v18, v1
v_fma_f32 v2, v209, v19, v2
v_fma_f32 v3, v210, v20, v3
v_fma_f32 v4, v211, v21, v4
v_fma_f32 v5, v212, v22, v5
v_fma_f32 v6, v213, v23, v6
v_fma_f32 v7, v214, v24, v7
v_fma_f32 v8, v215, v25, v8
v_cvt_pk_bf16_f32 v36, v1, v2
v_cvt_pk_bf16_f32 v37, v3, v4
v_cvt_pk_bf16_f32 v38, v5, v6
v_cvt_pk_bf16_f32 v39, v7, v8
buffer_store_dwordx4 v[36:39], v56, s[64:67], 0 offen
v_lshlrev_b32 v9, 16, v204
v_and_b32 v10, 0xffff0000, v204
v_lshlrev_b32 v11, 16, v205
v_and_b32 v12, 0xffff0000, v205
v_lshlrev_b32 v13, 16, v206
v_and_b32 v14, 0xffff0000, v206
v_lshlrev_b32 v15, 16, v207
v_and_b32 v16, 0xffff0000, v207
s_waitcnt vmcnt(8)
v_dot2_f32_bf16 v26, v96, s48, 0
v_dot2_f32_bf16 v27, v96, s49, 0
v_dot2_f32_bf16 v28, v97, s48, 0
v_dot2_f32_bf16 v29, v97, s49, 0
v_dot2_f32_bf16 v30, v98, s48, 0
v_dot2_f32_bf16 v31, v98, s49, 0
v_dot2_f32_bf16 v32, v99, s48, 0
v_dot2_f32_bf16 v33, v99, s49, 0
s_waitcnt vmcnt(7)
v_dot2_f32_bf16 v26, v100, s48, v26
v_dot2_f32_bf16 v27, v100, s49, v27
v_dot2_f32_bf16 v28, v101, s48, v28
v_dot2_f32_bf16 v29, v101, s49, v29
v_dot2_f32_bf16 v30, v102, s48, v30
v_dot2_f32_bf16 v31, v102, s49, v31
v_dot2_f32_bf16 v32, v103, s48, v32
v_dot2_f32_bf16 v33, v103, s49, v33
s_waitcnt vmcnt(6)
v_dot2_f32_bf16 v26, v104, s48, v26
v_dot2_f32_bf16 v27, v104, s49, v27
v_dot2_f32_bf16 v28, v105, s48, v28
v_dot2_f32_bf16 v29, v105, s49, v29
v_dot2_f32_bf16 v30, v106, s48, v30
v_dot2_f32_bf16 v31, v106, s49, v31
v_dot2_f32_bf16 v32, v107, s48, v32
v_dot2_f32_bf16 v33, v107, s49, v33
s_waitcnt vmcnt(5)
v_dot2_f32_bf16 v26, v108, s48, v26
v_dot2_f32_bf16 v27, v108, s49, v27
v_dot2_f32_bf16 v28, v109, s48, v28
v_dot2_f32_bf16 v29, v109, s49, v29
v_dot2_f32_bf16 v30, v110, s48, v30
v_dot2_f32_bf16 v31, v110, s49, v31
v_dot2_f32_bf16 v32, v111, s48, v32
v_dot2_f32_bf16 v33, v111, s49, v33
s_waitcnt vmcnt(4)
v_dot2_f32_bf16 v26, v112, s48, v26
v_dot2_f32_bf16 v27, v112, s49, v27
v_dot2_f32_bf16 v28, v113, s48, v28
v_dot2_f32_bf16 v29, v113, s49, v29
v_dot2_f32_bf16 v30, v114, s48, v30
v_dot2_f32_bf16 v31, v114, s49, v31
v_dot2_f32_bf16 v32, v115, s48, v32
v_dot2_f32_bf16 v33, v115, s49, v33
s_waitcnt vmcnt(3)
v_dot2_f32_bf16 v26, v116, s48, v26
v_dot2_f32_bf16 v27, v116, s49, v27
v_dot2_f32_bf16 v28, v117, s48, v28
v_dot2_f32_bf16 v29, v117, s49, v29
v_dot2_f32_bf16 v30, v118, s48, v30
v_dot2_f32_bf16 v31, v118, s49, v31
v_dot2_f32_bf16 v32, v119, s48, v32
v_dot2_f32_bf16 v33, v119, s49, v33
s_waitcnt vmcnt(2)
v_dot2_f32_bf16 v26, v120, s48, v26
v_dot2_f32_bf16 v27, v120, s49, v27
v_dot2_f32_bf16 v28, v121, s48, v28
v_dot2_f32_bf16 v29, v121, s49, v29
v_dot2_f32_bf16 v30, v122, s48, v30
v_dot2_f32_bf16 v31, v122, s49, v31
v_dot2_f32_bf16 v32, v123, s48, v32
v_dot2_f32_bf16 v33, v123, s49, v33
s_waitcnt vmcnt(1)
v_dot2_f32_bf16 v26, v124, s48, v26
v_dot2_f32_bf16 v27, v124, s49, v27
v_dot2_f32_bf16 v28, v125, s48, v28
v_dot2_f32_bf16 v29, v125, s49, v29
v_dot2_f32_bf16 v30, v126, s48, v30
v_dot2_f32_bf16 v31, v126, s49, v31
v_dot2_f32_bf16 v32, v127, s48, v32
v_dot2_f32_bf16 v33, v127, s49, v33
v_fma_f32 v9, v216, v26, v9
v_fma_f32 v10, v217, v27, v10
v_fma_f32 v11, v218, v28, v11
v_fma_f32 v12, v219, v29, v12
v_fma_f32 v13, v220, v30, v13
v_fma_f32 v14, v221, v31, v14
v_fma_f32 v15, v222, v32, v15
v_fma_f32 v16, v223, v33, v16
v_cvt_pk_bf16_f32 v40, v9, v10
v_cvt_pk_bf16_f32 v41, v11, v12
v_cvt_pk_bf16_f32 v42, v13, v14
v_cvt_pk_bf16_f32 v43, v15, v16
buffer_store_dwordx4 v[40:43], v56, s[64:67], 0 offen offset:128
s_waitcnt vmcnt(0) lgkmcnt(0)
L_end:
s_endpgm
L_fallback:
s_waitcnt vmcnt(0) lgkmcnt(0)
s_barrier
s_mov_b32 s60, 1
s_mov_b32 s56, 0x7ff00000
v_mov_b32 v41, 0xff800000
v_mov_b32 v42, 0xff800000
s_mov_b32 s6, 0
L_fb_loop:
s_mov_b32 m0, s52
s_nop 0
buffer_load_dwordx4 v38, s[32:35], s6 offen lds
buffer_load_dwordx4 v39, s[32:35], s6 offen offset:1088 lds
s_waitcnt vmcnt(0) lgkmcnt(0)
s_barrier
ds_read_b128 a[128:131], v32
ds_read_b128 a[132:135], v33
ds_read_b128 a[136:139], v32 offset:64
ds_read_b128 a[140:143], v33 offset:64
ds_read_b128 a[144:147], v32 offset:128
ds_read_b128 a[148:151], v33 offset:128
ds_read_b128 a[152:155], v32 offset:192
ds_read_b128 a[156:159], v33 offset:192
s_waitcnt lgkmcnt(7)
v_mfma_f32_32x32x16_bf16 v[64:79], a[128:131], v[192:195], 0
v_mfma_f32_32x32x16_bf16 v[80:95], a[128:131], v[196:199], 0
s_waitcnt lgkmcnt(6)
v_mfma_f32_32x32x16_bf16 v[64:79], a[132:135], v[200:203], v[64:79]
v_mfma_f32_32x32x16_bf16 v[80:95], a[132:135], v[204:207], v[80:95]
s_waitcnt lgkmcnt(5)
v_mfma_f32_32x32x16_bf16 v[64:79], a[136:139], v[208:211], v[64:79]
v_mfma_f32_32x32x16_bf16 v[80:95], a[136:139], v[212:215], v[80:95]
s_waitcnt lgkmcnt(4)
v_mfma_f32_32x32x16_bf16 v[64:79], a[140:143], v[216:219], v[64:79]
v_mfma_f32_32x32x16_bf16 v[80:95], a[140:143], v[220:223], v[80:95]
s_waitcnt lgkmcnt(3)
v_mfma_f32_32x32x16_bf16 v[64:79], a[144:147], v[0:3], v[64:79]
v_mfma_f32_32x32x16_bf16 v[80:95], a[144:147], v[4:7], v[80:95]
s_waitcnt lgkmcnt(2)
v_mfma_f32_32x32x16_bf16 v[64:79], a[148:151], v[8:11], v[64:79]
v_mfma_f32_32x32x16_bf16 v[80:95], a[148:151], v[12:15], v[80:95]
s_waitcnt lgkmcnt(1)
v_mfma_f32_32x32x16_bf16 v[64:79], a[152:155], v[16:19], v[64:79]
v_mfma_f32_32x32x16_bf16 v[80:95], a[152:155], v[20:23], v[80:95]
s_waitcnt lgkmcnt(0)
v_mfma_f32_32x32x16_bf16 v[64:79], a[156:159], v[24:27], v[64:79]
v_mfma_f32_32x32x16_bf16 v[80:95], a[156:159], v[28:31], v[80:95]
s_nop 10
v_max3_f32 v41, v41, v64, v65
v_max3_f32 v41, v41, v66, v67
v_max3_f32 v41, v41, v68, v69
v_max3_f32 v41, v41, v70, v71
v_max3_f32 v41, v41, v72, v73
v_max3_f32 v41, v41, v74, v75
v_max3_f32 v41, v41, v76, v77
v_max3_f32 v41, v41, v78, v79
v_max3_f32 v42, v42, v80, v81
v_max3_f32 v42, v42, v82, v83
v_max3_f32 v42, v42, v84, v85
v_max3_f32 v42, v42, v86, v87
v_max3_f32 v42, v42, v88, v89
v_max3_f32 v42, v42, v90, v91
v_max3_f32 v42, v42, v92, v93
v_max3_f32 v42, v42, v94, v95
v_mov_b32 v182, v41
v_mov_b32 v183, v42
s_nop 0
v_permlane32_swap_b32 v41, v182
v_permlane32_swap_b32 v42, v183
v_max_f32 v41, v41, v182
v_max_f32 v42, v42, v183
s_waitcnt vmcnt(0) lgkmcnt(0)
s_barrier
s_add_u32 s6, s6, 0x2000
s_cmp_lt_u32 s6, 0x20000
s_cbranch_scc1 L_fb_loop
s_add_u32 m0, s52, 0
s_mov_b32 s50, 0
buffer_load_dwordx4 v38, s[32:35], s50 offen lds
buffer_load_dwordx4 v39, s[32:35], s50 offen offset:1088 lds
s_add_u32 m0, s52, 0x2200
s_mov_b32 s50, 0x2000
buffer_load_dwordx4 v38, s[32:35], s50 offen lds
buffer_load_dwordx4 v39, s[32:35], s50 offen offset:1088 lds
s_add_u32 m0, s52, 0x4400
s_mov_b32 s50, 0x4000
buffer_load_dwordx4 v38, s[32:35], s50 offen lds
buffer_load_dwordx4 v39, s[32:35], s50 offen offset:1088 lds
s_add_u32 m0, s53, 0
s_mov_b32 s51, 0
buffer_load_dwordx4 v40, s[36:39], s51 offen lds
buffer_load_dwordx4 v40, s[36:39], s51 offen offset:1024 lds
s_add_u32 m0, s53, 0x2000
s_mov_b32 s51, 0x2000
buffer_load_dwordx4 v40, s[36:39], s51 offen lds
buffer_load_dwordx4 v40, s[36:39], s51 offen offset:1024 lds
s_waitcnt vmcnt(0) lgkmcnt(0)
s_barrier
ds_read_b128 a[128:131], v32
ds_read_b128 a[132:135], v33
ds_read_b128 a[136:139], v32 offset:64
ds_read_b128 a[140:143], v33 offset:64
ds_read_b128 a[144:147], v32 offset:128
ds_read_b128 a[148:151], v33 offset:128
ds_read_b128 a[152:155], v32 offset:192
ds_read_b128 a[156:159], v33 offset:192
s_waitcnt vmcnt(0) lgkmcnt(0)
s_branch L_att
L_code_end:
s_endpgm
.section .rodata,"a"
.p2align 6
.amdhsa_kernel recurrent_scan__sliding_block_cached__glu_gated_reglu__prompt_kernel
  .amdhsa_next_free_vgpr 512
  .amdhsa_next_free_sgpr 102
  .amdhsa_accum_offset 256
  .amdhsa_group_segment_fixed_size 0
  .amdhsa_kernarg_size 96
  .amdhsa_user_sgpr_count 2
  .amdhsa_user_sgpr_kernarg_segment_ptr 1
  .amdhsa_system_sgpr_workgroup_id_x 1
.end_amdhsa_kernel
```
